```python
import torch

def _softmax(x, axis=-1):
    return torch.softmax(x, dim=axis)
def _gelu(x):
    return torch.nn.functional.gelu(x, approximate="tanh")
def _silu(x):
    return torch.nn.functional.silu(x)
def _sigmoid(x):
    return torch.sigmoid(x)
def _layernorm(x, axis=-1, eps=1e-5):
    m = x.mean(dim=axis, keepdim=True)
    v = x.var(dim=axis, keepdim=True, unbiased=False)
    return (x - m) / torch.sqrt(v + eps)
def _scatter_add(tgt, idx, src, axis=0):
    return tgt.clone().index_add_(axis, idx, src)
def _segment_sum(src, seg, n):
    out = torch.zeros((n,) + src.shape[1:], dtype=src.dtype)
    return out.index_add_(0, seg, src)
def _pad(x, pw):
    flat = tuple(v for pair in reversed(pw) for v in pair)
    return torch.nn.functional.pad(x, flat)

kernel_name = 'standalone__gqa_block_cached__near_ridge'

def setup_inputs():

    _w = (lambda a: (lambda t: t.to(torch.bfloat16) if t.is_floating_point() else t)(torch.as_tensor(a)))
    B, Sq, D = 8, 128, 448
    Hq, Hkv, Sk, Dh = 16, 8, 1024, 256
    assert Hq % Hkv == 0, (Hq, Hkv)
    return {
        "x": _w((lambda *s: torch.randn(*s, dtype=torch.bfloat16) * 0.8)(B, Sq, D)),
        "k_cache": _w((lambda *s: torch.randn(*s, dtype=torch.bfloat16) * 0.8)(B, Hkv, Sk, Dh)),
        "v_cache": _w((lambda *s: torch.randn(*s, dtype=torch.bfloat16) * 0.05)(B, Hkv, Sk, Dh)),
        "wq": _w((lambda *s: torch.randn(*s, dtype=torch.bfloat16) * 0.8)(D, Hq * Dh) * (D ** -0.5)),
        "wo": _w((lambda *s: torch.randn(*s, dtype=torch.bfloat16) * 0.05)(Hq * Dh, D) * ((Hq * Dh) ** -0.5)),
    }

def reference(x, k_cache, v_cache, wq, wo):
    B, Sq, D = x.shape
    Hq, Dh = 16, 256
    Hkv = k_cache.shape[1]
    rep = Hq // Hkv
    q = (lambda x, *d: x.permute(*d))((x @ wq).reshape(B, Sq, Hq, Dh), 0, 2, 1, 3)
    k = (lambda x, n, axis: torch.repeat_interleave(x, n, dim=axis))(k_cache, rep, axis=1)
    v = (lambda x, n, axis: torch.repeat_interleave(x, n, dim=axis))(v_cache, rep, axis=1)
    scores = torch.einsum("bhqd,bhkd->bhqk", q, k) * (Dh ** -0.5)
    p = _softmax(scores, axis=-1)
    o = torch.einsum("bhqk,bhkd->bhqd", p, v)
    return (lambda x, *d: x.permute(*d))(o, 0, 2, 1, 3).reshape(B, Sq, Hq * Dh) @ wo
```

```asm
; @launch grid=(256,1,1) block=(512,1,1) lds=163840
.amdgcn_target "amdgcn-amd-amdhsa--gfx950"
.text
.globl standalone__gqa_block_cached__near_ridge_kernel
.p2align 8
.type standalone__gqa_block_cached__near_ridge_kernel,@function
standalone__gqa_block_cached__near_ridge_kernel:
s_cmp_lt_u32 s2, 256
s_cbranch_scc1 L_main_go
s_endpgm
L_main_go:
s_load_dwordx8 s[48:55], s[0:1], 0
s_load_dwordx4 s[56:59], s[0:1], 32
s_load_dwordx4 s[92:95], s[0:1], 48
v_lshrrev_b32 v1, 6, v0
v_and_b32 v2, 63, v0
v_readfirstlane_b32 s3, v1
s_and_b32 s4, s2, 7
s_lshr_b32 s5, s2, 3
s_lshr_b32 s32, s5, 2
s_and_b32 s35, s5, 3
s_and_b32 s6, s35, 1
s_lshl_b32 s33, s4, 1
s_add_u32 s33, s33, s6
s_lshr_b32 s34, s35, 1
s_lshr_b32 s44, s5, 1
s_cmp_lt_u32 s3, 4
s_cbranch_scc1 L_compute
s_sub_u32 s45, s3, 4
s_lshl_b32 s6, s6, 2
s_add_u32 s84, s44, s6
s_mul_i32 s7, s84, 37
s_lshr_b32 s7, s7, 8
s_mul_i32 s7, s7, 7
s_sub_u32 s84, s84, s7
s_add_u32 s85, s84, 1
s_cmp_eq_u32 s85, 7
s_cselect_b32 s85, 0, s85
v_lshrrev_b32 v5, 3, v2
v_and_b32 v6, 7, v2
v_lshlrev_b32 v6, 4, v6
v_and_b32 v8, 1, v5
v_lshrrev_b32 v7, 4, v2
v_lshl_add_u32 v8, v7, 4, v8
v_mul_u32_u24 v12, 896, v8
v_add_u32 v12, v12, v6
v_add_u32 v15, 6304, v12
v_add_u32 v14, 5568, v12
v_add_u32 v13, 4832, v12
v_add_u32 v12, 4096, v12
s_lshl_b32 s46, s44, 3
s_and_b32 s6, s45, 1
s_add_u32 s46, s46, s6
s_mul_i32 s46, s46, 7168
s_mul_i32 s61, s45, 4224
s_mul_i32 s83, s45, 4352
s_lshl_b32 s6, s6, 3
s_add_u32 s83, s83, s6
v_lshrrev_b32 v3, 5, v2
v_and_b32 v4, 31, v2
v_lshlrev_b32 v8, 4, v4
v_lshl_add_u32 v16, v3, 15, v8
v_add_u32 v19, 25408, v16
v_add_u32 v18, 18304, v16
v_add_u32 v17, 11200, v16
v_add_u32 v16, 4096, v16
s_lshl_b32 s47, s45, 16
s_lshl_b32 s6, s33, 9
s_add_u32 s47, s47, s6
s_getpc_b64 s[74:75]
L_pc:
s_add_u32 s74, s74, L_table-L_pc
s_addc_u32 s75, s75, 0
s_lshl_b32 s6, s35, 9
v_add_u32 v9, s6, v8
s_mov_b32 m0, 0
s_mov_b32 exec_hi, 0
global_load_lds_dwordx4 v9, s[74:75]
s_mov_b32 exec_hi, -1
s_waitcnt lgkmcnt(0)
s_sub_u32 s8, s48, 4096
s_subb_u32 s9, s49, 0
s_and_b32 s9, s9, 0xffff
s_mov_b32 s10, 0xe1000
s_mov_b32 s11, 0x20000
s_cmp_ge_u32 s45, 2
s_cselect_b32 s6, s85, s84
s_lshl_b32 s6, s6, 7
s_add_u32 m0, s61, 7168
s_add_u32 s6, s6, s46
buffer_load_dwordx4 v12, s[8:11], s6 offen offset:0 lds
buffer_load_dwordx4 v13, s[8:11], s6 offen offset:1056 lds
buffer_load_dwordx4 v14, s[8:11], s6 offen offset:2112 lds
buffer_load_dwordx4 v15, s[8:11], s6 offen offset:3168 lds
s_sub_u32 s20, s54, 4096
s_subb_u32 s21, s55, 0
s_and_b32 s21, s21, 0xffff
s_mov_b32 s22, 0x381000
s_mov_b32 s23, 0x20000
s_lshl_b32 s6, s84, 19
s_add_u32 m0, s83, 24576
s_add_u32 s6, s6, s47
buffer_load_dwordx4 v16, s[20:23], s6 offen offset:0 lds
buffer_load_dwordx4 v17, s[20:23], s6 offen offset:1088 lds
buffer_load_dwordx4 v18, s[20:23], s6 offen offset:2176 lds
buffer_load_dwordx4 v19, s[20:23], s6 offen offset:3264 lds
s_lshl_b32 s6, s84, 19
s_add_u32 m0, s83, 41984
s_add_u32 s6, s6, s47
s_add_u32 s6, s6, 262144
buffer_load_dwordx4 v16, s[20:23], s6 offen offset:0 lds
buffer_load_dwordx4 v17, s[20:23], s6 offen offset:1088 lds
buffer_load_dwordx4 v18, s[20:23], s6 offen offset:2176 lds
buffer_load_dwordx4 v19, s[20:23], s6 offen offset:3264 lds
s_add_u32 s86, s85, 1
s_cmp_eq_u32 s86, 7
s_cselect_b32 s86, 0, s86
s_add_u32 s87, s86, 1
s_cmp_eq_u32 s87, 7
s_cselect_b32 s87, 0, s87
s_cmp_ge_u32 s45, 2
s_cselect_b32 s6, s87, s86
s_lshl_b32 s6, s6, 7
s_add_u32 m0, s61, 59392
s_add_u32 s6, s6, s46
buffer_load_dwordx4 v12, s[8:11], s6 offen offset:0 lds
buffer_load_dwordx4 v13, s[8:11], s6 offen offset:1056 lds
buffer_load_dwordx4 v14, s[8:11], s6 offen offset:2112 lds
buffer_load_dwordx4 v15, s[8:11], s6 offen offset:3168 lds
s_waitcnt vmcnt(8)
s_barrier
s_lshl_b32 s6, s85, 19
s_add_u32 m0, s83, 76800
s_add_u32 s6, s6, s47
buffer_load_dwordx4 v16, s[20:23], s6 offen offset:0 lds
buffer_load_dwordx4 v17, s[20:23], s6 offen offset:1088 lds
buffer_load_dwordx4 v18, s[20:23], s6 offen offset:2176 lds
buffer_load_dwordx4 v19, s[20:23], s6 offen offset:3264 lds
s_add_u32 s88, s87, 1
s_cmp_eq_u32 s88, 7
s_cselect_b32 s88, 0, s88
s_add_u32 s89, s88, 1
s_cmp_eq_u32 s89, 7
s_cselect_b32 s89, 0, s89
s_add_u32 s90, s89, 1
s_cmp_eq_u32 s90, 7
s_cselect_b32 s90, 0, s90
s_add_u32 s91, s90, 1
s_cmp_eq_u32 s91, 7
s_cselect_b32 s91, 0, s91
s_lshl_b32 s80, s32, 3
s_add_u32 s80, s80, s4
s_mul_i32 s5, s80, 69
s_and_b32 s5, s5, 1023
s_lshl_b32 s80, s80, 19
s_lshr_b32 s6, s5, 6
s_lshl_b32 s6, s6, 15
s_or_b32 s81, s80, s6
s_and_b32 s5, s5, 63
s_and_b32 s78, s45, 1
s_lshl_b32 s78, s78, 2
s_lshr_b32 s79, s45, 1
s_xor_b32 s6, s79, 1
s_lshl_b32 s6, s6, 8
s_or_b32 s82, s81, s6
s_lshl_b32 s60, s33, 8
s_lshl_b32 s6, s79, 6
s_add_u32 s60, s60, s6
s_add_u32 s60, s60, s78
s_mul_i32 s60, s60, 896
v_and_b32 v8, 15, v2
v_lshlrev_b32 v8, 4, v8
s_lshl_b32 s6, s45, 2
s_xor_b32 s6, s6, s5
v_lshlrev_b32 v41, 4, v7
v_xor_b32 v41, s6, v41
s_lshl_b32 s6, s79, 5
s_add_u32 s6, s6, s78
s_xor_b32 s6, s6, s5
v_lshlrev_b32 v42, 3, v7
v_xor_b32 v42, s6, v42
v_xor_b32 v20, 0, v41
v_lshl_add_u32 v20, v20, 9, v8
v_add_u32 v20, 4096, v20
v_xor_b32 v21, 1, v41
v_lshl_add_u32 v21, v21, 9, v8
v_add_u32 v21, 3040, v21
v_xor_b32 v22, 2, v41
v_lshl_add_u32 v22, v22, 9, v8
v_add_u32 v22, 1984, v22
v_xor_b32 v23, 3, v41
v_lshl_add_u32 v23, v23, 9, v8
v_add_u32 v23, 928, v23
v_xor_b32 v24, 0, v42
v_lshl_add_u32 v24, v24, 9, v8
v_add_u32 v24, 4096, v24
v_xor_b32 v25, 1, v42
v_lshl_add_u32 v25, v25, 9, v8
v_add_u32 v25, 3040, v25
v_xor_b32 v26, 2, v42
v_lshl_add_u32 v26, v26, 9, v8
v_add_u32 v26, 1984, v26
v_xor_b32 v27, 3, v42
v_lshl_add_u32 v27, v27, 9, v8
v_add_u32 v27, 928, v27
v_lshlrev_b32 v41, 8, v3
v_xor_b32 v42, 0x100, v41
v_add_u32 v32, v42, v20
v_add_u32 v20, v41, v20
v_add_u32 v33, v42, v21
v_add_u32 v21, v41, v21
v_add_u32 v34, v42, v22
v_add_u32 v22, v41, v22
v_add_u32 v35, v42, v23
v_add_u32 v23, v41, v23
v_mul_u32_u24 v28, 7168, v5
v_add_u32 v28, v28, v6
v_add_u32 v31, 3616, v28
v_add_u32 v30, 3776, v28
v_add_u32 v29, 3936, v28
v_add_u32 v28, 4096, v28
s_sub_u32 s12, s50, 4096
s_subb_u32 s13, s51, 0
s_and_b32 s13, s13, 0xffff
s_mov_b32 s14, 0x2001000
s_mov_b32 s15, 0x20000
s_sub_u32 s16, s52, 4096
s_subb_u32 s17, s53, 0
s_and_b32 s17, s17, 0xffff
s_mov_b32 s18, 0x2001000
s_mov_b32 s19, 0x20000
s_sub_u32 s24, s56, 4096
s_subb_u32 s25, s57, 0
s_and_b32 s25, s25, 0xffff
s_mov_b32 s26, 0x381000
s_mov_b32 s27, 0x20000
s_lshl_b32 s76, s44, 2
s_add_u32 s76, s76, s45
s_mul_i32 s76, s76, 3584
s_mul_i32 s6, s33, 229376
s_add_u32 s76, s76, s6
v_min_u32 v10, 27, v2
v_lshlrev_b32 v10, 7, v10
v_add_u32 v10, 4096, v10
s_lshl_b32 s77, s45, 13
s_add_u32 s77, s77, s81
v_lshlrev_b32 v40, 7, v2
v_add_u32 v40, 4096, v40
s_sub_u32 s72, s74, L_table-standalone__gqa_block_cached__near_ridge_kernel
s_subb_u32 s73, s75, 0
s_lshr_b32 s6, s2, 3
s_lshl_b32 s6, s6, 2
s_add_u32 s6, s6, s45
s_lshl_b32 s6, s6, 7
v_lshlrev_b32 v45, 14, v2
v_add_u32 v45, s6, v45
v_min_u32 v45, L_table-standalone__gqa_block_cached__near_ridge_kernel, v45
global_load_dword v11, v45, s[72:73]
s_mov_b32 s0, s92
s_mov_b32 s1, s93
s_mov_b32 s28, s94
s_and_b32 s29, s95, 0xffff
s_mov_b32 s30, 0x10000000
s_mov_b32 s31, 0x20000
s_mov_b32 s96, s58
s_and_b32 s97, s59, 0xffff
s_mov_b32 s98, 0xe0000
s_mov_b32 s99, 0x20000
s_lshl_b32 s63, s44, 12
s_add_u32 s63, s63, 16777216
s_mov_b32 s41, 0x20000
s_mul_i32 s6, s44, 917504
s_lshl_b32 s7, s33, 10
s_add_u32 s6, s6, s7
s_mul_i32 s7, s45, 229376
s_add_u32 s6, s6, s7
v_min_u32 v43, 13, v2
v_lshlrev_b32 v43, 14, v43
v_add_u32 v43, s6, v43
s_add_u32 s6, s63, 3968
v_mov_b32 v44, s6
v_cmp_lt_u32 vcc, 31, v2
s_nop 1
v_cndmask_b32 v43, v43, v44, vcc
s_sub_u32 s7, s44, 7
s_cmp_ge_u32 s44, 7
s_cselect_b32 s44, s7, s44
s_sub_u32 s7, s44, 7
s_cmp_ge_u32 s44, 7
s_cselect_b32 s44, s7, s44
s_cmp_eq_u32 s35, 1
s_cbranch_scc1 L_ld1
s_cmp_eq_u32 s35, 2
s_cbranch_scc1 L_ld2
s_cmp_eq_u32 s35, 3
s_cbranch_scc1 L_ld3
L_ld0:
s_lshl_b32 s6, s85, 19
s_add_u32 m0, s83, 94208
s_add_u32 s6, s6, s47
s_add_u32 s6, s6, 262144
buffer_load_dwordx4 v16, s[20:23], s6 offen offset:0 lds
buffer_load_dwordx4 v17, s[20:23], s6 offen offset:1088 lds
buffer_load_dwordx4 v18, s[20:23], s6 offen offset:2176 lds
buffer_load_dwordx4 v19, s[20:23], s6 offen offset:3264 lds
s_waitcnt vmcnt(13)
s_barrier
s_lshl_b32 s6, s86, 19
s_add_u32 m0, s83, 111616
s_add_u32 s6, s6, s47
buffer_load_dwordx4 v16, s[20:23], s6 offen offset:0 lds
buffer_load_dwordx4 v17, s[20:23], s6 offen offset:1088 lds
buffer_load_dwordx4 v18, s[20:23], s6 offen offset:2176 lds
buffer_load_dwordx4 v19, s[20:23], s6 offen offset:3264 lds
s_lshl_b32 s6, s86, 19
s_add_u32 m0, s83, 129024
s_add_u32 s6, s6, s47
s_add_u32 s6, s6, 262144
buffer_load_dwordx4 v16, s[20:23], s6 offen offset:0 lds
buffer_load_dwordx4 v17, s[20:23], s6 offen offset:1088 lds
buffer_load_dwordx4 v18, s[20:23], s6 offen offset:2176 lds
buffer_load_dwordx4 v19, s[20:23], s6 offen offset:3264 lds
s_waitcnt vmcnt(13)
s_barrier
s_cmp_ge_u32 s45, 2
s_cselect_b32 s6, s89, s88
s_lshl_b32 s6, s6, 7
s_add_u32 m0, s61, 146432
s_add_u32 s6, s6, s46
buffer_load_dwordx4 v12, s[8:11], s6 offen offset:0 lds
buffer_load_dwordx4 v13, s[8:11], s6 offen offset:1056 lds
buffer_load_dwordx4 v14, s[8:11], s6 offen offset:2112 lds
buffer_load_dwordx4 v15, s[8:11], s6 offen offset:3168 lds
s_lshl_b32 s6, s87, 19
s_add_u32 m0, s83, 7168
s_add_u32 s6, s6, s47
buffer_load_dwordx4 v16, s[20:23], s6 offen offset:0 lds
buffer_load_dwordx4 v17, s[20:23], s6 offen offset:1088 lds
buffer_load_dwordx4 v18, s[20:23], s6 offen offset:2176 lds
buffer_load_dwordx4 v19, s[20:23], s6 offen offset:3264 lds
s_waitcnt vmcnt(16)
s_barrier
s_lshl_b32 s6, s87, 19
s_add_u32 m0, s83, 24576
s_add_u32 s6, s6, s47
s_add_u32 s6, s6, 262144
buffer_load_dwordx4 v16, s[20:23], s6 offen offset:0 lds
buffer_load_dwordx4 v17, s[20:23], s6 offen offset:1088 lds
buffer_load_dwordx4 v18, s[20:23], s6 offen offset:2176 lds
buffer_load_dwordx4 v19, s[20:23], s6 offen offset:3264 lds
s_lshl_b32 s6, s88, 19
s_add_u32 m0, s83, 41984
s_add_u32 s6, s6, s47
buffer_load_dwordx4 v16, s[20:23], s6 offen offset:0 lds
buffer_load_dwordx4 v17, s[20:23], s6 offen offset:1088 lds
buffer_load_dwordx4 v18, s[20:23], s6 offen offset:2176 lds
buffer_load_dwordx4 v19, s[20:23], s6 offen offset:3264 lds
s_waitcnt vmcnt(20)
s_barrier
s_add_u32 m0, s61, 76800
s_xor_b32 s6, s81, 0
buffer_load_dwordx4 v20, s[12:15], s6 offen offset:0 lds
buffer_load_dwordx4 v21, s[12:15], s6 offen offset:1056 lds
buffer_load_dwordx4 v22, s[12:15], s6 offen offset:2112 lds
buffer_load_dwordx4 v23, s[12:15], s6 offen offset:3168 lds
s_waitcnt vmcnt(20)
s_barrier
s_add_u32 m0, s61, 59392
s_xor_b32 s6, s81, 0
buffer_load_dwordx4 v32, s[12:15], s6 offen offset:0 lds
buffer_load_dwordx4 v33, s[12:15], s6 offen offset:1056 lds
buffer_load_dwordx4 v34, s[12:15], s6 offen offset:2112 lds
buffer_load_dwordx4 v35, s[12:15], s6 offen offset:3168 lds
s_waitcnt vmcnt(16)
s_barrier
s_lshl_b32 s6, s88, 19
s_add_u32 m0, s83, 94208
s_add_u32 s6, s6, s47
s_add_u32 s6, s6, 262144
buffer_load_dwordx4 v16, s[20:23], s6 offen offset:0 lds
buffer_load_dwordx4 v17, s[20:23], s6 offen offset:1088 lds
buffer_load_dwordx4 v18, s[20:23], s6 offen offset:2176 lds
buffer_load_dwordx4 v19, s[20:23], s6 offen offset:3264 lds
s_cmp_ge_u32 s45, 2
s_cselect_b32 s6, s91, s90
s_lshl_b32 s6, s6, 7
s_add_u32 m0, s61, 111616
s_add_u32 s6, s6, s46
buffer_load_dwordx4 v12, s[8:11], s6 offen offset:0 lds
buffer_load_dwordx4 v13, s[8:11], s6 offen offset:1056 lds
buffer_load_dwordx4 v14, s[8:11], s6 offen offset:2112 lds
buffer_load_dwordx4 v15, s[8:11], s6 offen offset:3168 lds
s_waitcnt vmcnt(20)
s_barrier
s_lshl_b32 s6, s89, 19
s_add_u32 m0, s83, 129024
s_add_u32 s6, s6, s47
buffer_load_dwordx4 v16, s[20:23], s6 offen offset:0 lds
buffer_load_dwordx4 v17, s[20:23], s6 offen offset:1088 lds
buffer_load_dwordx4 v18, s[20:23], s6 offen offset:2176 lds
buffer_load_dwordx4 v19, s[20:23], s6 offen offset:3264 lds
s_waitcnt vmcnt(20)
s_barrier
s_lshl_b32 s6, s89, 19
s_add_u32 m0, s83, 7168
s_add_u32 s6, s6, s47
s_add_u32 s6, s6, 262144
buffer_load_dwordx4 v16, s[20:23], s6 offen offset:0 lds
buffer_load_dwordx4 v17, s[20:23], s6 offen offset:1088 lds
buffer_load_dwordx4 v18, s[20:23], s6 offen offset:2176 lds
buffer_load_dwordx4 v19, s[20:23], s6 offen offset:3264 lds
s_waitcnt vmcnt(12)
s_barrier
s_lshl_b32 s6, s90, 19
s_add_u32 m0, s83, 24576
s_add_u32 s6, s6, s47
buffer_load_dwordx4 v16, s[20:23], s6 offen offset:0 lds
buffer_load_dwordx4 v17, s[20:23], s6 offen offset:1088 lds
buffer_load_dwordx4 v18, s[20:23], s6 offen offset:2176 lds
buffer_load_dwordx4 v19, s[20:23], s6 offen offset:3264 lds
s_lshl_b32 s6, s90, 19
s_add_u32 m0, s83, 146432
s_add_u32 s6, s6, s47
s_add_u32 s6, s6, 262144
buffer_load_dwordx4 v16, s[20:23], s6 offen offset:0 lds
buffer_load_dwordx4 v17, s[20:23], s6 offen offset:1088 lds
buffer_load_dwordx4 v18, s[20:23], s6 offen offset:2176 lds
buffer_load_dwordx4 v19, s[20:23], s6 offen offset:3264 lds
s_waitcnt vmcnt(12)
s_barrier
s_add_u32 m0, s61, 41984
s_xor_b32 s6, s82, 32768
buffer_load_dwordx4 v24, s[16:19], s6 offen offset:0 lds
buffer_load_dwordx4 v25, s[16:19], s6 offen offset:1056 lds
buffer_load_dwordx4 v26, s[16:19], s6 offen offset:2112 lds
buffer_load_dwordx4 v27, s[16:19], s6 offen offset:3168 lds
s_waitcnt vmcnt(12)
s_barrier
s_add_u32 m0, s61, 94208
s_xor_b32 s6, s82, 33024
buffer_load_dwordx4 v24, s[16:19], s6 offen offset:0 lds
buffer_load_dwordx4 v25, s[16:19], s6 offen offset:1056 lds
buffer_load_dwordx4 v26, s[16:19], s6 offen offset:2112 lds
buffer_load_dwordx4 v27, s[16:19], s6 offen offset:3168 lds
s_waitcnt vmcnt(12)
s_barrier
s_waitcnt vmcnt(8)
s_barrier
s_add_u32 m0, s61, 111616
s_xor_b32 s6, s81, 32768
buffer_load_dwordx4 v20, s[12:15], s6 offen offset:0 lds
buffer_load_dwordx4 v21, s[12:15], s6 offen offset:1056 lds
buffer_load_dwordx4 v22, s[12:15], s6 offen offset:2112 lds
buffer_load_dwordx4 v23, s[12:15], s6 offen offset:3168 lds
s_barrier
s_barrier
s_add_u32 m0, s61, 24576
s_xor_b32 s6, s81, 32768
buffer_load_dwordx4 v32, s[12:15], s6 offen offset:0 lds
buffer_load_dwordx4 v33, s[12:15], s6 offen offset:1056 lds
buffer_load_dwordx4 v34, s[12:15], s6 offen offset:2112 lds
buffer_load_dwordx4 v35, s[12:15], s6 offen offset:3168 lds
s_add_u32 m0, s61, 146432
s_xor_b32 s6, s82, 0
buffer_load_dwordx4 v24, s[16:19], s6 offen offset:0 lds
buffer_load_dwordx4 v25, s[16:19], s6 offen offset:1056 lds
buffer_load_dwordx4 v26, s[16:19], s6 offen offset:2112 lds
buffer_load_dwordx4 v27, s[16:19], s6 offen offset:3168 lds
s_waitcnt vmcnt(8)
s_barrier
s_add_u32 m0, s61, 76800
s_xor_b32 s6, s82, 256
buffer_load_dwordx4 v24, s[16:19], s6 offen offset:0 lds
buffer_load_dwordx4 v25, s[16:19], s6 offen offset:1056 lds
buffer_load_dwordx4 v26, s[16:19], s6 offen offset:2112 lds
buffer_load_dwordx4 v27, s[16:19], s6 offen offset:3168 lds
s_waitcnt vmcnt(8)
s_barrier
s_add_u32 m0, s61, 7168
s_xor_b32 s6, s81, 65536
buffer_load_dwordx4 v20, s[12:15], s6 offen offset:0 lds
buffer_load_dwordx4 v21, s[12:15], s6 offen offset:1056 lds
buffer_load_dwordx4 v22, s[12:15], s6 offen offset:2112 lds
buffer_load_dwordx4 v23, s[12:15], s6 offen offset:3168 lds
s_add_u32 m0, s61, 59392
s_xor_b32 s6, s81, 65536
buffer_load_dwordx4 v32, s[12:15], s6 offen offset:0 lds
buffer_load_dwordx4 v33, s[12:15], s6 offen offset:1056 lds
buffer_load_dwordx4 v34, s[12:15], s6 offen offset:2112 lds
buffer_load_dwordx4 v35, s[12:15], s6 offen offset:3168 lds
s_waitcnt vmcnt(12)
s_barrier
s_add_u32 m0, s61, 129024
s_xor_b32 s6, s82, 98304
buffer_load_dwordx4 v24, s[16:19], s6 offen offset:0 lds
buffer_load_dwordx4 v25, s[16:19], s6 offen offset:1056 lds
buffer_load_dwordx4 v26, s[16:19], s6 offen offset:2112 lds
buffer_load_dwordx4 v27, s[16:19], s6 offen offset:3168 lds
s_waitcnt vmcnt(12)
s_barrier
s_add_u32 m0, s61, 111616
s_xor_b32 s6, s82, 98560
buffer_load_dwordx4 v24, s[16:19], s6 offen offset:0 lds
buffer_load_dwordx4 v25, s[16:19], s6 offen offset:1056 lds
buffer_load_dwordx4 v26, s[16:19], s6 offen offset:2112 lds
buffer_load_dwordx4 v27, s[16:19], s6 offen offset:3168 lds
s_waitcnt vmcnt(12)
s_barrier
s_add_u32 m0, s61, 24576
s_xor_b32 s6, s81, 98304
buffer_load_dwordx4 v20, s[12:15], s6 offen offset:0 lds
buffer_load_dwordx4 v21, s[12:15], s6 offen offset:1056 lds
buffer_load_dwordx4 v22, s[12:15], s6 offen offset:2112 lds
buffer_load_dwordx4 v23, s[12:15], s6 offen offset:3168 lds
s_add_u32 m0, s61, 146432
s_xor_b32 s6, s81, 98304
buffer_load_dwordx4 v32, s[12:15], s6 offen offset:0 lds
buffer_load_dwordx4 v33, s[12:15], s6 offen offset:1056 lds
buffer_load_dwordx4 v34, s[12:15], s6 offen offset:2112 lds
buffer_load_dwordx4 v35, s[12:15], s6 offen offset:3168 lds
s_waitcnt vmcnt(16)
s_barrier
s_add_u32 m0, s61, 76800
s_xor_b32 s6, s82, 65536
buffer_load_dwordx4 v24, s[16:19], s6 offen offset:0 lds
buffer_load_dwordx4 v25, s[16:19], s6 offen offset:1056 lds
buffer_load_dwordx4 v26, s[16:19], s6 offen offset:2112 lds
buffer_load_dwordx4 v27, s[16:19], s6 offen offset:3168 lds
s_barrier
s_add_u32 m0, s61, 7168
s_xor_b32 s6, s82, 65792
buffer_load_dwordx4 v24, s[16:19], s6 offen offset:0 lds
buffer_load_dwordx4 v25, s[16:19], s6 offen offset:1056 lds
buffer_load_dwordx4 v26, s[16:19], s6 offen offset:2112 lds
buffer_load_dwordx4 v27, s[16:19], s6 offen offset:3168 lds
s_barrier
s_add_u32 m0, s61, 59392
s_xor_b32 s6, s81, 131072
buffer_load_dwordx4 v20, s[12:15], s6 offen offset:0 lds
buffer_load_dwordx4 v21, s[12:15], s6 offen offset:1056 lds
buffer_load_dwordx4 v22, s[12:15], s6 offen offset:2112 lds
buffer_load_dwordx4 v23, s[12:15], s6 offen offset:3168 lds
s_waitcnt vmcnt(16)
s_barrier
s_add_u32 m0, s61, 41984
s_xor_b32 s6, s81, 131072
buffer_load_dwordx4 v32, s[12:15], s6 offen offset:0 lds
buffer_load_dwordx4 v33, s[12:15], s6 offen offset:1056 lds
buffer_load_dwordx4 v34, s[12:15], s6 offen offset:2112 lds
buffer_load_dwordx4 v35, s[12:15], s6 offen offset:3168 lds
s_waitcnt vmcnt(16)
s_barrier
s_add_u32 m0, s61, 94208
s_xor_b32 s6, s82, 163840
buffer_load_dwordx4 v24, s[16:19], s6 offen offset:0 lds
buffer_load_dwordx4 v25, s[16:19], s6 offen offset:1056 lds
buffer_load_dwordx4 v26, s[16:19], s6 offen offset:2112 lds
buffer_load_dwordx4 v27, s[16:19], s6 offen offset:3168 lds
s_waitcnt vmcnt(16)
s_barrier
s_add_u32 m0, s61, 24576
s_xor_b32 s6, s82, 164096
buffer_load_dwordx4 v24, s[16:19], s6 offen offset:0 lds
buffer_load_dwordx4 v25, s[16:19], s6 offen offset:1056 lds
buffer_load_dwordx4 v26, s[16:19], s6 offen offset:2112 lds
buffer_load_dwordx4 v27, s[16:19], s6 offen offset:3168 lds
s_waitcnt vmcnt(16)
s_barrier
s_add_u32 m0, s61, 146432
s_xor_b32 s6, s81, 163840
buffer_load_dwordx4 v20, s[12:15], s6 offen offset:0 lds
buffer_load_dwordx4 v21, s[12:15], s6 offen offset:1056 lds
buffer_load_dwordx4 v22, s[12:15], s6 offen offset:2112 lds
buffer_load_dwordx4 v23, s[12:15], s6 offen offset:3168 lds
s_waitcnt vmcnt(16)
s_barrier
s_add_u32 m0, s61, 76800
s_xor_b32 s6, s81, 163840
buffer_load_dwordx4 v32, s[12:15], s6 offen offset:0 lds
buffer_load_dwordx4 v33, s[12:15], s6 offen offset:1056 lds
buffer_load_dwordx4 v34, s[12:15], s6 offen offset:2112 lds
buffer_load_dwordx4 v35, s[12:15], s6 offen offset:3168 lds
s_waitcnt vmcnt(16)
s_barrier
s_add_u32 m0, s61, 7168
s_xor_b32 s6, s82, 131072
buffer_load_dwordx4 v24, s[16:19], s6 offen offset:0 lds
buffer_load_dwordx4 v25, s[16:19], s6 offen offset:1056 lds
buffer_load_dwordx4 v26, s[16:19], s6 offen offset:2112 lds
buffer_load_dwordx4 v27, s[16:19], s6 offen offset:3168 lds
s_barrier
s_add_u32 m0, s61, 59392
s_xor_b32 s6, s82, 131328
buffer_load_dwordx4 v24, s[16:19], s6 offen offset:0 lds
buffer_load_dwordx4 v25, s[16:19], s6 offen offset:1056 lds
buffer_load_dwordx4 v26, s[16:19], s6 offen offset:2112 lds
buffer_load_dwordx4 v27, s[16:19], s6 offen offset:3168 lds
s_barrier
s_add_u32 m0, s61, 41984
s_xor_b32 s6, s81, 196608
buffer_load_dwordx4 v20, s[12:15], s6 offen offset:0 lds
buffer_load_dwordx4 v21, s[12:15], s6 offen offset:1056 lds
buffer_load_dwordx4 v22, s[12:15], s6 offen offset:2112 lds
buffer_load_dwordx4 v23, s[12:15], s6 offen offset:3168 lds
s_waitcnt vmcnt(16)
s_barrier
s_add_u32 m0, s61, 129024
s_xor_b32 s6, s81, 196608
buffer_load_dwordx4 v32, s[12:15], s6 offen offset:0 lds
buffer_load_dwordx4 v33, s[12:15], s6 offen offset:1056 lds
buffer_load_dwordx4 v34, s[12:15], s6 offen offset:2112 lds
buffer_load_dwordx4 v35, s[12:15], s6 offen offset:3168 lds
s_waitcnt vmcnt(16)
s_barrier
s_add_u32 m0, s61, 111616
s_xor_b32 s6, s82, 229376
buffer_load_dwordx4 v24, s[16:19], s6 offen offset:0 lds
buffer_load_dwordx4 v25, s[16:19], s6 offen offset:1056 lds
buffer_load_dwordx4 v26, s[16:19], s6 offen offset:2112 lds
buffer_load_dwordx4 v27, s[16:19], s6 offen offset:3168 lds
s_waitcnt vmcnt(16)
s_barrier
s_add_u32 m0, s61, 146432
s_xor_b32 s6, s82, 229632
buffer_load_dwordx4 v24, s[16:19], s6 offen offset:0 lds
buffer_load_dwordx4 v25, s[16:19], s6 offen offset:1056 lds
buffer_load_dwordx4 v26, s[16:19], s6 offen offset:2112 lds
buffer_load_dwordx4 v27, s[16:19], s6 offen offset:3168 lds
s_waitcnt vmcnt(16)
s_barrier
s_add_u32 m0, s61, 76800
s_xor_b32 s6, s81, 229376
buffer_load_dwordx4 v20, s[12:15], s6 offen offset:0 lds
buffer_load_dwordx4 v21, s[12:15], s6 offen offset:1056 lds
buffer_load_dwordx4 v22, s[12:15], s6 offen offset:2112 lds
buffer_load_dwordx4 v23, s[12:15], s6 offen offset:3168 lds
s_waitcnt vmcnt(16)
s_barrier
s_add_u32 m0, s61, 7168
s_xor_b32 s6, s81, 229376
buffer_load_dwordx4 v32, s[12:15], s6 offen offset:0 lds
buffer_load_dwordx4 v33, s[12:15], s6 offen offset:1056 lds
buffer_load_dwordx4 v34, s[12:15], s6 offen offset:2112 lds
buffer_load_dwordx4 v35, s[12:15], s6 offen offset:3168 lds
s_waitcnt vmcnt(16)
s_barrier
s_add_u32 m0, s61, 59392
s_xor_b32 s6, s82, 196608
buffer_load_dwordx4 v24, s[16:19], s6 offen offset:0 lds
buffer_load_dwordx4 v25, s[16:19], s6 offen offset:1056 lds
buffer_load_dwordx4 v26, s[16:19], s6 offen offset:2112 lds
buffer_load_dwordx4 v27, s[16:19], s6 offen offset:3168 lds
s_barrier
s_add_u32 m0, s61, 41984
s_xor_b32 s6, s82, 196864
buffer_load_dwordx4 v24, s[16:19], s6 offen offset:0 lds
buffer_load_dwordx4 v25, s[16:19], s6 offen offset:1056 lds
buffer_load_dwordx4 v26, s[16:19], s6 offen offset:2112 lds
buffer_load_dwordx4 v27, s[16:19], s6 offen offset:3168 lds
s_barrier
s_add_u32 m0, s61, 129024
s_xor_b32 s6, s81, 262144
buffer_load_dwordx4 v20, s[12:15], s6 offen offset:0 lds
buffer_load_dwordx4 v21, s[12:15], s6 offen offset:1056 lds
buffer_load_dwordx4 v22, s[12:15], s6 offen offset:2112 lds
buffer_load_dwordx4 v23, s[12:15], s6 offen offset:3168 lds
s_waitcnt vmcnt(16)
s_barrier
s_add_u32 m0, s61, 94208
s_xor_b32 s6, s81, 262144
buffer_load_dwordx4 v32, s[12:15], s6 offen offset:0 lds
buffer_load_dwordx4 v33, s[12:15], s6 offen offset:1056 lds
buffer_load_dwordx4 v34, s[12:15], s6 offen offset:2112 lds
buffer_load_dwordx4 v35, s[12:15], s6 offen offset:3168 lds
s_waitcnt vmcnt(16)
s_barrier
s_add_u32 m0, s61, 24576
s_xor_b32 s6, s82, 294912
buffer_load_dwordx4 v24, s[16:19], s6 offen offset:0 lds
buffer_load_dwordx4 v25, s[16:19], s6 offen offset:1056 lds
buffer_load_dwordx4 v26, s[16:19], s6 offen offset:2112 lds
buffer_load_dwordx4 v27, s[16:19], s6 offen offset:3168 lds
s_waitcnt vmcnt(16)
s_barrier
s_add_u32 m0, s61, 76800
s_xor_b32 s6, s82, 295168
buffer_load_dwordx4 v24, s[16:19], s6 offen offset:0 lds
buffer_load_dwordx4 v25, s[16:19], s6 offen offset:1056 lds
buffer_load_dwordx4 v26, s[16:19], s6 offen offset:2112 lds
buffer_load_dwordx4 v27, s[16:19], s6 offen offset:3168 lds
s_waitcnt vmcnt(16)
s_barrier
s_add_u32 m0, s61, 7168
s_xor_b32 s6, s81, 294912
buffer_load_dwordx4 v20, s[12:15], s6 offen offset:0 lds
buffer_load_dwordx4 v21, s[12:15], s6 offen offset:1056 lds
buffer_load_dwordx4 v22, s[12:15], s6 offen offset:2112 lds
buffer_load_dwordx4 v23, s[12:15], s6 offen offset:3168 lds
s_waitcnt vmcnt(16)
s_barrier
s_add_u32 m0, s61, 59392
s_xor_b32 s6, s81, 294912
buffer_load_dwordx4 v32, s[12:15], s6 offen offset:0 lds
buffer_load_dwordx4 v33, s[12:15], s6 offen offset:1056 lds
buffer_load_dwordx4 v34, s[12:15], s6 offen offset:2112 lds
buffer_load_dwordx4 v35, s[12:15], s6 offen offset:3168 lds
s_waitcnt vmcnt(16)
s_barrier
s_add_u32 m0, s61, 41984
s_xor_b32 s6, s82, 262144
buffer_load_dwordx4 v24, s[16:19], s6 offen offset:0 lds
buffer_load_dwordx4 v25, s[16:19], s6 offen offset:1056 lds
buffer_load_dwordx4 v26, s[16:19], s6 offen offset:2112 lds
buffer_load_dwordx4 v27, s[16:19], s6 offen offset:3168 lds
s_barrier
s_add_u32 m0, s61, 129024
s_xor_b32 s6, s82, 262400
buffer_load_dwordx4 v24, s[16:19], s6 offen offset:0 lds
buffer_load_dwordx4 v25, s[16:19], s6 offen offset:1056 lds
buffer_load_dwordx4 v26, s[16:19], s6 offen offset:2112 lds
buffer_load_dwordx4 v27, s[16:19], s6 offen offset:3168 lds
s_barrier
s_add_u32 m0, s61, 94208
s_xor_b32 s6, s81, 327680
buffer_load_dwordx4 v20, s[12:15], s6 offen offset:0 lds
buffer_load_dwordx4 v21, s[12:15], s6 offen offset:1056 lds
buffer_load_dwordx4 v22, s[12:15], s6 offen offset:2112 lds
buffer_load_dwordx4 v23, s[12:15], s6 offen offset:3168 lds
s_waitcnt vmcnt(16)
s_barrier
s_add_u32 m0, s61, 111616
s_xor_b32 s6, s81, 327680
buffer_load_dwordx4 v32, s[12:15], s6 offen offset:0 lds
buffer_load_dwordx4 v33, s[12:15], s6 offen offset:1056 lds
buffer_load_dwordx4 v34, s[12:15], s6 offen offset:2112 lds
buffer_load_dwordx4 v35, s[12:15], s6 offen offset:3168 lds
s_waitcnt vmcnt(16)
s_barrier
buffer_load_dword v11, v10, s[24:27], s76 offen
v_mov_b32 v50, 0
global_load_dword v48, v50, s[0:1] sc1
global_load_dword v11, v45, s[72:73]
s_add_u32 m0, s61, 146432
s_xor_b32 s6, s82, 360448
buffer_load_dwordx4 v24, s[16:19], s6 offen offset:0 lds
buffer_load_dwordx4 v25, s[16:19], s6 offen offset:1056 lds
buffer_load_dwordx4 v26, s[16:19], s6 offen offset:2112 lds
buffer_load_dwordx4 v27, s[16:19], s6 offen offset:3168 lds
s_waitcnt vmcnt(19)
s_barrier
s_add_u32 m0, s61, 7168
s_xor_b32 s6, s82, 360704
buffer_load_dwordx4 v24, s[16:19], s6 offen offset:0 lds
buffer_load_dwordx4 v25, s[16:19], s6 offen offset:1056 lds
buffer_load_dwordx4 v26, s[16:19], s6 offen offset:2112 lds
buffer_load_dwordx4 v27, s[16:19], s6 offen offset:3168 lds
s_waitcnt vmcnt(19)
s_barrier
s_add_u32 m0, s61, 59392
s_xor_b32 s6, s81, 360448
buffer_load_dwordx4 v20, s[12:15], s6 offen offset:0 lds
buffer_load_dwordx4 v21, s[12:15], s6 offen offset:1056 lds
buffer_load_dwordx4 v22, s[12:15], s6 offen offset:2112 lds
buffer_load_dwordx4 v23, s[12:15], s6 offen offset:3168 lds
s_waitcnt vmcnt(19)
s_barrier
s_add_u32 m0, s61, 41984
s_xor_b32 s6, s81, 360448
buffer_load_dwordx4 v32, s[12:15], s6 offen offset:0 lds
buffer_load_dwordx4 v33, s[12:15], s6 offen offset:1056 lds
buffer_load_dwordx4 v34, s[12:15], s6 offen offset:2112 lds
buffer_load_dwordx4 v35, s[12:15], s6 offen offset:3168 lds
s_waitcnt vmcnt(19)
s_barrier
s_add_u32 m0, s61, 129024
s_xor_b32 s6, s82, 327680
buffer_load_dwordx4 v24, s[16:19], s6 offen offset:0 lds
buffer_load_dwordx4 v25, s[16:19], s6 offen offset:1056 lds
buffer_load_dwordx4 v26, s[16:19], s6 offen offset:2112 lds
buffer_load_dwordx4 v27, s[16:19], s6 offen offset:3168 lds
s_barrier
s_add_u32 m0, s61, 94208
s_xor_b32 s6, s82, 327936
buffer_load_dwordx4 v24, s[16:19], s6 offen offset:0 lds
buffer_load_dwordx4 v25, s[16:19], s6 offen offset:1056 lds
buffer_load_dwordx4 v26, s[16:19], s6 offen offset:2112 lds
buffer_load_dwordx4 v27, s[16:19], s6 offen offset:3168 lds
s_barrier
s_add_u32 m0, s61, 111616
s_xor_b32 s6, s81, 393216
buffer_load_dwordx4 v20, s[12:15], s6 offen offset:0 lds
buffer_load_dwordx4 v21, s[12:15], s6 offen offset:1056 lds
buffer_load_dwordx4 v22, s[12:15], s6 offen offset:2112 lds
buffer_load_dwordx4 v23, s[12:15], s6 offen offset:3168 lds
s_waitcnt vmcnt(16)
s_barrier
s_add_u32 m0, s61, 24576
s_xor_b32 s6, s81, 393216
buffer_load_dwordx4 v32, s[12:15], s6 offen offset:0 lds
buffer_load_dwordx4 v33, s[12:15], s6 offen offset:1056 lds
buffer_load_dwordx4 v34, s[12:15], s6 offen offset:2112 lds
buffer_load_dwordx4 v35, s[12:15], s6 offen offset:3168 lds
s_waitcnt vmcnt(16)
s_barrier
s_add_u32 m0, s61, 76800
s_xor_b32 s6, s82, 425984
buffer_load_dwordx4 v24, s[16:19], s6 offen offset:0 lds
buffer_load_dwordx4 v25, s[16:19], s6 offen offset:1056 lds
buffer_load_dwordx4 v26, s[16:19], s6 offen offset:2112 lds
buffer_load_dwordx4 v27, s[16:19], s6 offen offset:3168 lds
s_waitcnt vmcnt(16)
s_barrier
s_add_u32 m0, s61, 59392
s_xor_b32 s6, s82, 426240
buffer_load_dwordx4 v24, s[16:19], s6 offen offset:0 lds
buffer_load_dwordx4 v25, s[16:19], s6 offen offset:1056 lds
buffer_load_dwordx4 v26, s[16:19], s6 offen offset:2112 lds
buffer_load_dwordx4 v27, s[16:19], s6 offen offset:3168 lds
s_waitcnt vmcnt(16)
s_barrier
s_add_u32 m0, s61, 41984
s_xor_b32 s6, s81, 425984
buffer_load_dwordx4 v20, s[12:15], s6 offen offset:0 lds
buffer_load_dwordx4 v21, s[12:15], s6 offen offset:1056 lds
buffer_load_dwordx4 v22, s[12:15], s6 offen offset:2112 lds
buffer_load_dwordx4 v23, s[12:15], s6 offen offset:3168 lds
s_waitcnt vmcnt(16)
s_barrier
s_add_u32 m0, s61, 129024
s_xor_b32 s6, s81, 425984
buffer_load_dwordx4 v32, s[12:15], s6 offen offset:0 lds
buffer_load_dwordx4 v33, s[12:15], s6 offen offset:1056 lds
buffer_load_dwordx4 v34, s[12:15], s6 offen offset:2112 lds
buffer_load_dwordx4 v35, s[12:15], s6 offen offset:3168 lds
s_waitcnt vmcnt(16)
s_barrier
s_add_u32 m0, s61, 94208
s_xor_b32 s6, s82, 393216
buffer_load_dwordx4 v24, s[16:19], s6 offen offset:0 lds
buffer_load_dwordx4 v25, s[16:19], s6 offen offset:1056 lds
buffer_load_dwordx4 v26, s[16:19], s6 offen offset:2112 lds
buffer_load_dwordx4 v27, s[16:19], s6 offen offset:3168 lds
s_barrier
s_add_u32 m0, s61, 111616
s_xor_b32 s6, s82, 393472
buffer_load_dwordx4 v24, s[16:19], s6 offen offset:0 lds
buffer_load_dwordx4 v25, s[16:19], s6 offen offset:1056 lds
buffer_load_dwordx4 v26, s[16:19], s6 offen offset:2112 lds
buffer_load_dwordx4 v27, s[16:19], s6 offen offset:3168 lds
s_barrier
s_add_u32 m0, s61, 24576
s_xor_b32 s6, s81, 458752
buffer_load_dwordx4 v20, s[12:15], s6 offen offset:0 lds
buffer_load_dwordx4 v21, s[12:15], s6 offen offset:1056 lds
buffer_load_dwordx4 v22, s[12:15], s6 offen offset:2112 lds
buffer_load_dwordx4 v23, s[12:15], s6 offen offset:3168 lds
s_waitcnt vmcnt(16)
s_barrier
s_add_u32 m0, s61, 146432
s_xor_b32 s6, s81, 458752
buffer_load_dwordx4 v32, s[12:15], s6 offen offset:0 lds
buffer_load_dwordx4 v33, s[12:15], s6 offen offset:1056 lds
buffer_load_dwordx4 v34, s[12:15], s6 offen offset:2112 lds
buffer_load_dwordx4 v35, s[12:15], s6 offen offset:3168 lds
s_waitcnt vmcnt(16)
s_barrier
s_add_u32 m0, s61, 7168
s_xor_b32 s6, s81, 491520
buffer_load_dwordx4 v20, s[12:15], s6 offen offset:0 lds
buffer_load_dwordx4 v21, s[12:15], s6 offen offset:1056 lds
buffer_load_dwordx4 v22, s[12:15], s6 offen offset:2112 lds
buffer_load_dwordx4 v23, s[12:15], s6 offen offset:3168 lds
s_waitcnt vmcnt(16)
s_barrier
s_add_u32 m0, s61, 41984
s_xor_b32 s6, s81, 491520
buffer_load_dwordx4 v32, s[12:15], s6 offen offset:0 lds
buffer_load_dwordx4 v33, s[12:15], s6 offen offset:1056 lds
buffer_load_dwordx4 v34, s[12:15], s6 offen offset:2112 lds
buffer_load_dwordx4 v35, s[12:15], s6 offen offset:3168 lds
s_waitcnt vmcnt(16)
s_barrier
s_add_u32 m0, s61, 129024
s_xor_b32 s6, s82, 458752
buffer_load_dwordx4 v24, s[16:19], s6 offen offset:0 lds
buffer_load_dwordx4 v25, s[16:19], s6 offen offset:1056 lds
buffer_load_dwordx4 v26, s[16:19], s6 offen offset:2112 lds
buffer_load_dwordx4 v27, s[16:19], s6 offen offset:3168 lds
s_waitcnt vmcnt(16)
s_barrier
s_add_u32 m0, s61, 94208
s_xor_b32 s6, s82, 459008
buffer_load_dwordx4 v24, s[16:19], s6 offen offset:0 lds
buffer_load_dwordx4 v25, s[16:19], s6 offen offset:1056 lds
buffer_load_dwordx4 v26, s[16:19], s6 offen offset:2112 lds
buffer_load_dwordx4 v27, s[16:19], s6 offen offset:3168 lds
s_waitcnt vmcnt(16)
s_barrier
s_add_u32 m0, s61, 111616
s_xor_b32 s6, s82, 491520
buffer_load_dwordx4 v24, s[16:19], s6 offen offset:0 lds
buffer_load_dwordx4 v25, s[16:19], s6 offen offset:1056 lds
buffer_load_dwordx4 v26, s[16:19], s6 offen offset:2112 lds
buffer_load_dwordx4 v27, s[16:19], s6 offen offset:3168 lds
s_barrier
s_add_u32 m0, s61, 24576
s_xor_b32 s6, s82, 491776
buffer_load_dwordx4 v24, s[16:19], s6 offen offset:0 lds
buffer_load_dwordx4 v25, s[16:19], s6 offen offset:1056 lds
buffer_load_dwordx4 v26, s[16:19], s6 offen offset:2112 lds
buffer_load_dwordx4 v27, s[16:19], s6 offen offset:3168 lds
s_barrier
s_mov_b32 s84, s44
s_add_u32 s85, s84, 1
s_cmp_eq_u32 s85, 7
s_cselect_b32 s85, 0, s85
s_add_u32 s86, s85, 1
s_cmp_eq_u32 s86, 7
s_cselect_b32 s86, 0, s86
s_add_u32 s87, s86, 1
s_cmp_eq_u32 s87, 7
s_cselect_b32 s87, 0, s87
s_add_u32 s88, s87, 1
s_cmp_eq_u32 s88, 7
s_cselect_b32 s88, 0, s88
s_add_u32 s89, s88, 1
s_cmp_eq_u32 s89, 7
s_cselect_b32 s89, 0, s89
s_add_u32 s90, s89, 1
s_cmp_eq_u32 s90, 7
s_cselect_b32 s90, 0, s90
s_lshl_b32 s6, s84, 7
s_add_u32 m0, s61, 146432
s_add_u32 s6, s6, s60
buffer_load_dwordx4 v28, s[24:27], s6 offen offset:0 lds
buffer_load_dwordx4 v29, s[24:27], s6 offen offset:1056 lds
buffer_load_dwordx4 v30, s[24:27], s6 offen offset:2112 lds
buffer_load_dwordx4 v31, s[24:27], s6 offen offset:3168 lds
s_waitcnt vmcnt(24)
s_barrier
s_lshl_b32 s6, s84, 7
s_add_u32 m0, s61, 76800
s_add_u32 s6, s6, s60
s_add_u32 s6, s6, 114688
buffer_load_dwordx4 v28, s[24:27], s6 offen offset:0 lds
buffer_load_dwordx4 v29, s[24:27], s6 offen offset:1056 lds
buffer_load_dwordx4 v30, s[24:27], s6 offen offset:2112 lds
buffer_load_dwordx4 v31, s[24:27], s6 offen offset:3168 lds
s_waitcnt vmcnt(24)
s_barrier
s_lshl_b32 s6, s85, 7
s_add_u32 m0, s61, 59392
s_add_u32 s6, s6, s60
buffer_load_dwordx4 v28, s[24:27], s6 offen offset:0 lds
buffer_load_dwordx4 v29, s[24:27], s6 offen offset:1056 lds
buffer_load_dwordx4 v30, s[24:27], s6 offen offset:2112 lds
buffer_load_dwordx4 v31, s[24:27], s6 offen offset:3168 lds
s_waitcnt vmcnt(24)
s_barrier
s_lshl_b32 s6, s85, 7
s_add_u32 m0, s61, 7168
s_add_u32 s6, s6, s60
s_add_u32 s6, s6, 114688
buffer_load_dwordx4 v28, s[24:27], s6 offen offset:0 lds
buffer_load_dwordx4 v29, s[24:27], s6 offen offset:1056 lds
buffer_load_dwordx4 v30, s[24:27], s6 offen offset:2112 lds
buffer_load_dwordx4 v31, s[24:27], s6 offen offset:3168 lds
s_waitcnt vmcnt(24)
s_barrier
s_lshl_b32 s6, s86, 7
s_add_u32 m0, s61, 41984
s_add_u32 s6, s6, s60
buffer_load_dwordx4 v28, s[24:27], s6 offen offset:0 lds
buffer_load_dwordx4 v29, s[24:27], s6 offen offset:1056 lds
buffer_load_dwordx4 v30, s[24:27], s6 offen offset:2112 lds
buffer_load_dwordx4 v31, s[24:27], s6 offen offset:3168 lds
s_waitcnt vmcnt(24)
s_barrier
s_waitcnt vmcnt(20)
s_barrier
s_waitcnt vmcnt(12)
s_barrier
s_barrier
s_lshl_b32 s6, s86, 7
s_add_u32 m0, s61, 24576
s_add_u32 s6, s6, s60
s_add_u32 s6, s6, 114688
buffer_load_dwordx4 v28, s[24:27], s6 offen offset:0 lds
buffer_load_dwordx4 v29, s[24:27], s6 offen offset:1056 lds
buffer_load_dwordx4 v30, s[24:27], s6 offen offset:2112 lds
buffer_load_dwordx4 v31, s[24:27], s6 offen offset:3168 lds
s_waitcnt vmcnt(8)
s_barrier
s_lshl_b32 s6, s87, 7
s_add_u32 m0, s61, 111616
s_add_u32 s6, s6, s60
buffer_load_dwordx4 v28, s[24:27], s6 offen offset:0 lds
buffer_load_dwordx4 v29, s[24:27], s6 offen offset:1056 lds
buffer_load_dwordx4 v30, s[24:27], s6 offen offset:2112 lds
buffer_load_dwordx4 v31, s[24:27], s6 offen offset:3168 lds
s_barrier
s_lshl_b32 s6, s87, 7
s_add_u32 m0, s61, 94208
s_add_u32 s6, s6, s60
s_add_u32 s6, s6, 114688
buffer_load_dwordx4 v28, s[24:27], s6 offen offset:0 lds
buffer_load_dwordx4 v29, s[24:27], s6 offen offset:1056 lds
buffer_load_dwordx4 v30, s[24:27], s6 offen offset:2112 lds
buffer_load_dwordx4 v31, s[24:27], s6 offen offset:3168 lds
s_waitcnt vmcnt(8)
s_barrier
s_lshl_b32 s6, s88, 7
s_add_u32 m0, s61, 129024
s_add_u32 s6, s6, s60
buffer_load_dwordx4 v28, s[24:27], s6 offen offset:0 lds
buffer_load_dwordx4 v29, s[24:27], s6 offen offset:1056 lds
buffer_load_dwordx4 v30, s[24:27], s6 offen offset:2112 lds
buffer_load_dwordx4 v31, s[24:27], s6 offen offset:3168 lds
s_barrier
s_lshl_b32 s6, s88, 7
s_add_u32 m0, s61, 76800
s_add_u32 s6, s6, s60
s_add_u32 s6, s6, 114688
buffer_load_dwordx4 v28, s[24:27], s6 offen offset:0 lds
buffer_load_dwordx4 v29, s[24:27], s6 offen offset:1056 lds
buffer_load_dwordx4 v30, s[24:27], s6 offen offset:2112 lds
buffer_load_dwordx4 v31, s[24:27], s6 offen offset:3168 lds
s_waitcnt vmcnt(8)
s_barrier
s_lshl_b32 s6, s89, 7
s_add_u32 m0, s61, 146432
s_add_u32 s6, s6, s60
buffer_load_dwordx4 v28, s[24:27], s6 offen offset:0 lds
buffer_load_dwordx4 v29, s[24:27], s6 offen offset:1056 lds
buffer_load_dwordx4 v30, s[24:27], s6 offen offset:2112 lds
buffer_load_dwordx4 v31, s[24:27], s6 offen offset:3168 lds
s_barrier
s_lshl_b32 s6, s89, 7
s_add_u32 m0, s61, 7168
s_add_u32 s6, s6, s60
s_add_u32 s6, s6, 114688
buffer_load_dwordx4 v28, s[24:27], s6 offen offset:0 lds
buffer_load_dwordx4 v29, s[24:27], s6 offen offset:1056 lds
buffer_load_dwordx4 v30, s[24:27], s6 offen offset:2112 lds
buffer_load_dwordx4 v31, s[24:27], s6 offen offset:3168 lds
s_waitcnt vmcnt(8)
s_barrier
s_lshl_b32 s6, s90, 7
s_add_u32 m0, s61, 59392
s_add_u32 s6, s6, s60
buffer_load_dwordx4 v28, s[24:27], s6 offen offset:0 lds
buffer_load_dwordx4 v29, s[24:27], s6 offen offset:1056 lds
buffer_load_dwordx4 v30, s[24:27], s6 offen offset:2112 lds
buffer_load_dwordx4 v31, s[24:27], s6 offen offset:3168 lds
s_barrier
s_lshl_b32 s6, s90, 7
s_add_u32 m0, s61, 24576
s_add_u32 s6, s6, s60
s_add_u32 s6, s6, 114688
buffer_load_dwordx4 v28, s[24:27], s6 offen offset:0 lds
buffer_load_dwordx4 v29, s[24:27], s6 offen offset:1056 lds
buffer_load_dwordx4 v30, s[24:27], s6 offen offset:2112 lds
buffer_load_dwordx4 v31, s[24:27], s6 offen offset:3168 lds
s_waitcnt vmcnt(8)
s_barrier
s_barrier
s_waitcnt vmcnt(0)
s_barrier
s_barrier
s_mov_b32 s62, s45
s_branch L_reduce
L_ld1:
s_lshl_b32 s6, s85, 19
s_add_u32 m0, s83, 94208
s_add_u32 s6, s6, s47
s_add_u32 s6, s6, 262144
buffer_load_dwordx4 v17, s[20:23], s6 offen offset:1088 lds
buffer_load_dwordx4 v18, s[20:23], s6 offen offset:2176 lds
buffer_load_dwordx4 v19, s[20:23], s6 offen offset:3264 lds
buffer_load_dwordx4 v16, s[20:23], s6 offen offset:0 lds
s_waitcnt vmcnt(13)
s_barrier
s_lshl_b32 s6, s86, 19
s_add_u32 m0, s83, 111616
s_add_u32 s6, s6, s47
buffer_load_dwordx4 v17, s[20:23], s6 offen offset:1088 lds
buffer_load_dwordx4 v18, s[20:23], s6 offen offset:2176 lds
buffer_load_dwordx4 v19, s[20:23], s6 offen offset:3264 lds
buffer_load_dwordx4 v16, s[20:23], s6 offen offset:0 lds
s_lshl_b32 s6, s86, 19
s_add_u32 m0, s83, 129024
s_add_u32 s6, s6, s47
s_add_u32 s6, s6, 262144
buffer_load_dwordx4 v17, s[20:23], s6 offen offset:1088 lds
buffer_load_dwordx4 v18, s[20:23], s6 offen offset:2176 lds
buffer_load_dwordx4 v19, s[20:23], s6 offen offset:3264 lds
buffer_load_dwordx4 v16, s[20:23], s6 offen offset:0 lds
s_waitcnt vmcnt(13)
s_barrier
s_cmp_ge_u32 s45, 2
s_cselect_b32 s6, s89, s88
s_lshl_b32 s6, s6, 7
s_add_u32 m0, s61, 146432
s_add_u32 s6, s6, s46
buffer_load_dwordx4 v13, s[8:11], s6 offen offset:1056 lds
buffer_load_dwordx4 v14, s[8:11], s6 offen offset:2112 lds
buffer_load_dwordx4 v15, s[8:11], s6 offen offset:3168 lds
buffer_load_dwordx4 v12, s[8:11], s6 offen offset:0 lds
s_lshl_b32 s6, s87, 19
s_add_u32 m0, s83, 7168
s_add_u32 s6, s6, s47
buffer_load_dwordx4 v17, s[20:23], s6 offen offset:1088 lds
buffer_load_dwordx4 v18, s[20:23], s6 offen offset:2176 lds
buffer_load_dwordx4 v19, s[20:23], s6 offen offset:3264 lds
buffer_load_dwordx4 v16, s[20:23], s6 offen offset:0 lds
s_waitcnt vmcnt(16)
s_barrier
s_lshl_b32 s6, s87, 19
s_add_u32 m0, s83, 24576
s_add_u32 s6, s6, s47
s_add_u32 s6, s6, 262144
buffer_load_dwordx4 v17, s[20:23], s6 offen offset:1088 lds
buffer_load_dwordx4 v18, s[20:23], s6 offen offset:2176 lds
buffer_load_dwordx4 v19, s[20:23], s6 offen offset:3264 lds
buffer_load_dwordx4 v16, s[20:23], s6 offen offset:0 lds
s_lshl_b32 s6, s88, 19
s_add_u32 m0, s83, 41984
s_add_u32 s6, s6, s47
buffer_load_dwordx4 v17, s[20:23], s6 offen offset:1088 lds
buffer_load_dwordx4 v18, s[20:23], s6 offen offset:2176 lds
buffer_load_dwordx4 v19, s[20:23], s6 offen offset:3264 lds
buffer_load_dwordx4 v16, s[20:23], s6 offen offset:0 lds
s_waitcnt vmcnt(20)
s_barrier
s_lshl_b32 s6, s88, 19
s_add_u32 m0, s83, 76800
s_add_u32 s6, s6, s47
s_add_u32 s6, s6, 262144
buffer_load_dwordx4 v17, s[20:23], s6 offen offset:1088 lds
buffer_load_dwordx4 v18, s[20:23], s6 offen offset:2176 lds
buffer_load_dwordx4 v19, s[20:23], s6 offen offset:3264 lds
buffer_load_dwordx4 v16, s[20:23], s6 offen offset:0 lds
s_waitcnt vmcnt(20)
s_barrier
s_cmp_ge_u32 s45, 2
s_cselect_b32 s6, s91, s90
s_lshl_b32 s6, s6, 7
s_add_u32 m0, s61, 59392
s_add_u32 s6, s6, s46
buffer_load_dwordx4 v13, s[8:11], s6 offen offset:1056 lds
buffer_load_dwordx4 v14, s[8:11], s6 offen offset:2112 lds
buffer_load_dwordx4 v15, s[8:11], s6 offen offset:3168 lds
buffer_load_dwordx4 v12, s[8:11], s6 offen offset:0 lds
s_lshl_b32 s6, s89, 19
s_add_u32 m0, s83, 94208
s_add_u32 s6, s6, s47
buffer_load_dwordx4 v17, s[20:23], s6 offen offset:1088 lds
buffer_load_dwordx4 v18, s[20:23], s6 offen offset:2176 lds
buffer_load_dwordx4 v19, s[20:23], s6 offen offset:3264 lds
buffer_load_dwordx4 v16, s[20:23], s6 offen offset:0 lds
s_waitcnt vmcnt(20)
s_barrier
s_add_u32 m0, s61, 111616
s_xor_b32 s6, s81, 32768
buffer_load_dwordx4 v21, s[12:15], s6 offen offset:1056 lds
buffer_load_dwordx4 v22, s[12:15], s6 offen offset:2112 lds
buffer_load_dwordx4 v23, s[12:15], s6 offen offset:3168 lds
buffer_load_dwordx4 v20, s[12:15], s6 offen offset:0 lds
s_waitcnt vmcnt(20)
s_barrier
s_add_u32 m0, s61, 129024
s_xor_b32 s6, s81, 32768
buffer_load_dwordx4 v33, s[12:15], s6 offen offset:1056 lds
buffer_load_dwordx4 v34, s[12:15], s6 offen offset:2112 lds
buffer_load_dwordx4 v35, s[12:15], s6 offen offset:3168 lds
buffer_load_dwordx4 v32, s[12:15], s6 offen offset:0 lds
s_waitcnt vmcnt(20)
s_barrier
s_lshl_b32 s6, s89, 19
s_add_u32 m0, s83, 7168
s_add_u32 s6, s6, s47
s_add_u32 s6, s6, 262144
buffer_load_dwordx4 v17, s[20:23], s6 offen offset:1088 lds
buffer_load_dwordx4 v18, s[20:23], s6 offen offset:2176 lds
buffer_load_dwordx4 v19, s[20:23], s6 offen offset:3264 lds
buffer_load_dwordx4 v16, s[20:23], s6 offen offset:0 lds
s_waitcnt vmcnt(20)
s_barrier
s_lshl_b32 s6, s90, 19
s_add_u32 m0, s83, 24576
s_add_u32 s6, s6, s47
buffer_load_dwordx4 v17, s[20:23], s6 offen offset:1088 lds
buffer_load_dwordx4 v18, s[20:23], s6 offen offset:2176 lds
buffer_load_dwordx4 v19, s[20:23], s6 offen offset:3264 lds
buffer_load_dwordx4 v16, s[20:23], s6 offen offset:0 lds
s_lshl_b32 s6, s90, 19
s_add_u32 m0, s83, 146432
s_add_u32 s6, s6, s47
s_add_u32 s6, s6, 262144
buffer_load_dwordx4 v17, s[20:23], s6 offen offset:1088 lds
buffer_load_dwordx4 v18, s[20:23], s6 offen offset:2176 lds
buffer_load_dwordx4 v19, s[20:23], s6 offen offset:3264 lds
buffer_load_dwordx4 v16, s[20:23], s6 offen offset:0 lds
s_waitcnt vmcnt(20)
s_barrier
s_add_u32 m0, s61, 41984
s_xor_b32 s6, s81, 0
buffer_load_dwordx4 v21, s[12:15], s6 offen offset:1056 lds
buffer_load_dwordx4 v22, s[12:15], s6 offen offset:2112 lds
buffer_load_dwordx4 v23, s[12:15], s6 offen offset:3168 lds
buffer_load_dwordx4 v20, s[12:15], s6 offen offset:0 lds
s_waitcnt vmcnt(12)
s_barrier
s_add_u32 m0, s61, 76800
s_xor_b32 s6, s81, 0
buffer_load_dwordx4 v33, s[12:15], s6 offen offset:1056 lds
buffer_load_dwordx4 v34, s[12:15], s6 offen offset:2112 lds
buffer_load_dwordx4 v35, s[12:15], s6 offen offset:3168 lds
buffer_load_dwordx4 v32, s[12:15], s6 offen offset:0 lds
s_waitcnt vmcnt(12)
s_barrier
s_waitcnt vmcnt(8)
s_barrier
s_add_u32 m0, s61, 59392
s_xor_b32 s6, s81, 98304
buffer_load_dwordx4 v21, s[12:15], s6 offen offset:1056 lds
buffer_load_dwordx4 v22, s[12:15], s6 offen offset:2112 lds
buffer_load_dwordx4 v23, s[12:15], s6 offen offset:3168 lds
buffer_load_dwordx4 v20, s[12:15], s6 offen offset:0 lds
s_waitcnt vmcnt(8)
s_barrier
s_waitcnt vmcnt(4)
s_barrier
s_add_u32 m0, s61, 24576
s_xor_b32 s6, s81, 98304
buffer_load_dwordx4 v33, s[12:15], s6 offen offset:1056 lds
buffer_load_dwordx4 v34, s[12:15], s6 offen offset:2112 lds
buffer_load_dwordx4 v35, s[12:15], s6 offen offset:3168 lds
buffer_load_dwordx4 v32, s[12:15], s6 offen offset:0 lds
s_barrier
s_add_u32 m0, s61, 146432
s_xor_b32 s6, s82, 0
buffer_load_dwordx4 v25, s[16:19], s6 offen offset:1056 lds
buffer_load_dwordx4 v26, s[16:19], s6 offen offset:2112 lds
buffer_load_dwordx4 v27, s[16:19], s6 offen offset:3168 lds
buffer_load_dwordx4 v24, s[16:19], s6 offen offset:0 lds
s_add_u32 m0, s61, 41984
s_xor_b32 s6, s82, 256
buffer_load_dwordx4 v25, s[16:19], s6 offen offset:1056 lds
buffer_load_dwordx4 v26, s[16:19], s6 offen offset:2112 lds
buffer_load_dwordx4 v27, s[16:19], s6 offen offset:3168 lds
buffer_load_dwordx4 v24, s[16:19], s6 offen offset:0 lds
s_barrier
s_add_u32 m0, s61, 7168
s_xor_b32 s6, s81, 65536
buffer_load_dwordx4 v21, s[12:15], s6 offen offset:1056 lds
buffer_load_dwordx4 v22, s[12:15], s6 offen offset:2112 lds
buffer_load_dwordx4 v23, s[12:15], s6 offen offset:3168 lds
buffer_load_dwordx4 v20, s[12:15], s6 offen offset:0 lds
s_add_u32 m0, s61, 76800
s_xor_b32 s6, s81, 65536
buffer_load_dwordx4 v33, s[12:15], s6 offen offset:1056 lds
buffer_load_dwordx4 v34, s[12:15], s6 offen offset:2112 lds
buffer_load_dwordx4 v35, s[12:15], s6 offen offset:3168 lds
buffer_load_dwordx4 v32, s[12:15], s6 offen offset:0 lds
s_waitcnt vmcnt(12)
s_barrier
s_add_u32 m0, s61, 94208
s_xor_b32 s6, s82, 32768
buffer_load_dwordx4 v25, s[16:19], s6 offen offset:1056 lds
buffer_load_dwordx4 v26, s[16:19], s6 offen offset:2112 lds
buffer_load_dwordx4 v27, s[16:19], s6 offen offset:3168 lds
buffer_load_dwordx4 v24, s[16:19], s6 offen offset:0 lds
s_add_u32 m0, s61, 111616
s_xor_b32 s6, s82, 33024
buffer_load_dwordx4 v25, s[16:19], s6 offen offset:1056 lds
buffer_load_dwordx4 v26, s[16:19], s6 offen offset:2112 lds
buffer_load_dwordx4 v27, s[16:19], s6 offen offset:3168 lds
buffer_load_dwordx4 v24, s[16:19], s6 offen offset:0 lds
s_waitcnt vmcnt(16)
s_barrier
s_add_u32 m0, s61, 129024
s_xor_b32 s6, s81, 163840
buffer_load_dwordx4 v21, s[12:15], s6 offen offset:1056 lds
buffer_load_dwordx4 v22, s[12:15], s6 offen offset:2112 lds
buffer_load_dwordx4 v23, s[12:15], s6 offen offset:3168 lds
buffer_load_dwordx4 v20, s[12:15], s6 offen offset:0 lds
s_waitcnt vmcnt(16)
s_barrier
s_add_u32 m0, s61, 146432
s_xor_b32 s6, s81, 163840
buffer_load_dwordx4 v33, s[12:15], s6 offen offset:1056 lds
buffer_load_dwordx4 v34, s[12:15], s6 offen offset:2112 lds
buffer_load_dwordx4 v35, s[12:15], s6 offen offset:3168 lds
buffer_load_dwordx4 v32, s[12:15], s6 offen offset:0 lds
s_waitcnt vmcnt(16)
s_barrier
s_add_u32 m0, s61, 41984
s_xor_b32 s6, s82, 65536
buffer_load_dwordx4 v25, s[16:19], s6 offen offset:1056 lds
buffer_load_dwordx4 v26, s[16:19], s6 offen offset:2112 lds
buffer_load_dwordx4 v27, s[16:19], s6 offen offset:3168 lds
buffer_load_dwordx4 v24, s[16:19], s6 offen offset:0 lds
s_waitcnt vmcnt(16)
s_barrier
s_add_u32 m0, s61, 7168
s_xor_b32 s6, s82, 65792
buffer_load_dwordx4 v25, s[16:19], s6 offen offset:1056 lds
buffer_load_dwordx4 v26, s[16:19], s6 offen offset:2112 lds
buffer_load_dwordx4 v27, s[16:19], s6 offen offset:3168 lds
buffer_load_dwordx4 v24, s[16:19], s6 offen offset:0 lds
s_waitcnt vmcnt(16)
s_barrier
s_add_u32 m0, s61, 76800
s_xor_b32 s6, s81, 131072
buffer_load_dwordx4 v21, s[12:15], s6 offen offset:1056 lds
buffer_load_dwordx4 v22, s[12:15], s6 offen offset:2112 lds
buffer_load_dwordx4 v23, s[12:15], s6 offen offset:3168 lds
buffer_load_dwordx4 v20, s[12:15], s6 offen offset:0 lds
s_barrier
s_add_u32 m0, s61, 94208
s_xor_b32 s6, s81, 131072
buffer_load_dwordx4 v33, s[12:15], s6 offen offset:1056 lds
buffer_load_dwordx4 v34, s[12:15], s6 offen offset:2112 lds
buffer_load_dwordx4 v35, s[12:15], s6 offen offset:3168 lds
buffer_load_dwordx4 v32, s[12:15], s6 offen offset:0 lds
s_barrier
s_add_u32 m0, s61, 111616
s_xor_b32 s6, s82, 98304
buffer_load_dwordx4 v25, s[16:19], s6 offen offset:1056 lds
buffer_load_dwordx4 v26, s[16:19], s6 offen offset:2112 lds
buffer_load_dwordx4 v27, s[16:19], s6 offen offset:3168 lds
buffer_load_dwordx4 v24, s[16:19], s6 offen offset:0 lds
s_waitcnt vmcnt(16)
s_barrier
s_add_u32 m0, s61, 59392
s_xor_b32 s6, s82, 98560
buffer_load_dwordx4 v25, s[16:19], s6 offen offset:1056 lds
buffer_load_dwordx4 v26, s[16:19], s6 offen offset:2112 lds
buffer_load_dwordx4 v27, s[16:19], s6 offen offset:3168 lds
buffer_load_dwordx4 v24, s[16:19], s6 offen offset:0 lds
s_waitcnt vmcnt(16)
s_barrier
s_add_u32 m0, s61, 24576
s_xor_b32 s6, s81, 229376
buffer_load_dwordx4 v21, s[12:15], s6 offen offset:1056 lds
buffer_load_dwordx4 v22, s[12:15], s6 offen offset:2112 lds
buffer_load_dwordx4 v23, s[12:15], s6 offen offset:3168 lds
buffer_load_dwordx4 v20, s[12:15], s6 offen offset:0 lds
s_waitcnt vmcnt(16)
s_barrier
s_add_u32 m0, s61, 41984
s_xor_b32 s6, s81, 229376
buffer_load_dwordx4 v33, s[12:15], s6 offen offset:1056 lds
buffer_load_dwordx4 v34, s[12:15], s6 offen offset:2112 lds
buffer_load_dwordx4 v35, s[12:15], s6 offen offset:3168 lds
buffer_load_dwordx4 v32, s[12:15], s6 offen offset:0 lds
s_waitcnt vmcnt(16)
s_barrier
s_add_u32 m0, s61, 7168
s_xor_b32 s6, s82, 131072
buffer_load_dwordx4 v25, s[16:19], s6 offen offset:1056 lds
buffer_load_dwordx4 v26, s[16:19], s6 offen offset:2112 lds
buffer_load_dwordx4 v27, s[16:19], s6 offen offset:3168 lds
buffer_load_dwordx4 v24, s[16:19], s6 offen offset:0 lds
s_waitcnt vmcnt(16)
s_barrier
s_add_u32 m0, s61, 76800
s_xor_b32 s6, s82, 131328
buffer_load_dwordx4 v25, s[16:19], s6 offen offset:1056 lds
buffer_load_dwordx4 v26, s[16:19], s6 offen offset:2112 lds
buffer_load_dwordx4 v27, s[16:19], s6 offen offset:3168 lds
buffer_load_dwordx4 v24, s[16:19], s6 offen offset:0 lds
s_waitcnt vmcnt(16)
s_barrier
s_add_u32 m0, s61, 94208
s_xor_b32 s6, s81, 196608
buffer_load_dwordx4 v21, s[12:15], s6 offen offset:1056 lds
buffer_load_dwordx4 v22, s[12:15], s6 offen offset:2112 lds
buffer_load_dwordx4 v23, s[12:15], s6 offen offset:3168 lds
buffer_load_dwordx4 v20, s[12:15], s6 offen offset:0 lds
s_barrier
s_add_u32 m0, s61, 111616
s_xor_b32 s6, s81, 196608
buffer_load_dwordx4 v33, s[12:15], s6 offen offset:1056 lds
buffer_load_dwordx4 v34, s[12:15], s6 offen offset:2112 lds
buffer_load_dwordx4 v35, s[12:15], s6 offen offset:3168 lds
buffer_load_dwordx4 v32, s[12:15], s6 offen offset:0 lds
s_barrier
s_add_u32 m0, s61, 59392
s_xor_b32 s6, s82, 163840
buffer_load_dwordx4 v25, s[16:19], s6 offen offset:1056 lds
buffer_load_dwordx4 v26, s[16:19], s6 offen offset:2112 lds
buffer_load_dwordx4 v27, s[16:19], s6 offen offset:3168 lds
buffer_load_dwordx4 v24, s[16:19], s6 offen offset:0 lds
s_waitcnt vmcnt(16)
s_barrier
s_add_u32 m0, s61, 129024
s_xor_b32 s6, s82, 164096
buffer_load_dwordx4 v25, s[16:19], s6 offen offset:1056 lds
buffer_load_dwordx4 v26, s[16:19], s6 offen offset:2112 lds
buffer_load_dwordx4 v27, s[16:19], s6 offen offset:3168 lds
buffer_load_dwordx4 v24, s[16:19], s6 offen offset:0 lds
s_waitcnt vmcnt(16)
s_barrier
s_add_u32 m0, s61, 146432
s_xor_b32 s6, s81, 294912
buffer_load_dwordx4 v21, s[12:15], s6 offen offset:1056 lds
buffer_load_dwordx4 v22, s[12:15], s6 offen offset:2112 lds
buffer_load_dwordx4 v23, s[12:15], s6 offen offset:3168 lds
buffer_load_dwordx4 v20, s[12:15], s6 offen offset:0 lds
s_waitcnt vmcnt(16)
s_barrier
s_add_u32 m0, s61, 7168
s_xor_b32 s6, s81, 294912
buffer_load_dwordx4 v33, s[12:15], s6 offen offset:1056 lds
buffer_load_dwordx4 v34, s[12:15], s6 offen offset:2112 lds
buffer_load_dwordx4 v35, s[12:15], s6 offen offset:3168 lds
buffer_load_dwordx4 v32, s[12:15], s6 offen offset:0 lds
s_waitcnt vmcnt(16)
s_barrier
s_add_u32 m0, s61, 76800
s_xor_b32 s6, s82, 196608
buffer_load_dwordx4 v25, s[16:19], s6 offen offset:1056 lds
buffer_load_dwordx4 v26, s[16:19], s6 offen offset:2112 lds
buffer_load_dwordx4 v27, s[16:19], s6 offen offset:3168 lds
buffer_load_dwordx4 v24, s[16:19], s6 offen offset:0 lds
s_waitcnt vmcnt(16)
s_barrier
s_add_u32 m0, s61, 94208
s_xor_b32 s6, s82, 196864
buffer_load_dwordx4 v25, s[16:19], s6 offen offset:1056 lds
buffer_load_dwordx4 v26, s[16:19], s6 offen offset:2112 lds
buffer_load_dwordx4 v27, s[16:19], s6 offen offset:3168 lds
buffer_load_dwordx4 v24, s[16:19], s6 offen offset:0 lds
s_waitcnt vmcnt(16)
s_barrier
s_add_u32 m0, s61, 111616
s_xor_b32 s6, s81, 262144
buffer_load_dwordx4 v21, s[12:15], s6 offen offset:1056 lds
buffer_load_dwordx4 v22, s[12:15], s6 offen offset:2112 lds
buffer_load_dwordx4 v23, s[12:15], s6 offen offset:3168 lds
buffer_load_dwordx4 v20, s[12:15], s6 offen offset:0 lds
s_barrier
s_add_u32 m0, s61, 59392
s_xor_b32 s6, s81, 262144
buffer_load_dwordx4 v33, s[12:15], s6 offen offset:1056 lds
buffer_load_dwordx4 v34, s[12:15], s6 offen offset:2112 lds
buffer_load_dwordx4 v35, s[12:15], s6 offen offset:3168 lds
buffer_load_dwordx4 v32, s[12:15], s6 offen offset:0 lds
s_barrier
s_add_u32 m0, s61, 129024
s_xor_b32 s6, s82, 229376
buffer_load_dwordx4 v25, s[16:19], s6 offen offset:1056 lds
buffer_load_dwordx4 v26, s[16:19], s6 offen offset:2112 lds
buffer_load_dwordx4 v27, s[16:19], s6 offen offset:3168 lds
buffer_load_dwordx4 v24, s[16:19], s6 offen offset:0 lds
s_waitcnt vmcnt(16)
s_barrier
s_add_u32 m0, s61, 24576
s_xor_b32 s6, s82, 229632
buffer_load_dwordx4 v25, s[16:19], s6 offen offset:1056 lds
buffer_load_dwordx4 v26, s[16:19], s6 offen offset:2112 lds
buffer_load_dwordx4 v27, s[16:19], s6 offen offset:3168 lds
buffer_load_dwordx4 v24, s[16:19], s6 offen offset:0 lds
s_waitcnt vmcnt(16)
s_barrier
s_add_u32 m0, s61, 41984
s_xor_b32 s6, s81, 360448
buffer_load_dwordx4 v21, s[12:15], s6 offen offset:1056 lds
buffer_load_dwordx4 v22, s[12:15], s6 offen offset:2112 lds
buffer_load_dwordx4 v23, s[12:15], s6 offen offset:3168 lds
buffer_load_dwordx4 v20, s[12:15], s6 offen offset:0 lds
s_waitcnt vmcnt(16)
s_barrier
s_add_u32 m0, s61, 76800
s_xor_b32 s6, s81, 360448
buffer_load_dwordx4 v33, s[12:15], s6 offen offset:1056 lds
buffer_load_dwordx4 v34, s[12:15], s6 offen offset:2112 lds
buffer_load_dwordx4 v35, s[12:15], s6 offen offset:3168 lds
buffer_load_dwordx4 v32, s[12:15], s6 offen offset:0 lds
s_waitcnt vmcnt(16)
s_barrier
s_add_u32 m0, s61, 94208
s_xor_b32 s6, s82, 262144
buffer_load_dwordx4 v25, s[16:19], s6 offen offset:1056 lds
buffer_load_dwordx4 v26, s[16:19], s6 offen offset:2112 lds
buffer_load_dwordx4 v27, s[16:19], s6 offen offset:3168 lds
buffer_load_dwordx4 v24, s[16:19], s6 offen offset:0 lds
s_waitcnt vmcnt(16)
s_barrier
s_add_u32 m0, s61, 111616
s_xor_b32 s6, s82, 262400
buffer_load_dwordx4 v25, s[16:19], s6 offen offset:1056 lds
buffer_load_dwordx4 v26, s[16:19], s6 offen offset:2112 lds
buffer_load_dwordx4 v27, s[16:19], s6 offen offset:3168 lds
buffer_load_dwordx4 v24, s[16:19], s6 offen offset:0 lds
s_waitcnt vmcnt(16)
s_barrier
s_add_u32 m0, s61, 59392
s_xor_b32 s6, s81, 327680
buffer_load_dwordx4 v21, s[12:15], s6 offen offset:1056 lds
buffer_load_dwordx4 v22, s[12:15], s6 offen offset:2112 lds
buffer_load_dwordx4 v23, s[12:15], s6 offen offset:3168 lds
buffer_load_dwordx4 v20, s[12:15], s6 offen offset:0 lds
s_barrier
s_add_u32 m0, s61, 129024
s_xor_b32 s6, s81, 327680
buffer_load_dwordx4 v33, s[12:15], s6 offen offset:1056 lds
buffer_load_dwordx4 v34, s[12:15], s6 offen offset:2112 lds
buffer_load_dwordx4 v35, s[12:15], s6 offen offset:3168 lds
buffer_load_dwordx4 v32, s[12:15], s6 offen offset:0 lds
s_barrier
s_add_u32 m0, s61, 24576
s_xor_b32 s6, s82, 294912
buffer_load_dwordx4 v25, s[16:19], s6 offen offset:1056 lds
buffer_load_dwordx4 v26, s[16:19], s6 offen offset:2112 lds
buffer_load_dwordx4 v27, s[16:19], s6 offen offset:3168 lds
buffer_load_dwordx4 v24, s[16:19], s6 offen offset:0 lds
s_waitcnt vmcnt(16)
s_barrier
s_add_u32 m0, s61, 146432
s_xor_b32 s6, s82, 295168
buffer_load_dwordx4 v25, s[16:19], s6 offen offset:1056 lds
buffer_load_dwordx4 v26, s[16:19], s6 offen offset:2112 lds
buffer_load_dwordx4 v27, s[16:19], s6 offen offset:3168 lds
buffer_load_dwordx4 v24, s[16:19], s6 offen offset:0 lds
s_waitcnt vmcnt(16)
s_barrier
buffer_load_dword v11, v10, s[24:27], s76 offen
v_mov_b32 v50, 0
global_load_dword v48, v50, s[0:1] sc1
global_load_dword v11, v45, s[72:73]
s_add_u32 m0, s61, 7168
s_xor_b32 s6, s81, 425984
buffer_load_dwordx4 v21, s[12:15], s6 offen offset:1056 lds
buffer_load_dwordx4 v22, s[12:15], s6 offen offset:2112 lds
buffer_load_dwordx4 v23, s[12:15], s6 offen offset:3168 lds
buffer_load_dwordx4 v20, s[12:15], s6 offen offset:0 lds
s_waitcnt vmcnt(19)
s_barrier
s_add_u32 m0, s61, 94208
s_xor_b32 s6, s81, 425984
buffer_load_dwordx4 v33, s[12:15], s6 offen offset:1056 lds
buffer_load_dwordx4 v34, s[12:15], s6 offen offset:2112 lds
buffer_load_dwordx4 v35, s[12:15], s6 offen offset:3168 lds
buffer_load_dwordx4 v32, s[12:15], s6 offen offset:0 lds
s_waitcnt vmcnt(19)
s_barrier
s_add_u32 m0, s61, 111616
s_xor_b32 s6, s82, 327680
buffer_load_dwordx4 v25, s[16:19], s6 offen offset:1056 lds
buffer_load_dwordx4 v26, s[16:19], s6 offen offset:2112 lds
buffer_load_dwordx4 v27, s[16:19], s6 offen offset:3168 lds
buffer_load_dwordx4 v24, s[16:19], s6 offen offset:0 lds
s_waitcnt vmcnt(19)
s_barrier
s_add_u32 m0, s61, 59392
s_xor_b32 s6, s82, 327936
buffer_load_dwordx4 v25, s[16:19], s6 offen offset:1056 lds
buffer_load_dwordx4 v26, s[16:19], s6 offen offset:2112 lds
buffer_load_dwordx4 v27, s[16:19], s6 offen offset:3168 lds
buffer_load_dwordx4 v24, s[16:19], s6 offen offset:0 lds
s_waitcnt vmcnt(19)
s_barrier
s_add_u32 m0, s61, 129024
s_xor_b32 s6, s81, 393216
buffer_load_dwordx4 v21, s[12:15], s6 offen offset:1056 lds
buffer_load_dwordx4 v22, s[12:15], s6 offen offset:2112 lds
buffer_load_dwordx4 v23, s[12:15], s6 offen offset:3168 lds
buffer_load_dwordx4 v20, s[12:15], s6 offen offset:0 lds
s_barrier
s_add_u32 m0, s61, 24576
s_xor_b32 s6, s81, 393216
buffer_load_dwordx4 v33, s[12:15], s6 offen offset:1056 lds
buffer_load_dwordx4 v34, s[12:15], s6 offen offset:2112 lds
buffer_load_dwordx4 v35, s[12:15], s6 offen offset:3168 lds
buffer_load_dwordx4 v32, s[12:15], s6 offen offset:0 lds
s_barrier
s_add_u32 m0, s61, 146432
s_xor_b32 s6, s82, 360448
buffer_load_dwordx4 v25, s[16:19], s6 offen offset:1056 lds
buffer_load_dwordx4 v26, s[16:19], s6 offen offset:2112 lds
buffer_load_dwordx4 v27, s[16:19], s6 offen offset:3168 lds
buffer_load_dwordx4 v24, s[16:19], s6 offen offset:0 lds
s_waitcnt vmcnt(16)
s_barrier
s_add_u32 m0, s61, 41984
s_xor_b32 s6, s82, 360704
buffer_load_dwordx4 v25, s[16:19], s6 offen offset:1056 lds
buffer_load_dwordx4 v26, s[16:19], s6 offen offset:2112 lds
buffer_load_dwordx4 v27, s[16:19], s6 offen offset:3168 lds
buffer_load_dwordx4 v24, s[16:19], s6 offen offset:0 lds
s_waitcnt vmcnt(16)
s_barrier
s_add_u32 m0, s61, 76800
s_xor_b32 s6, s81, 491520
buffer_load_dwordx4 v21, s[12:15], s6 offen offset:1056 lds
buffer_load_dwordx4 v22, s[12:15], s6 offen offset:2112 lds
buffer_load_dwordx4 v23, s[12:15], s6 offen offset:3168 lds
buffer_load_dwordx4 v20, s[12:15], s6 offen offset:0 lds
s_waitcnt vmcnt(16)
s_barrier
s_add_u32 m0, s61, 111616
s_xor_b32 s6, s81, 491520
buffer_load_dwordx4 v33, s[12:15], s6 offen offset:1056 lds
buffer_load_dwordx4 v34, s[12:15], s6 offen offset:2112 lds
buffer_load_dwordx4 v35, s[12:15], s6 offen offset:3168 lds
buffer_load_dwordx4 v32, s[12:15], s6 offen offset:0 lds
s_waitcnt vmcnt(16)
s_barrier
s_add_u32 m0, s61, 59392
s_xor_b32 s6, s82, 393216
buffer_load_dwordx4 v25, s[16:19], s6 offen offset:1056 lds
buffer_load_dwordx4 v26, s[16:19], s6 offen offset:2112 lds
buffer_load_dwordx4 v27, s[16:19], s6 offen offset:3168 lds
buffer_load_dwordx4 v24, s[16:19], s6 offen offset:0 lds
s_waitcnt vmcnt(16)
s_barrier
s_add_u32 m0, s61, 129024
s_xor_b32 s6, s82, 393472
buffer_load_dwordx4 v25, s[16:19], s6 offen offset:1056 lds
buffer_load_dwordx4 v26, s[16:19], s6 offen offset:2112 lds
buffer_load_dwordx4 v27, s[16:19], s6 offen offset:3168 lds
buffer_load_dwordx4 v24, s[16:19], s6 offen offset:0 lds
s_waitcnt vmcnt(16)
s_barrier
s_add_u32 m0, s61, 24576
s_xor_b32 s6, s81, 458752
buffer_load_dwordx4 v21, s[12:15], s6 offen offset:1056 lds
buffer_load_dwordx4 v22, s[12:15], s6 offen offset:2112 lds
buffer_load_dwordx4 v23, s[12:15], s6 offen offset:3168 lds
buffer_load_dwordx4 v20, s[12:15], s6 offen offset:0 lds
s_barrier
s_add_u32 m0, s61, 146432
s_xor_b32 s6, s81, 458752
buffer_load_dwordx4 v33, s[12:15], s6 offen offset:1056 lds
buffer_load_dwordx4 v34, s[12:15], s6 offen offset:2112 lds
buffer_load_dwordx4 v35, s[12:15], s6 offen offset:3168 lds
buffer_load_dwordx4 v32, s[12:15], s6 offen offset:0 lds
s_barrier
s_add_u32 m0, s61, 41984
s_xor_b32 s6, s82, 425984
buffer_load_dwordx4 v25, s[16:19], s6 offen offset:1056 lds
buffer_load_dwordx4 v26, s[16:19], s6 offen offset:2112 lds
buffer_load_dwordx4 v27, s[16:19], s6 offen offset:3168 lds
buffer_load_dwordx4 v24, s[16:19], s6 offen offset:0 lds
s_waitcnt vmcnt(16)
s_barrier
s_add_u32 m0, s61, 7168
s_xor_b32 s6, s82, 426240
buffer_load_dwordx4 v25, s[16:19], s6 offen offset:1056 lds
buffer_load_dwordx4 v26, s[16:19], s6 offen offset:2112 lds
buffer_load_dwordx4 v27, s[16:19], s6 offen offset:3168 lds
buffer_load_dwordx4 v24, s[16:19], s6 offen offset:0 lds
s_waitcnt vmcnt(16)
s_barrier
s_add_u32 m0, s61, 94208
s_xor_b32 s6, s82, 458752
buffer_load_dwordx4 v25, s[16:19], s6 offen offset:1056 lds
buffer_load_dwordx4 v26, s[16:19], s6 offen offset:2112 lds
buffer_load_dwordx4 v27, s[16:19], s6 offen offset:3168 lds
buffer_load_dwordx4 v24, s[16:19], s6 offen offset:0 lds
s_waitcnt vmcnt(16)
s_barrier
s_add_u32 m0, s61, 59392
s_xor_b32 s6, s82, 459008
buffer_load_dwordx4 v25, s[16:19], s6 offen offset:1056 lds
buffer_load_dwordx4 v26, s[16:19], s6 offen offset:2112 lds
buffer_load_dwordx4 v27, s[16:19], s6 offen offset:3168 lds
buffer_load_dwordx4 v24, s[16:19], s6 offen offset:0 lds
s_waitcnt vmcnt(16)
s_barrier
s_add_u32 m0, s61, 129024
s_xor_b32 s6, s82, 491520
buffer_load_dwordx4 v25, s[16:19], s6 offen offset:1056 lds
buffer_load_dwordx4 v26, s[16:19], s6 offen offset:2112 lds
buffer_load_dwordx4 v27, s[16:19], s6 offen offset:3168 lds
buffer_load_dwordx4 v24, s[16:19], s6 offen offset:0 lds
s_waitcnt vmcnt(16)
s_barrier
s_add_u32 m0, s61, 24576
s_xor_b32 s6, s82, 491776
buffer_load_dwordx4 v25, s[16:19], s6 offen offset:1056 lds
buffer_load_dwordx4 v26, s[16:19], s6 offen offset:2112 lds
buffer_load_dwordx4 v27, s[16:19], s6 offen offset:3168 lds
buffer_load_dwordx4 v24, s[16:19], s6 offen offset:0 lds
s_waitcnt vmcnt(16)
s_barrier
s_mov_b32 s84, s44
s_add_u32 s85, s84, 1
s_cmp_eq_u32 s85, 7
s_cselect_b32 s85, 0, s85
s_add_u32 s86, s85, 1
s_cmp_eq_u32 s86, 7
s_cselect_b32 s86, 0, s86
s_add_u32 s87, s86, 1
s_cmp_eq_u32 s87, 7
s_cselect_b32 s87, 0, s87
s_add_u32 s88, s87, 1
s_cmp_eq_u32 s88, 7
s_cselect_b32 s88, 0, s88
s_add_u32 s89, s88, 1
s_cmp_eq_u32 s89, 7
s_cselect_b32 s89, 0, s89
s_add_u32 s90, s89, 1
s_cmp_eq_u32 s90, 7
s_cselect_b32 s90, 0, s90
s_lshl_b32 s6, s84, 7
s_add_u32 m0, s61, 146432
s_add_u32 s6, s6, s60
buffer_load_dwordx4 v29, s[24:27], s6 offen offset:1056 lds
buffer_load_dwordx4 v30, s[24:27], s6 offen offset:2112 lds
buffer_load_dwordx4 v31, s[24:27], s6 offen offset:3168 lds
buffer_load_dwordx4 v28, s[24:27], s6 offen offset:0 lds
s_barrier
s_lshl_b32 s6, s84, 7
s_add_u32 m0, s61, 41984
s_add_u32 s6, s6, s60
s_add_u32 s6, s6, 114688
buffer_load_dwordx4 v29, s[24:27], s6 offen offset:1056 lds
buffer_load_dwordx4 v30, s[24:27], s6 offen offset:2112 lds
buffer_load_dwordx4 v31, s[24:27], s6 offen offset:3168 lds
buffer_load_dwordx4 v28, s[24:27], s6 offen offset:0 lds
s_barrier
s_lshl_b32 s6, s85, 7
s_add_u32 m0, s61, 7168
s_add_u32 s6, s6, s60
buffer_load_dwordx4 v29, s[24:27], s6 offen offset:1056 lds
buffer_load_dwordx4 v30, s[24:27], s6 offen offset:2112 lds
buffer_load_dwordx4 v31, s[24:27], s6 offen offset:3168 lds
buffer_load_dwordx4 v28, s[24:27], s6 offen offset:0 lds
s_waitcnt vmcnt(24)
s_barrier
s_lshl_b32 s6, s85, 7
s_add_u32 m0, s61, 76800
s_add_u32 s6, s6, s60
s_add_u32 s6, s6, 114688
buffer_load_dwordx4 v29, s[24:27], s6 offen offset:1056 lds
buffer_load_dwordx4 v30, s[24:27], s6 offen offset:2112 lds
buffer_load_dwordx4 v31, s[24:27], s6 offen offset:3168 lds
buffer_load_dwordx4 v28, s[24:27], s6 offen offset:0 lds
s_waitcnt vmcnt(24)
s_barrier
s_lshl_b32 s6, s86, 7
s_add_u32 m0, s61, 111616
s_add_u32 s6, s6, s60
buffer_load_dwordx4 v29, s[24:27], s6 offen offset:1056 lds
buffer_load_dwordx4 v30, s[24:27], s6 offen offset:2112 lds
buffer_load_dwordx4 v31, s[24:27], s6 offen offset:3168 lds
buffer_load_dwordx4 v28, s[24:27], s6 offen offset:0 lds
s_waitcnt vmcnt(24)
s_barrier
s_waitcnt vmcnt(20)
s_barrier
s_waitcnt vmcnt(12)
s_barrier
s_barrier
s_lshl_b32 s6, s86, 7
s_add_u32 m0, s61, 24576
s_add_u32 s6, s6, s60
s_add_u32 s6, s6, 114688
buffer_load_dwordx4 v29, s[24:27], s6 offen offset:1056 lds
buffer_load_dwordx4 v30, s[24:27], s6 offen offset:2112 lds
buffer_load_dwordx4 v31, s[24:27], s6 offen offset:3168 lds
buffer_load_dwordx4 v28, s[24:27], s6 offen offset:0 lds
s_waitcnt vmcnt(8)
s_barrier
s_lshl_b32 s6, s87, 7
s_add_u32 m0, s61, 129024
s_add_u32 s6, s6, s60
buffer_load_dwordx4 v29, s[24:27], s6 offen offset:1056 lds
buffer_load_dwordx4 v30, s[24:27], s6 offen offset:2112 lds
buffer_load_dwordx4 v31, s[24:27], s6 offen offset:3168 lds
buffer_load_dwordx4 v28, s[24:27], s6 offen offset:0 lds
s_barrier
s_lshl_b32 s6, s87, 7
s_add_u32 m0, s61, 59392
s_add_u32 s6, s6, s60
s_add_u32 s6, s6, 114688
buffer_load_dwordx4 v29, s[24:27], s6 offen offset:1056 lds
buffer_load_dwordx4 v30, s[24:27], s6 offen offset:2112 lds
buffer_load_dwordx4 v31, s[24:27], s6 offen offset:3168 lds
buffer_load_dwordx4 v28, s[24:27], s6 offen offset:0 lds
s_waitcnt vmcnt(8)
s_barrier
s_lshl_b32 s6, s88, 7
s_add_u32 m0, s61, 94208
s_add_u32 s6, s6, s60
buffer_load_dwordx4 v29, s[24:27], s6 offen offset:1056 lds
buffer_load_dwordx4 v30, s[24:27], s6 offen offset:2112 lds
buffer_load_dwordx4 v31, s[24:27], s6 offen offset:3168 lds
buffer_load_dwordx4 v28, s[24:27], s6 offen offset:0 lds
s_barrier
s_lshl_b32 s6, s88, 7
s_add_u32 m0, s61, 41984
s_add_u32 s6, s6, s60
s_add_u32 s6, s6, 114688
buffer_load_dwordx4 v29, s[24:27], s6 offen offset:1056 lds
buffer_load_dwordx4 v30, s[24:27], s6 offen offset:2112 lds
buffer_load_dwordx4 v31, s[24:27], s6 offen offset:3168 lds
buffer_load_dwordx4 v28, s[24:27], s6 offen offset:0 lds
s_waitcnt vmcnt(8)
s_barrier
s_lshl_b32 s6, s89, 7
s_add_u32 m0, s61, 146432
s_add_u32 s6, s6, s60
buffer_load_dwordx4 v29, s[24:27], s6 offen offset:1056 lds
buffer_load_dwordx4 v30, s[24:27], s6 offen offset:2112 lds
buffer_load_dwordx4 v31, s[24:27], s6 offen offset:3168 lds
buffer_load_dwordx4 v28, s[24:27], s6 offen offset:0 lds
s_barrier
s_lshl_b32 s6, s89, 7
s_add_u32 m0, s61, 7168
s_add_u32 s6, s6, s60
s_add_u32 s6, s6, 114688
buffer_load_dwordx4 v29, s[24:27], s6 offen offset:1056 lds
buffer_load_dwordx4 v30, s[24:27], s6 offen offset:2112 lds
buffer_load_dwordx4 v31, s[24:27], s6 offen offset:3168 lds
buffer_load_dwordx4 v28, s[24:27], s6 offen offset:0 lds
s_waitcnt vmcnt(8)
s_barrier
s_lshl_b32 s6, s90, 7
s_add_u32 m0, s61, 76800
s_add_u32 s6, s6, s60
buffer_load_dwordx4 v29, s[24:27], s6 offen offset:1056 lds
buffer_load_dwordx4 v30, s[24:27], s6 offen offset:2112 lds
buffer_load_dwordx4 v31, s[24:27], s6 offen offset:3168 lds
buffer_load_dwordx4 v28, s[24:27], s6 offen offset:0 lds
s_barrier
s_lshl_b32 s6, s90, 7
s_add_u32 m0, s61, 24576
s_add_u32 s6, s6, s60
s_add_u32 s6, s6, 114688
buffer_load_dwordx4 v29, s[24:27], s6 offen offset:1056 lds
buffer_load_dwordx4 v30, s[24:27], s6 offen offset:2112 lds
buffer_load_dwordx4 v31, s[24:27], s6 offen offset:3168 lds
buffer_load_dwordx4 v28, s[24:27], s6 offen offset:0 lds
s_waitcnt vmcnt(8)
s_barrier
s_barrier
s_waitcnt vmcnt(0)
s_barrier
s_barrier
s_mov_b32 s62, s45
s_branch L_reduce
L_ld2:
s_lshl_b32 s6, s85, 19
s_add_u32 m0, s83, 94208
s_add_u32 s6, s6, s47
s_add_u32 s6, s6, 262144
buffer_load_dwordx4 v18, s[20:23], s6 offen offset:2176 lds
buffer_load_dwordx4 v19, s[20:23], s6 offen offset:3264 lds
buffer_load_dwordx4 v16, s[20:23], s6 offen offset:0 lds
buffer_load_dwordx4 v17, s[20:23], s6 offen offset:1088 lds
s_waitcnt vmcnt(13)
s_barrier
s_lshl_b32 s6, s86, 19
s_add_u32 m0, s83, 111616
s_add_u32 s6, s6, s47
buffer_load_dwordx4 v18, s[20:23], s6 offen offset:2176 lds
buffer_load_dwordx4 v19, s[20:23], s6 offen offset:3264 lds
buffer_load_dwordx4 v16, s[20:23], s6 offen offset:0 lds
buffer_load_dwordx4 v17, s[20:23], s6 offen offset:1088 lds
s_lshl_b32 s6, s86, 19
s_add_u32 m0, s83, 129024
s_add_u32 s6, s6, s47
s_add_u32 s6, s6, 262144
buffer_load_dwordx4 v18, s[20:23], s6 offen offset:2176 lds
buffer_load_dwordx4 v19, s[20:23], s6 offen offset:3264 lds
buffer_load_dwordx4 v16, s[20:23], s6 offen offset:0 lds
buffer_load_dwordx4 v17, s[20:23], s6 offen offset:1088 lds
s_waitcnt vmcnt(13)
s_barrier
s_cmp_ge_u32 s45, 2
s_cselect_b32 s6, s89, s88
s_lshl_b32 s6, s6, 7
s_add_u32 m0, s61, 146432
s_add_u32 s6, s6, s46
buffer_load_dwordx4 v14, s[8:11], s6 offen offset:2112 lds
buffer_load_dwordx4 v15, s[8:11], s6 offen offset:3168 lds
buffer_load_dwordx4 v12, s[8:11], s6 offen offset:0 lds
buffer_load_dwordx4 v13, s[8:11], s6 offen offset:1056 lds
s_lshl_b32 s6, s87, 19
s_add_u32 m0, s83, 7168
s_add_u32 s6, s6, s47
buffer_load_dwordx4 v18, s[20:23], s6 offen offset:2176 lds
buffer_load_dwordx4 v19, s[20:23], s6 offen offset:3264 lds
buffer_load_dwordx4 v16, s[20:23], s6 offen offset:0 lds
buffer_load_dwordx4 v17, s[20:23], s6 offen offset:1088 lds
s_waitcnt vmcnt(16)
s_barrier
s_lshl_b32 s6, s87, 19
s_add_u32 m0, s83, 24576
s_add_u32 s6, s6, s47
s_add_u32 s6, s6, 262144
buffer_load_dwordx4 v18, s[20:23], s6 offen offset:2176 lds
buffer_load_dwordx4 v19, s[20:23], s6 offen offset:3264 lds
buffer_load_dwordx4 v16, s[20:23], s6 offen offset:0 lds
buffer_load_dwordx4 v17, s[20:23], s6 offen offset:1088 lds
s_lshl_b32 s6, s88, 19
s_add_u32 m0, s83, 41984
s_add_u32 s6, s6, s47
buffer_load_dwordx4 v18, s[20:23], s6 offen offset:2176 lds
buffer_load_dwordx4 v19, s[20:23], s6 offen offset:3264 lds
buffer_load_dwordx4 v16, s[20:23], s6 offen offset:0 lds
buffer_load_dwordx4 v17, s[20:23], s6 offen offset:1088 lds
s_waitcnt vmcnt(20)
s_barrier
s_lshl_b32 s6, s88, 19
s_add_u32 m0, s83, 76800
s_add_u32 s6, s6, s47
s_add_u32 s6, s6, 262144
buffer_load_dwordx4 v18, s[20:23], s6 offen offset:2176 lds
buffer_load_dwordx4 v19, s[20:23], s6 offen offset:3264 lds
buffer_load_dwordx4 v16, s[20:23], s6 offen offset:0 lds
buffer_load_dwordx4 v17, s[20:23], s6 offen offset:1088 lds
s_waitcnt vmcnt(20)
s_barrier
s_cmp_ge_u32 s45, 2
s_cselect_b32 s6, s91, s90
s_lshl_b32 s6, s6, 7
s_add_u32 m0, s61, 59392
s_add_u32 s6, s6, s46
buffer_load_dwordx4 v14, s[8:11], s6 offen offset:2112 lds
buffer_load_dwordx4 v15, s[8:11], s6 offen offset:3168 lds
buffer_load_dwordx4 v12, s[8:11], s6 offen offset:0 lds
buffer_load_dwordx4 v13, s[8:11], s6 offen offset:1056 lds
s_lshl_b32 s6, s89, 19
s_add_u32 m0, s83, 94208
s_add_u32 s6, s6, s47
buffer_load_dwordx4 v18, s[20:23], s6 offen offset:2176 lds
buffer_load_dwordx4 v19, s[20:23], s6 offen offset:3264 lds
buffer_load_dwordx4 v16, s[20:23], s6 offen offset:0 lds
buffer_load_dwordx4 v17, s[20:23], s6 offen offset:1088 lds
s_waitcnt vmcnt(20)
s_barrier
s_lshl_b32 s6, s89, 19
s_add_u32 m0, s83, 111616
s_add_u32 s6, s6, s47
s_add_u32 s6, s6, 262144
buffer_load_dwordx4 v18, s[20:23], s6 offen offset:2176 lds
buffer_load_dwordx4 v19, s[20:23], s6 offen offset:3264 lds
buffer_load_dwordx4 v16, s[20:23], s6 offen offset:0 lds
buffer_load_dwordx4 v17, s[20:23], s6 offen offset:1088 lds
s_waitcnt vmcnt(20)
s_barrier
s_add_u32 m0, s61, 129024
s_xor_b32 s6, s82, 0
buffer_load_dwordx4 v26, s[16:19], s6 offen offset:2112 lds
buffer_load_dwordx4 v27, s[16:19], s6 offen offset:3168 lds
buffer_load_dwordx4 v24, s[16:19], s6 offen offset:0 lds
buffer_load_dwordx4 v25, s[16:19], s6 offen offset:1056 lds
s_waitcnt vmcnt(20)
s_barrier
s_add_u32 m0, s61, 7168
s_xor_b32 s6, s82, 256
buffer_load_dwordx4 v26, s[16:19], s6 offen offset:2112 lds
buffer_load_dwordx4 v27, s[16:19], s6 offen offset:3168 lds
buffer_load_dwordx4 v24, s[16:19], s6 offen offset:0 lds
buffer_load_dwordx4 v25, s[16:19], s6 offen offset:1056 lds
s_waitcnt vmcnt(20)
s_barrier
s_lshl_b32 s6, s90, 19
s_add_u32 m0, s83, 24576
s_add_u32 s6, s6, s47
buffer_load_dwordx4 v18, s[20:23], s6 offen offset:2176 lds
buffer_load_dwordx4 v19, s[20:23], s6 offen offset:3264 lds
buffer_load_dwordx4 v16, s[20:23], s6 offen offset:0 lds
buffer_load_dwordx4 v17, s[20:23], s6 offen offset:1088 lds
s_lshl_b32 s6, s90, 19
s_add_u32 m0, s83, 146432
s_add_u32 s6, s6, s47
s_add_u32 s6, s6, 262144
buffer_load_dwordx4 v18, s[20:23], s6 offen offset:2176 lds
buffer_load_dwordx4 v19, s[20:23], s6 offen offset:3264 lds
buffer_load_dwordx4 v16, s[20:23], s6 offen offset:0 lds
buffer_load_dwordx4 v17, s[20:23], s6 offen offset:1088 lds
s_waitcnt vmcnt(20)
s_barrier
s_add_u32 m0, s61, 41984
s_xor_b32 s6, s81, 0
buffer_load_dwordx4 v22, s[12:15], s6 offen offset:2112 lds
buffer_load_dwordx4 v23, s[12:15], s6 offen offset:3168 lds
buffer_load_dwordx4 v20, s[12:15], s6 offen offset:0 lds
buffer_load_dwordx4 v21, s[12:15], s6 offen offset:1056 lds
s_waitcnt vmcnt(20)
s_barrier
s_add_u32 m0, s61, 76800
s_xor_b32 s6, s81, 0
buffer_load_dwordx4 v34, s[12:15], s6 offen offset:2112 lds
buffer_load_dwordx4 v35, s[12:15], s6 offen offset:3168 lds
buffer_load_dwordx4 v32, s[12:15], s6 offen offset:0 lds
buffer_load_dwordx4 v33, s[12:15], s6 offen offset:1056 lds
s_waitcnt vmcnt(12)
s_barrier
s_waitcnt vmcnt(8)
s_barrier
s_add_u32 m0, s61, 111616
s_xor_b32 s6, s81, 32768
buffer_load_dwordx4 v22, s[12:15], s6 offen offset:2112 lds
buffer_load_dwordx4 v23, s[12:15], s6 offen offset:3168 lds
buffer_load_dwordx4 v20, s[12:15], s6 offen offset:0 lds
buffer_load_dwordx4 v21, s[12:15], s6 offen offset:1056 lds
s_waitcnt vmcnt(8)
s_barrier
s_waitcnt vmcnt(4)
s_barrier
s_add_u32 m0, s61, 24576
s_xor_b32 s6, s81, 32768
buffer_load_dwordx4 v34, s[12:15], s6 offen offset:2112 lds
buffer_load_dwordx4 v35, s[12:15], s6 offen offset:3168 lds
buffer_load_dwordx4 v32, s[12:15], s6 offen offset:0 lds
buffer_load_dwordx4 v33, s[12:15], s6 offen offset:1056 lds
s_add_u32 m0, s61, 146432
s_xor_b32 s6, s82, 65536
buffer_load_dwordx4 v26, s[16:19], s6 offen offset:2112 lds
buffer_load_dwordx4 v27, s[16:19], s6 offen offset:3168 lds
buffer_load_dwordx4 v24, s[16:19], s6 offen offset:0 lds
buffer_load_dwordx4 v25, s[16:19], s6 offen offset:1056 lds
s_waitcnt vmcnt(8)
s_barrier
s_add_u32 m0, s61, 41984
s_xor_b32 s6, s82, 65792
buffer_load_dwordx4 v26, s[16:19], s6 offen offset:2112 lds
buffer_load_dwordx4 v27, s[16:19], s6 offen offset:3168 lds
buffer_load_dwordx4 v24, s[16:19], s6 offen offset:0 lds
buffer_load_dwordx4 v25, s[16:19], s6 offen offset:1056 lds
s_waitcnt vmcnt(8)
s_barrier
s_add_u32 m0, s61, 59392
s_xor_b32 s6, s81, 65536
buffer_load_dwordx4 v22, s[12:15], s6 offen offset:2112 lds
buffer_load_dwordx4 v23, s[12:15], s6 offen offset:3168 lds
buffer_load_dwordx4 v20, s[12:15], s6 offen offset:0 lds
buffer_load_dwordx4 v21, s[12:15], s6 offen offset:1056 lds
s_add_u32 m0, s61, 76800
s_xor_b32 s6, s81, 65536
buffer_load_dwordx4 v34, s[12:15], s6 offen offset:2112 lds
buffer_load_dwordx4 v35, s[12:15], s6 offen offset:3168 lds
buffer_load_dwordx4 v32, s[12:15], s6 offen offset:0 lds
buffer_load_dwordx4 v33, s[12:15], s6 offen offset:1056 lds
s_barrier
s_add_u32 m0, s61, 94208
s_xor_b32 s6, s82, 32768
buffer_load_dwordx4 v26, s[16:19], s6 offen offset:2112 lds
buffer_load_dwordx4 v27, s[16:19], s6 offen offset:3168 lds
buffer_load_dwordx4 v24, s[16:19], s6 offen offset:0 lds
buffer_load_dwordx4 v25, s[16:19], s6 offen offset:1056 lds
s_add_u32 m0, s61, 111616
s_xor_b32 s6, s82, 33024
buffer_load_dwordx4 v26, s[16:19], s6 offen offset:2112 lds
buffer_load_dwordx4 v27, s[16:19], s6 offen offset:3168 lds
buffer_load_dwordx4 v24, s[16:19], s6 offen offset:0 lds
buffer_load_dwordx4 v25, s[16:19], s6 offen offset:1056 lds
s_barrier
s_add_u32 m0, s61, 24576
s_xor_b32 s6, s81, 98304
buffer_load_dwordx4 v22, s[12:15], s6 offen offset:2112 lds
buffer_load_dwordx4 v23, s[12:15], s6 offen offset:3168 lds
buffer_load_dwordx4 v20, s[12:15], s6 offen offset:0 lds
buffer_load_dwordx4 v21, s[12:15], s6 offen offset:1056 lds
s_waitcnt vmcnt(16)
s_barrier
s_add_u32 m0, s61, 129024
s_xor_b32 s6, s81, 98304
buffer_load_dwordx4 v34, s[12:15], s6 offen offset:2112 lds
buffer_load_dwordx4 v35, s[12:15], s6 offen offset:3168 lds
buffer_load_dwordx4 v32, s[12:15], s6 offen offset:0 lds
buffer_load_dwordx4 v33, s[12:15], s6 offen offset:1056 lds
s_waitcnt vmcnt(16)
s_barrier
s_add_u32 m0, s61, 7168
s_xor_b32 s6, s82, 131072
buffer_load_dwordx4 v26, s[16:19], s6 offen offset:2112 lds
buffer_load_dwordx4 v27, s[16:19], s6 offen offset:3168 lds
buffer_load_dwordx4 v24, s[16:19], s6 offen offset:0 lds
buffer_load_dwordx4 v25, s[16:19], s6 offen offset:1056 lds
s_waitcnt vmcnt(16)
s_barrier
s_add_u32 m0, s61, 59392
s_xor_b32 s6, s82, 131328
buffer_load_dwordx4 v26, s[16:19], s6 offen offset:2112 lds
buffer_load_dwordx4 v27, s[16:19], s6 offen offset:3168 lds
buffer_load_dwordx4 v24, s[16:19], s6 offen offset:0 lds
buffer_load_dwordx4 v25, s[16:19], s6 offen offset:1056 lds
s_waitcnt vmcnt(16)
s_barrier
s_add_u32 m0, s61, 76800
s_xor_b32 s6, s81, 131072
buffer_load_dwordx4 v22, s[12:15], s6 offen offset:2112 lds
buffer_load_dwordx4 v23, s[12:15], s6 offen offset:3168 lds
buffer_load_dwordx4 v20, s[12:15], s6 offen offset:0 lds
buffer_load_dwordx4 v21, s[12:15], s6 offen offset:1056 lds
s_waitcnt vmcnt(16)
s_barrier
s_add_u32 m0, s61, 94208
s_xor_b32 s6, s81, 131072
buffer_load_dwordx4 v34, s[12:15], s6 offen offset:2112 lds
buffer_load_dwordx4 v35, s[12:15], s6 offen offset:3168 lds
buffer_load_dwordx4 v32, s[12:15], s6 offen offset:0 lds
buffer_load_dwordx4 v33, s[12:15], s6 offen offset:1056 lds
s_waitcnt vmcnt(16)
s_barrier
s_add_u32 m0, s61, 111616
s_xor_b32 s6, s82, 98304
buffer_load_dwordx4 v26, s[16:19], s6 offen offset:2112 lds
buffer_load_dwordx4 v27, s[16:19], s6 offen offset:3168 lds
buffer_load_dwordx4 v24, s[16:19], s6 offen offset:0 lds
buffer_load_dwordx4 v25, s[16:19], s6 offen offset:1056 lds
s_barrier
s_add_u32 m0, s61, 24576
s_xor_b32 s6, s82, 98560
buffer_load_dwordx4 v26, s[16:19], s6 offen offset:2112 lds
buffer_load_dwordx4 v27, s[16:19], s6 offen offset:3168 lds
buffer_load_dwordx4 v24, s[16:19], s6 offen offset:0 lds
buffer_load_dwordx4 v25, s[16:19], s6 offen offset:1056 lds
s_barrier
s_add_u32 m0, s61, 129024
s_xor_b32 s6, s81, 163840
buffer_load_dwordx4 v22, s[12:15], s6 offen offset:2112 lds
buffer_load_dwordx4 v23, s[12:15], s6 offen offset:3168 lds
buffer_load_dwordx4 v20, s[12:15], s6 offen offset:0 lds
buffer_load_dwordx4 v21, s[12:15], s6 offen offset:1056 lds
s_waitcnt vmcnt(16)
s_barrier
s_add_u32 m0, s61, 146432
s_xor_b32 s6, s81, 163840
buffer_load_dwordx4 v34, s[12:15], s6 offen offset:2112 lds
buffer_load_dwordx4 v35, s[12:15], s6 offen offset:3168 lds
buffer_load_dwordx4 v32, s[12:15], s6 offen offset:0 lds
buffer_load_dwordx4 v33, s[12:15], s6 offen offset:1056 lds
s_waitcnt vmcnt(16)
s_barrier
s_add_u32 m0, s61, 41984
s_xor_b32 s6, s82, 196608
buffer_load_dwordx4 v26, s[16:19], s6 offen offset:2112 lds
buffer_load_dwordx4 v27, s[16:19], s6 offen offset:3168 lds
buffer_load_dwordx4 v24, s[16:19], s6 offen offset:0 lds
buffer_load_dwordx4 v25, s[16:19], s6 offen offset:1056 lds
s_waitcnt vmcnt(16)
s_barrier
s_add_u32 m0, s61, 76800
s_xor_b32 s6, s82, 196864
buffer_load_dwordx4 v26, s[16:19], s6 offen offset:2112 lds
buffer_load_dwordx4 v27, s[16:19], s6 offen offset:3168 lds
buffer_load_dwordx4 v24, s[16:19], s6 offen offset:0 lds
buffer_load_dwordx4 v25, s[16:19], s6 offen offset:1056 lds
s_waitcnt vmcnt(16)
s_barrier
s_add_u32 m0, s61, 94208
s_xor_b32 s6, s81, 196608
buffer_load_dwordx4 v22, s[12:15], s6 offen offset:2112 lds
buffer_load_dwordx4 v23, s[12:15], s6 offen offset:3168 lds
buffer_load_dwordx4 v20, s[12:15], s6 offen offset:0 lds
buffer_load_dwordx4 v21, s[12:15], s6 offen offset:1056 lds
s_waitcnt vmcnt(16)
s_barrier
s_add_u32 m0, s61, 111616
s_xor_b32 s6, s81, 196608
buffer_load_dwordx4 v34, s[12:15], s6 offen offset:2112 lds
buffer_load_dwordx4 v35, s[12:15], s6 offen offset:3168 lds
buffer_load_dwordx4 v32, s[12:15], s6 offen offset:0 lds
buffer_load_dwordx4 v33, s[12:15], s6 offen offset:1056 lds
s_waitcnt vmcnt(16)
s_barrier
s_add_u32 m0, s61, 24576
s_xor_b32 s6, s82, 163840
buffer_load_dwordx4 v26, s[16:19], s6 offen offset:2112 lds
buffer_load_dwordx4 v27, s[16:19], s6 offen offset:3168 lds
buffer_load_dwordx4 v24, s[16:19], s6 offen offset:0 lds
buffer_load_dwordx4 v25, s[16:19], s6 offen offset:1056 lds
s_barrier
s_add_u32 m0, s61, 129024
s_xor_b32 s6, s82, 164096
buffer_load_dwordx4 v26, s[16:19], s6 offen offset:2112 lds
buffer_load_dwordx4 v27, s[16:19], s6 offen offset:3168 lds
buffer_load_dwordx4 v24, s[16:19], s6 offen offset:0 lds
buffer_load_dwordx4 v25, s[16:19], s6 offen offset:1056 lds
s_barrier
s_add_u32 m0, s61, 146432
s_xor_b32 s6, s81, 229376
buffer_load_dwordx4 v22, s[12:15], s6 offen offset:2112 lds
buffer_load_dwordx4 v23, s[12:15], s6 offen offset:3168 lds
buffer_load_dwordx4 v20, s[12:15], s6 offen offset:0 lds
buffer_load_dwordx4 v21, s[12:15], s6 offen offset:1056 lds
s_waitcnt vmcnt(16)
s_barrier
s_add_u32 m0, s61, 7168
s_xor_b32 s6, s81, 229376
buffer_load_dwordx4 v34, s[12:15], s6 offen offset:2112 lds
buffer_load_dwordx4 v35, s[12:15], s6 offen offset:3168 lds
buffer_load_dwordx4 v32, s[12:15], s6 offen offset:0 lds
buffer_load_dwordx4 v33, s[12:15], s6 offen offset:1056 lds
s_waitcnt vmcnt(16)
s_barrier
s_add_u32 m0, s61, 59392
s_xor_b32 s6, s82, 262144
buffer_load_dwordx4 v26, s[16:19], s6 offen offset:2112 lds
buffer_load_dwordx4 v27, s[16:19], s6 offen offset:3168 lds
buffer_load_dwordx4 v24, s[16:19], s6 offen offset:0 lds
buffer_load_dwordx4 v25, s[16:19], s6 offen offset:1056 lds
s_waitcnt vmcnt(16)
s_barrier
s_add_u32 m0, s61, 94208
s_xor_b32 s6, s82, 262400
buffer_load_dwordx4 v26, s[16:19], s6 offen offset:2112 lds
buffer_load_dwordx4 v27, s[16:19], s6 offen offset:3168 lds
buffer_load_dwordx4 v24, s[16:19], s6 offen offset:0 lds
buffer_load_dwordx4 v25, s[16:19], s6 offen offset:1056 lds
s_waitcnt vmcnt(16)
s_barrier
s_add_u32 m0, s61, 111616
s_xor_b32 s6, s81, 262144
buffer_load_dwordx4 v22, s[12:15], s6 offen offset:2112 lds
buffer_load_dwordx4 v23, s[12:15], s6 offen offset:3168 lds
buffer_load_dwordx4 v20, s[12:15], s6 offen offset:0 lds
buffer_load_dwordx4 v21, s[12:15], s6 offen offset:1056 lds
s_waitcnt vmcnt(16)
s_barrier
s_add_u32 m0, s61, 24576
s_xor_b32 s6, s81, 262144
buffer_load_dwordx4 v34, s[12:15], s6 offen offset:2112 lds
buffer_load_dwordx4 v35, s[12:15], s6 offen offset:3168 lds
buffer_load_dwordx4 v32, s[12:15], s6 offen offset:0 lds
buffer_load_dwordx4 v33, s[12:15], s6 offen offset:1056 lds
s_waitcnt vmcnt(16)
s_barrier
s_add_u32 m0, s61, 129024
s_xor_b32 s6, s82, 229376
buffer_load_dwordx4 v26, s[16:19], s6 offen offset:2112 lds
buffer_load_dwordx4 v27, s[16:19], s6 offen offset:3168 lds
buffer_load_dwordx4 v24, s[16:19], s6 offen offset:0 lds
buffer_load_dwordx4 v25, s[16:19], s6 offen offset:1056 lds
s_barrier
s_add_u32 m0, s61, 146432
s_xor_b32 s6, s82, 229632
buffer_load_dwordx4 v26, s[16:19], s6 offen offset:2112 lds
buffer_load_dwordx4 v27, s[16:19], s6 offen offset:3168 lds
buffer_load_dwordx4 v24, s[16:19], s6 offen offset:0 lds
buffer_load_dwordx4 v25, s[16:19], s6 offen offset:1056 lds
s_barrier
s_add_u32 m0, s61, 7168
s_xor_b32 s6, s81, 294912
buffer_load_dwordx4 v22, s[12:15], s6 offen offset:2112 lds
buffer_load_dwordx4 v23, s[12:15], s6 offen offset:3168 lds
buffer_load_dwordx4 v20, s[12:15], s6 offen offset:0 lds
buffer_load_dwordx4 v21, s[12:15], s6 offen offset:1056 lds
s_waitcnt vmcnt(16)
s_barrier
s_add_u32 m0, s61, 41984
s_xor_b32 s6, s81, 294912
buffer_load_dwordx4 v34, s[12:15], s6 offen offset:2112 lds
buffer_load_dwordx4 v35, s[12:15], s6 offen offset:3168 lds
buffer_load_dwordx4 v32, s[12:15], s6 offen offset:0 lds
buffer_load_dwordx4 v33, s[12:15], s6 offen offset:1056 lds
s_waitcnt vmcnt(16)
s_barrier
s_add_u32 m0, s61, 76800
s_xor_b32 s6, s82, 327680
buffer_load_dwordx4 v26, s[16:19], s6 offen offset:2112 lds
buffer_load_dwordx4 v27, s[16:19], s6 offen offset:3168 lds
buffer_load_dwordx4 v24, s[16:19], s6 offen offset:0 lds
buffer_load_dwordx4 v25, s[16:19], s6 offen offset:1056 lds
s_waitcnt vmcnt(16)
s_barrier
s_add_u32 m0, s61, 111616
s_xor_b32 s6, s82, 327936
buffer_load_dwordx4 v26, s[16:19], s6 offen offset:2112 lds
buffer_load_dwordx4 v27, s[16:19], s6 offen offset:3168 lds
buffer_load_dwordx4 v24, s[16:19], s6 offen offset:0 lds
buffer_load_dwordx4 v25, s[16:19], s6 offen offset:1056 lds
s_waitcnt vmcnt(16)
s_barrier
s_add_u32 m0, s61, 24576
s_xor_b32 s6, s81, 327680
buffer_load_dwordx4 v22, s[12:15], s6 offen offset:2112 lds
buffer_load_dwordx4 v23, s[12:15], s6 offen offset:3168 lds
buffer_load_dwordx4 v20, s[12:15], s6 offen offset:0 lds
buffer_load_dwordx4 v21, s[12:15], s6 offen offset:1056 lds
s_waitcnt vmcnt(16)
s_barrier
s_add_u32 m0, s61, 129024
s_xor_b32 s6, s81, 327680
buffer_load_dwordx4 v34, s[12:15], s6 offen offset:2112 lds
buffer_load_dwordx4 v35, s[12:15], s6 offen offset:3168 lds
buffer_load_dwordx4 v32, s[12:15], s6 offen offset:0 lds
buffer_load_dwordx4 v33, s[12:15], s6 offen offset:1056 lds
s_waitcnt vmcnt(16)
s_barrier
s_add_u32 m0, s61, 146432
s_xor_b32 s6, s82, 294912
buffer_load_dwordx4 v26, s[16:19], s6 offen offset:2112 lds
buffer_load_dwordx4 v27, s[16:19], s6 offen offset:3168 lds
buffer_load_dwordx4 v24, s[16:19], s6 offen offset:0 lds
buffer_load_dwordx4 v25, s[16:19], s6 offen offset:1056 lds
s_barrier
s_add_u32 m0, s61, 7168
s_xor_b32 s6, s82, 295168
buffer_load_dwordx4 v26, s[16:19], s6 offen offset:2112 lds
buffer_load_dwordx4 v27, s[16:19], s6 offen offset:3168 lds
buffer_load_dwordx4 v24, s[16:19], s6 offen offset:0 lds
buffer_load_dwordx4 v25, s[16:19], s6 offen offset:1056 lds
s_barrier
s_add_u32 m0, s61, 41984
s_xor_b32 s6, s81, 360448
buffer_load_dwordx4 v22, s[12:15], s6 offen offset:2112 lds
buffer_load_dwordx4 v23, s[12:15], s6 offen offset:3168 lds
buffer_load_dwordx4 v20, s[12:15], s6 offen offset:0 lds
buffer_load_dwordx4 v21, s[12:15], s6 offen offset:1056 lds
s_waitcnt vmcnt(16)
s_barrier
s_add_u32 m0, s61, 59392
s_xor_b32 s6, s81, 360448
buffer_load_dwordx4 v34, s[12:15], s6 offen offset:2112 lds
buffer_load_dwordx4 v35, s[12:15], s6 offen offset:3168 lds
buffer_load_dwordx4 v32, s[12:15], s6 offen offset:0 lds
buffer_load_dwordx4 v33, s[12:15], s6 offen offset:1056 lds
s_waitcnt vmcnt(16)
s_barrier
buffer_load_dword v11, v10, s[24:27], s76 offen
v_mov_b32 v50, 0
global_load_dword v48, v50, s[0:1] sc1
global_load_dword v11, v45, s[72:73]
s_add_u32 m0, s61, 94208
s_xor_b32 s6, s82, 393216
buffer_load_dwordx4 v26, s[16:19], s6 offen offset:2112 lds
buffer_load_dwordx4 v27, s[16:19], s6 offen offset:3168 lds
buffer_load_dwordx4 v24, s[16:19], s6 offen offset:0 lds
buffer_load_dwordx4 v25, s[16:19], s6 offen offset:1056 lds
s_waitcnt vmcnt(19)
s_barrier
s_add_u32 m0, s61, 24576
s_xor_b32 s6, s82, 393472
buffer_load_dwordx4 v26, s[16:19], s6 offen offset:2112 lds
buffer_load_dwordx4 v27, s[16:19], s6 offen offset:3168 lds
buffer_load_dwordx4 v24, s[16:19], s6 offen offset:0 lds
buffer_load_dwordx4 v25, s[16:19], s6 offen offset:1056 lds
s_waitcnt vmcnt(19)
s_barrier
s_add_u32 m0, s61, 129024
s_xor_b32 s6, s81, 393216
buffer_load_dwordx4 v22, s[12:15], s6 offen offset:2112 lds
buffer_load_dwordx4 v23, s[12:15], s6 offen offset:3168 lds
buffer_load_dwordx4 v20, s[12:15], s6 offen offset:0 lds
buffer_load_dwordx4 v21, s[12:15], s6 offen offset:1056 lds
s_waitcnt vmcnt(19)
s_barrier
s_add_u32 m0, s61, 146432
s_xor_b32 s6, s81, 393216
buffer_load_dwordx4 v34, s[12:15], s6 offen offset:2112 lds
buffer_load_dwordx4 v35, s[12:15], s6 offen offset:3168 lds
buffer_load_dwordx4 v32, s[12:15], s6 offen offset:0 lds
buffer_load_dwordx4 v33, s[12:15], s6 offen offset:1056 lds
s_waitcnt vmcnt(19)
s_barrier
s_add_u32 m0, s61, 7168
s_xor_b32 s6, s82, 360448
buffer_load_dwordx4 v26, s[16:19], s6 offen offset:2112 lds
buffer_load_dwordx4 v27, s[16:19], s6 offen offset:3168 lds
buffer_load_dwordx4 v24, s[16:19], s6 offen offset:0 lds
buffer_load_dwordx4 v25, s[16:19], s6 offen offset:1056 lds
s_barrier
s_add_u32 m0, s61, 41984
s_xor_b32 s6, s82, 360704
buffer_load_dwordx4 v26, s[16:19], s6 offen offset:2112 lds
buffer_load_dwordx4 v27, s[16:19], s6 offen offset:3168 lds
buffer_load_dwordx4 v24, s[16:19], s6 offen offset:0 lds
buffer_load_dwordx4 v25, s[16:19], s6 offen offset:1056 lds
s_barrier
s_add_u32 m0, s61, 59392
s_xor_b32 s6, s81, 425984
buffer_load_dwordx4 v22, s[12:15], s6 offen offset:2112 lds
buffer_load_dwordx4 v23, s[12:15], s6 offen offset:3168 lds
buffer_load_dwordx4 v20, s[12:15], s6 offen offset:0 lds
buffer_load_dwordx4 v21, s[12:15], s6 offen offset:1056 lds
s_waitcnt vmcnt(16)
s_barrier
s_add_u32 m0, s61, 76800
s_xor_b32 s6, s81, 425984
buffer_load_dwordx4 v34, s[12:15], s6 offen offset:2112 lds
buffer_load_dwordx4 v35, s[12:15], s6 offen offset:3168 lds
buffer_load_dwordx4 v32, s[12:15], s6 offen offset:0 lds
buffer_load_dwordx4 v33, s[12:15], s6 offen offset:1056 lds
s_waitcnt vmcnt(16)
s_barrier
s_add_u32 m0, s61, 111616
s_xor_b32 s6, s82, 458752
buffer_load_dwordx4 v26, s[16:19], s6 offen offset:2112 lds
buffer_load_dwordx4 v27, s[16:19], s6 offen offset:3168 lds
buffer_load_dwordx4 v24, s[16:19], s6 offen offset:0 lds
buffer_load_dwordx4 v25, s[16:19], s6 offen offset:1056 lds
s_waitcnt vmcnt(16)
s_barrier
s_add_u32 m0, s61, 129024
s_xor_b32 s6, s82, 459008
buffer_load_dwordx4 v26, s[16:19], s6 offen offset:2112 lds
buffer_load_dwordx4 v27, s[16:19], s6 offen offset:3168 lds
buffer_load_dwordx4 v24, s[16:19], s6 offen offset:0 lds
buffer_load_dwordx4 v25, s[16:19], s6 offen offset:1056 lds
s_waitcnt vmcnt(16)
s_barrier
s_add_u32 m0, s61, 146432
s_xor_b32 s6, s81, 458752
buffer_load_dwordx4 v22, s[12:15], s6 offen offset:2112 lds
buffer_load_dwordx4 v23, s[12:15], s6 offen offset:3168 lds
buffer_load_dwordx4 v20, s[12:15], s6 offen offset:0 lds
buffer_load_dwordx4 v21, s[12:15], s6 offen offset:1056 lds
s_waitcnt vmcnt(16)
s_barrier
s_add_u32 m0, s61, 7168
s_xor_b32 s6, s81, 458752
buffer_load_dwordx4 v34, s[12:15], s6 offen offset:2112 lds
buffer_load_dwordx4 v35, s[12:15], s6 offen offset:3168 lds
buffer_load_dwordx4 v32, s[12:15], s6 offen offset:0 lds
buffer_load_dwordx4 v33, s[12:15], s6 offen offset:1056 lds
s_waitcnt vmcnt(16)
s_barrier
s_add_u32 m0, s61, 41984
s_xor_b32 s6, s82, 425984
buffer_load_dwordx4 v26, s[16:19], s6 offen offset:2112 lds
buffer_load_dwordx4 v27, s[16:19], s6 offen offset:3168 lds
buffer_load_dwordx4 v24, s[16:19], s6 offen offset:0 lds
buffer_load_dwordx4 v25, s[16:19], s6 offen offset:1056 lds
s_barrier
s_add_u32 m0, s61, 59392
s_xor_b32 s6, s82, 426240
buffer_load_dwordx4 v26, s[16:19], s6 offen offset:2112 lds
buffer_load_dwordx4 v27, s[16:19], s6 offen offset:3168 lds
buffer_load_dwordx4 v24, s[16:19], s6 offen offset:0 lds
buffer_load_dwordx4 v25, s[16:19], s6 offen offset:1056 lds
s_barrier
s_add_u32 m0, s61, 76800
s_xor_b32 s6, s81, 491520
buffer_load_dwordx4 v22, s[12:15], s6 offen offset:2112 lds
buffer_load_dwordx4 v23, s[12:15], s6 offen offset:3168 lds
buffer_load_dwordx4 v20, s[12:15], s6 offen offset:0 lds
buffer_load_dwordx4 v21, s[12:15], s6 offen offset:1056 lds
s_waitcnt vmcnt(16)
s_barrier
s_add_u32 m0, s61, 94208
s_xor_b32 s6, s81, 491520
buffer_load_dwordx4 v34, s[12:15], s6 offen offset:2112 lds
buffer_load_dwordx4 v35, s[12:15], s6 offen offset:3168 lds
buffer_load_dwordx4 v32, s[12:15], s6 offen offset:0 lds
buffer_load_dwordx4 v33, s[12:15], s6 offen offset:1056 lds
s_waitcnt vmcnt(16)
s_barrier
s_add_u32 m0, s61, 24576
s_xor_b32 s6, s82, 491520
buffer_load_dwordx4 v26, s[16:19], s6 offen offset:2112 lds
buffer_load_dwordx4 v27, s[16:19], s6 offen offset:3168 lds
buffer_load_dwordx4 v24, s[16:19], s6 offen offset:0 lds
buffer_load_dwordx4 v25, s[16:19], s6 offen offset:1056 lds
s_waitcnt vmcnt(16)
s_barrier
s_add_u32 m0, s61, 146432
s_xor_b32 s6, s82, 491776
buffer_load_dwordx4 v26, s[16:19], s6 offen offset:2112 lds
buffer_load_dwordx4 v27, s[16:19], s6 offen offset:3168 lds
buffer_load_dwordx4 v24, s[16:19], s6 offen offset:0 lds
buffer_load_dwordx4 v25, s[16:19], s6 offen offset:1056 lds
s_waitcnt vmcnt(16)
s_barrier
s_mov_b32 s84, s44
s_add_u32 s85, s84, 1
s_cmp_eq_u32 s85, 7
s_cselect_b32 s85, 0, s85
s_add_u32 s86, s85, 1
s_cmp_eq_u32 s86, 7
s_cselect_b32 s86, 0, s86
s_add_u32 s87, s86, 1
s_cmp_eq_u32 s87, 7
s_cselect_b32 s87, 0, s87
s_add_u32 s88, s87, 1
s_cmp_eq_u32 s88, 7
s_cselect_b32 s88, 0, s88
s_add_u32 s89, s88, 1
s_cmp_eq_u32 s89, 7
s_cselect_b32 s89, 0, s89
s_add_u32 s90, s89, 1
s_cmp_eq_u32 s90, 7
s_cselect_b32 s90, 0, s90
s_lshl_b32 s6, s84, 7
s_add_u32 m0, s61, 7168
s_add_u32 s6, s6, s60
buffer_load_dwordx4 v30, s[24:27], s6 offen offset:2112 lds
buffer_load_dwordx4 v31, s[24:27], s6 offen offset:3168 lds
buffer_load_dwordx4 v28, s[24:27], s6 offen offset:0 lds
buffer_load_dwordx4 v29, s[24:27], s6 offen offset:1056 lds
s_waitcnt vmcnt(16)
s_barrier
s_lshl_b32 s6, s84, 7
s_add_u32 m0, s61, 41984
s_add_u32 s6, s6, s60
s_add_u32 s6, s6, 114688
buffer_load_dwordx4 v30, s[24:27], s6 offen offset:2112 lds
buffer_load_dwordx4 v31, s[24:27], s6 offen offset:3168 lds
buffer_load_dwordx4 v28, s[24:27], s6 offen offset:0 lds
buffer_load_dwordx4 v29, s[24:27], s6 offen offset:1056 lds
s_waitcnt vmcnt(16)
s_barrier
s_lshl_b32 s6, s85, 7
s_add_u32 m0, s61, 59392
s_add_u32 s6, s6, s60
buffer_load_dwordx4 v30, s[24:27], s6 offen offset:2112 lds
buffer_load_dwordx4 v31, s[24:27], s6 offen offset:3168 lds
buffer_load_dwordx4 v28, s[24:27], s6 offen offset:0 lds
buffer_load_dwordx4 v29, s[24:27], s6 offen offset:1056 lds
s_barrier
s_lshl_b32 s6, s85, 7
s_add_u32 m0, s61, 76800
s_add_u32 s6, s6, s60
s_add_u32 s6, s6, 114688
buffer_load_dwordx4 v30, s[24:27], s6 offen offset:2112 lds
buffer_load_dwordx4 v31, s[24:27], s6 offen offset:3168 lds
buffer_load_dwordx4 v28, s[24:27], s6 offen offset:0 lds
buffer_load_dwordx4 v29, s[24:27], s6 offen offset:1056 lds
s_barrier
s_lshl_b32 s6, s86, 7
s_add_u32 m0, s61, 94208
s_add_u32 s6, s6, s60
buffer_load_dwordx4 v30, s[24:27], s6 offen offset:2112 lds
buffer_load_dwordx4 v31, s[24:27], s6 offen offset:3168 lds
buffer_load_dwordx4 v28, s[24:27], s6 offen offset:0 lds
buffer_load_dwordx4 v29, s[24:27], s6 offen offset:1056 lds
s_waitcnt vmcnt(24)
s_barrier
s_waitcnt vmcnt(20)
s_barrier
s_waitcnt vmcnt(12)
s_barrier
s_barrier
s_lshl_b32 s6, s86, 7
s_add_u32 m0, s61, 24576
s_add_u32 s6, s6, s60
s_add_u32 s6, s6, 114688
buffer_load_dwordx4 v30, s[24:27], s6 offen offset:2112 lds
buffer_load_dwordx4 v31, s[24:27], s6 offen offset:3168 lds
buffer_load_dwordx4 v28, s[24:27], s6 offen offset:0 lds
buffer_load_dwordx4 v29, s[24:27], s6 offen offset:1056 lds
s_waitcnt vmcnt(8)
s_barrier
s_lshl_b32 s6, s87, 7
s_add_u32 m0, s61, 146432
s_add_u32 s6, s6, s60
buffer_load_dwordx4 v30, s[24:27], s6 offen offset:2112 lds
buffer_load_dwordx4 v31, s[24:27], s6 offen offset:3168 lds
buffer_load_dwordx4 v28, s[24:27], s6 offen offset:0 lds
buffer_load_dwordx4 v29, s[24:27], s6 offen offset:1056 lds
s_barrier
s_lshl_b32 s6, s87, 7
s_add_u32 m0, s61, 111616
s_add_u32 s6, s6, s60
s_add_u32 s6, s6, 114688
buffer_load_dwordx4 v30, s[24:27], s6 offen offset:2112 lds
buffer_load_dwordx4 v31, s[24:27], s6 offen offset:3168 lds
buffer_load_dwordx4 v28, s[24:27], s6 offen offset:0 lds
buffer_load_dwordx4 v29, s[24:27], s6 offen offset:1056 lds
s_waitcnt vmcnt(8)
s_barrier
s_lshl_b32 s6, s88, 7
s_add_u32 m0, s61, 129024
s_add_u32 s6, s6, s60
buffer_load_dwordx4 v30, s[24:27], s6 offen offset:2112 lds
buffer_load_dwordx4 v31, s[24:27], s6 offen offset:3168 lds
buffer_load_dwordx4 v28, s[24:27], s6 offen offset:0 lds
buffer_load_dwordx4 v29, s[24:27], s6 offen offset:1056 lds
s_barrier
s_lshl_b32 s6, s88, 7
s_add_u32 m0, s61, 7168
s_add_u32 s6, s6, s60
s_add_u32 s6, s6, 114688
buffer_load_dwordx4 v30, s[24:27], s6 offen offset:2112 lds
buffer_load_dwordx4 v31, s[24:27], s6 offen offset:3168 lds
buffer_load_dwordx4 v28, s[24:27], s6 offen offset:0 lds
buffer_load_dwordx4 v29, s[24:27], s6 offen offset:1056 lds
s_waitcnt vmcnt(8)
s_barrier
s_lshl_b32 s6, s89, 7
s_add_u32 m0, s61, 41984
s_add_u32 s6, s6, s60
buffer_load_dwordx4 v30, s[24:27], s6 offen offset:2112 lds
buffer_load_dwordx4 v31, s[24:27], s6 offen offset:3168 lds
buffer_load_dwordx4 v28, s[24:27], s6 offen offset:0 lds
buffer_load_dwordx4 v29, s[24:27], s6 offen offset:1056 lds
s_barrier
s_lshl_b32 s6, s89, 7
s_add_u32 m0, s61, 59392
s_add_u32 s6, s6, s60
s_add_u32 s6, s6, 114688
buffer_load_dwordx4 v30, s[24:27], s6 offen offset:2112 lds
buffer_load_dwordx4 v31, s[24:27], s6 offen offset:3168 lds
buffer_load_dwordx4 v28, s[24:27], s6 offen offset:0 lds
buffer_load_dwordx4 v29, s[24:27], s6 offen offset:1056 lds
s_waitcnt vmcnt(8)
s_barrier
s_lshl_b32 s6, s90, 7
s_add_u32 m0, s61, 76800
s_add_u32 s6, s6, s60
buffer_load_dwordx4 v30, s[24:27], s6 offen offset:2112 lds
buffer_load_dwordx4 v31, s[24:27], s6 offen offset:3168 lds
buffer_load_dwordx4 v28, s[24:27], s6 offen offset:0 lds
buffer_load_dwordx4 v29, s[24:27], s6 offen offset:1056 lds
s_barrier
s_lshl_b32 s6, s90, 7
s_add_u32 m0, s61, 24576
s_add_u32 s6, s6, s60
s_add_u32 s6, s6, 114688
buffer_load_dwordx4 v30, s[24:27], s6 offen offset:2112 lds
buffer_load_dwordx4 v31, s[24:27], s6 offen offset:3168 lds
buffer_load_dwordx4 v28, s[24:27], s6 offen offset:0 lds
buffer_load_dwordx4 v29, s[24:27], s6 offen offset:1056 lds
s_waitcnt vmcnt(8)
s_barrier
s_barrier
s_waitcnt vmcnt(0)
s_barrier
s_barrier
s_mov_b32 s62, s45
s_branch L_reduce
L_ld3:
s_lshl_b32 s6, s85, 19
s_add_u32 m0, s83, 94208
s_add_u32 s6, s6, s47
s_add_u32 s6, s6, 262144
buffer_load_dwordx4 v19, s[20:23], s6 offen offset:3264 lds
buffer_load_dwordx4 v16, s[20:23], s6 offen offset:0 lds
buffer_load_dwordx4 v17, s[20:23], s6 offen offset:1088 lds
buffer_load_dwordx4 v18, s[20:23], s6 offen offset:2176 lds
s_waitcnt vmcnt(13)
s_barrier
s_lshl_b32 s6, s86, 19
s_add_u32 m0, s83, 111616
s_add_u32 s6, s6, s47
buffer_load_dwordx4 v19, s[20:23], s6 offen offset:3264 lds
buffer_load_dwordx4 v16, s[20:23], s6 offen offset:0 lds
buffer_load_dwordx4 v17, s[20:23], s6 offen offset:1088 lds
buffer_load_dwordx4 v18, s[20:23], s6 offen offset:2176 lds
s_lshl_b32 s6, s86, 19
s_add_u32 m0, s83, 129024
s_add_u32 s6, s6, s47
s_add_u32 s6, s6, 262144
buffer_load_dwordx4 v19, s[20:23], s6 offen offset:3264 lds
buffer_load_dwordx4 v16, s[20:23], s6 offen offset:0 lds
buffer_load_dwordx4 v17, s[20:23], s6 offen offset:1088 lds
buffer_load_dwordx4 v18, s[20:23], s6 offen offset:2176 lds
s_waitcnt vmcnt(13)
s_barrier
s_cmp_ge_u32 s45, 2
s_cselect_b32 s6, s89, s88
s_lshl_b32 s6, s6, 7
s_add_u32 m0, s61, 146432
s_add_u32 s6, s6, s46
buffer_load_dwordx4 v15, s[8:11], s6 offen offset:3168 lds
buffer_load_dwordx4 v12, s[8:11], s6 offen offset:0 lds
buffer_load_dwordx4 v13, s[8:11], s6 offen offset:1056 lds
buffer_load_dwordx4 v14, s[8:11], s6 offen offset:2112 lds
s_lshl_b32 s6, s87, 19
s_add_u32 m0, s83, 7168
s_add_u32 s6, s6, s47
buffer_load_dwordx4 v19, s[20:23], s6 offen offset:3264 lds
buffer_load_dwordx4 v16, s[20:23], s6 offen offset:0 lds
buffer_load_dwordx4 v17, s[20:23], s6 offen offset:1088 lds
buffer_load_dwordx4 v18, s[20:23], s6 offen offset:2176 lds
s_waitcnt vmcnt(16)
s_barrier
s_lshl_b32 s6, s87, 19
s_add_u32 m0, s83, 24576
s_add_u32 s6, s6, s47
s_add_u32 s6, s6, 262144
buffer_load_dwordx4 v19, s[20:23], s6 offen offset:3264 lds
buffer_load_dwordx4 v16, s[20:23], s6 offen offset:0 lds
buffer_load_dwordx4 v17, s[20:23], s6 offen offset:1088 lds
buffer_load_dwordx4 v18, s[20:23], s6 offen offset:2176 lds
s_lshl_b32 s6, s88, 19
s_add_u32 m0, s83, 41984
s_add_u32 s6, s6, s47
buffer_load_dwordx4 v19, s[20:23], s6 offen offset:3264 lds
buffer_load_dwordx4 v16, s[20:23], s6 offen offset:0 lds
buffer_load_dwordx4 v17, s[20:23], s6 offen offset:1088 lds
buffer_load_dwordx4 v18, s[20:23], s6 offen offset:2176 lds
s_waitcnt vmcnt(20)
s_barrier
s_lshl_b32 s6, s88, 19
s_add_u32 m0, s83, 76800
s_add_u32 s6, s6, s47
s_add_u32 s6, s6, 262144
buffer_load_dwordx4 v19, s[20:23], s6 offen offset:3264 lds
buffer_load_dwordx4 v16, s[20:23], s6 offen offset:0 lds
buffer_load_dwordx4 v17, s[20:23], s6 offen offset:1088 lds
buffer_load_dwordx4 v18, s[20:23], s6 offen offset:2176 lds
s_waitcnt vmcnt(20)
s_barrier
s_cmp_ge_u32 s45, 2
s_cselect_b32 s6, s91, s90
s_lshl_b32 s6, s6, 7
s_add_u32 m0, s61, 59392
s_add_u32 s6, s6, s46
buffer_load_dwordx4 v15, s[8:11], s6 offen offset:3168 lds
buffer_load_dwordx4 v12, s[8:11], s6 offen offset:0 lds
buffer_load_dwordx4 v13, s[8:11], s6 offen offset:1056 lds
buffer_load_dwordx4 v14, s[8:11], s6 offen offset:2112 lds
s_lshl_b32 s6, s89, 19
s_add_u32 m0, s83, 94208
s_add_u32 s6, s6, s47
buffer_load_dwordx4 v19, s[20:23], s6 offen offset:3264 lds
buffer_load_dwordx4 v16, s[20:23], s6 offen offset:0 lds
buffer_load_dwordx4 v17, s[20:23], s6 offen offset:1088 lds
buffer_load_dwordx4 v18, s[20:23], s6 offen offset:2176 lds
s_waitcnt vmcnt(20)
s_barrier
s_lshl_b32 s6, s89, 19
s_add_u32 m0, s83, 111616
s_add_u32 s6, s6, s47
s_add_u32 s6, s6, 262144
buffer_load_dwordx4 v19, s[20:23], s6 offen offset:3264 lds
buffer_load_dwordx4 v16, s[20:23], s6 offen offset:0 lds
buffer_load_dwordx4 v17, s[20:23], s6 offen offset:1088 lds
buffer_load_dwordx4 v18, s[20:23], s6 offen offset:2176 lds
s_waitcnt vmcnt(20)
s_barrier
s_lshl_b32 s6, s90, 19
s_add_u32 m0, s83, 129024
s_add_u32 s6, s6, s47
buffer_load_dwordx4 v19, s[20:23], s6 offen offset:3264 lds
buffer_load_dwordx4 v16, s[20:23], s6 offen offset:0 lds
buffer_load_dwordx4 v17, s[20:23], s6 offen offset:1088 lds
buffer_load_dwordx4 v18, s[20:23], s6 offen offset:2176 lds
s_waitcnt vmcnt(20)
s_barrier
s_lshl_b32 s6, s90, 19
s_add_u32 m0, s83, 7168
s_add_u32 s6, s6, s47
s_add_u32 s6, s6, 262144
buffer_load_dwordx4 v19, s[20:23], s6 offen offset:3264 lds
buffer_load_dwordx4 v16, s[20:23], s6 offen offset:0 lds
buffer_load_dwordx4 v17, s[20:23], s6 offen offset:1088 lds
buffer_load_dwordx4 v18, s[20:23], s6 offen offset:2176 lds
s_waitcnt vmcnt(20)
s_barrier
s_add_u32 m0, s61, 24576
s_xor_b32 s6, s81, 65536
buffer_load_dwordx4 v23, s[12:15], s6 offen offset:3168 lds
buffer_load_dwordx4 v20, s[12:15], s6 offen offset:0 lds
buffer_load_dwordx4 v21, s[12:15], s6 offen offset:1056 lds
buffer_load_dwordx4 v22, s[12:15], s6 offen offset:2112 lds
s_add_u32 m0, s61, 146432
s_xor_b32 s6, s81, 65536
buffer_load_dwordx4 v35, s[12:15], s6 offen offset:3168 lds
buffer_load_dwordx4 v32, s[12:15], s6 offen offset:0 lds
buffer_load_dwordx4 v33, s[12:15], s6 offen offset:1056 lds
buffer_load_dwordx4 v34, s[12:15], s6 offen offset:2112 lds
s_waitcnt vmcnt(20)
s_barrier
s_add_u32 m0, s61, 41984
s_xor_b32 s6, s81, 0
buffer_load_dwordx4 v23, s[12:15], s6 offen offset:3168 lds
buffer_load_dwordx4 v20, s[12:15], s6 offen offset:0 lds
buffer_load_dwordx4 v21, s[12:15], s6 offen offset:1056 lds
buffer_load_dwordx4 v22, s[12:15], s6 offen offset:2112 lds
s_waitcnt vmcnt(20)
s_barrier
s_add_u32 m0, s61, 76800
s_xor_b32 s6, s81, 0
buffer_load_dwordx4 v35, s[12:15], s6 offen offset:3168 lds
buffer_load_dwordx4 v32, s[12:15], s6 offen offset:0 lds
buffer_load_dwordx4 v33, s[12:15], s6 offen offset:1056 lds
buffer_load_dwordx4 v34, s[12:15], s6 offen offset:2112 lds
s_waitcnt vmcnt(20)
s_barrier
s_waitcnt vmcnt(16)
s_barrier
s_add_u32 m0, s61, 111616
s_xor_b32 s6, s81, 32768
buffer_load_dwordx4 v23, s[12:15], s6 offen offset:3168 lds
buffer_load_dwordx4 v20, s[12:15], s6 offen offset:0 lds
buffer_load_dwordx4 v21, s[12:15], s6 offen offset:1056 lds
buffer_load_dwordx4 v22, s[12:15], s6 offen offset:2112 lds
s_waitcnt vmcnt(8)
s_barrier
s_waitcnt vmcnt(4)
s_barrier
s_add_u32 m0, s61, 129024
s_xor_b32 s6, s81, 32768
buffer_load_dwordx4 v35, s[12:15], s6 offen offset:3168 lds
buffer_load_dwordx4 v32, s[12:15], s6 offen offset:0 lds
buffer_load_dwordx4 v33, s[12:15], s6 offen offset:1056 lds
buffer_load_dwordx4 v34, s[12:15], s6 offen offset:2112 lds
s_add_u32 m0, s61, 7168
s_xor_b32 s6, s82, 0
buffer_load_dwordx4 v27, s[16:19], s6 offen offset:3168 lds
buffer_load_dwordx4 v24, s[16:19], s6 offen offset:0 lds
buffer_load_dwordx4 v25, s[16:19], s6 offen offset:1056 lds
buffer_load_dwordx4 v26, s[16:19], s6 offen offset:2112 lds
s_waitcnt vmcnt(8)
s_barrier
s_add_u32 m0, s61, 41984
s_xor_b32 s6, s82, 256
buffer_load_dwordx4 v27, s[16:19], s6 offen offset:3168 lds
buffer_load_dwordx4 v24, s[16:19], s6 offen offset:0 lds
buffer_load_dwordx4 v25, s[16:19], s6 offen offset:1056 lds
buffer_load_dwordx4 v26, s[16:19], s6 offen offset:2112 lds
s_waitcnt vmcnt(8)
s_barrier
s_add_u32 m0, s61, 59392
s_xor_b32 s6, s81, 131072
buffer_load_dwordx4 v23, s[12:15], s6 offen offset:3168 lds
buffer_load_dwordx4 v20, s[12:15], s6 offen offset:0 lds
buffer_load_dwordx4 v21, s[12:15], s6 offen offset:1056 lds
buffer_load_dwordx4 v22, s[12:15], s6 offen offset:2112 lds
s_add_u32 m0, s61, 76800
s_xor_b32 s6, s81, 131072
buffer_load_dwordx4 v35, s[12:15], s6 offen offset:3168 lds
buffer_load_dwordx4 v32, s[12:15], s6 offen offset:0 lds
buffer_load_dwordx4 v33, s[12:15], s6 offen offset:1056 lds
buffer_load_dwordx4 v34, s[12:15], s6 offen offset:2112 lds
s_waitcnt vmcnt(12)
s_barrier
s_add_u32 m0, s61, 94208
s_xor_b32 s6, s82, 32768
buffer_load_dwordx4 v27, s[16:19], s6 offen offset:3168 lds
buffer_load_dwordx4 v24, s[16:19], s6 offen offset:0 lds
buffer_load_dwordx4 v25, s[16:19], s6 offen offset:1056 lds
buffer_load_dwordx4 v26, s[16:19], s6 offen offset:2112 lds
s_add_u32 m0, s61, 111616
s_xor_b32 s6, s82, 33024
buffer_load_dwordx4 v27, s[16:19], s6 offen offset:3168 lds
buffer_load_dwordx4 v24, s[16:19], s6 offen offset:0 lds
buffer_load_dwordx4 v25, s[16:19], s6 offen offset:1056 lds
buffer_load_dwordx4 v26, s[16:19], s6 offen offset:2112 lds
s_waitcnt vmcnt(16)
s_barrier
s_add_u32 m0, s61, 129024
s_xor_b32 s6, s81, 98304
buffer_load_dwordx4 v23, s[12:15], s6 offen offset:3168 lds
buffer_load_dwordx4 v20, s[12:15], s6 offen offset:0 lds
buffer_load_dwordx4 v21, s[12:15], s6 offen offset:1056 lds
buffer_load_dwordx4 v22, s[12:15], s6 offen offset:2112 lds
s_barrier
s_add_u32 m0, s61, 7168
s_xor_b32 s6, s81, 98304
buffer_load_dwordx4 v35, s[12:15], s6 offen offset:3168 lds
buffer_load_dwordx4 v32, s[12:15], s6 offen offset:0 lds
buffer_load_dwordx4 v33, s[12:15], s6 offen offset:1056 lds
buffer_load_dwordx4 v34, s[12:15], s6 offen offset:2112 lds
s_barrier
s_add_u32 m0, s61, 41984
s_xor_b32 s6, s82, 65536
buffer_load_dwordx4 v27, s[16:19], s6 offen offset:3168 lds
buffer_load_dwordx4 v24, s[16:19], s6 offen offset:0 lds
buffer_load_dwordx4 v25, s[16:19], s6 offen offset:1056 lds
buffer_load_dwordx4 v26, s[16:19], s6 offen offset:2112 lds
s_waitcnt vmcnt(16)
s_barrier
s_add_u32 m0, s61, 24576
s_xor_b32 s6, s82, 65792
buffer_load_dwordx4 v27, s[16:19], s6 offen offset:3168 lds
buffer_load_dwordx4 v24, s[16:19], s6 offen offset:0 lds
buffer_load_dwordx4 v25, s[16:19], s6 offen offset:1056 lds
buffer_load_dwordx4 v26, s[16:19], s6 offen offset:2112 lds
s_waitcnt vmcnt(16)
s_barrier
s_add_u32 m0, s61, 146432
s_xor_b32 s6, s81, 196608
buffer_load_dwordx4 v23, s[12:15], s6 offen offset:3168 lds
buffer_load_dwordx4 v20, s[12:15], s6 offen offset:0 lds
buffer_load_dwordx4 v21, s[12:15], s6 offen offset:1056 lds
buffer_load_dwordx4 v22, s[12:15], s6 offen offset:2112 lds
s_waitcnt vmcnt(16)
s_barrier
s_add_u32 m0, s61, 94208
s_xor_b32 s6, s81, 196608
buffer_load_dwordx4 v35, s[12:15], s6 offen offset:3168 lds
buffer_load_dwordx4 v32, s[12:15], s6 offen offset:0 lds
buffer_load_dwordx4 v33, s[12:15], s6 offen offset:1056 lds
buffer_load_dwordx4 v34, s[12:15], s6 offen offset:2112 lds
s_waitcnt vmcnt(16)
s_barrier
s_add_u32 m0, s61, 111616
s_xor_b32 s6, s82, 98304
buffer_load_dwordx4 v27, s[16:19], s6 offen offset:3168 lds
buffer_load_dwordx4 v24, s[16:19], s6 offen offset:0 lds
buffer_load_dwordx4 v25, s[16:19], s6 offen offset:1056 lds
buffer_load_dwordx4 v26, s[16:19], s6 offen offset:2112 lds
s_waitcnt vmcnt(16)
s_barrier
s_add_u32 m0, s61, 129024
s_xor_b32 s6, s82, 98560
buffer_load_dwordx4 v27, s[16:19], s6 offen offset:3168 lds
buffer_load_dwordx4 v24, s[16:19], s6 offen offset:0 lds
buffer_load_dwordx4 v25, s[16:19], s6 offen offset:1056 lds
buffer_load_dwordx4 v26, s[16:19], s6 offen offset:2112 lds
s_waitcnt vmcnt(16)
s_barrier
s_add_u32 m0, s61, 7168
s_xor_b32 s6, s81, 163840
buffer_load_dwordx4 v23, s[12:15], s6 offen offset:3168 lds
buffer_load_dwordx4 v20, s[12:15], s6 offen offset:0 lds
buffer_load_dwordx4 v21, s[12:15], s6 offen offset:1056 lds
buffer_load_dwordx4 v22, s[12:15], s6 offen offset:2112 lds
s_barrier
s_add_u32 m0, s61, 41984
s_xor_b32 s6, s81, 163840
buffer_load_dwordx4 v35, s[12:15], s6 offen offset:3168 lds
buffer_load_dwordx4 v32, s[12:15], s6 offen offset:0 lds
buffer_load_dwordx4 v33, s[12:15], s6 offen offset:1056 lds
buffer_load_dwordx4 v34, s[12:15], s6 offen offset:2112 lds
s_barrier
s_add_u32 m0, s61, 24576
s_xor_b32 s6, s82, 131072
buffer_load_dwordx4 v27, s[16:19], s6 offen offset:3168 lds
buffer_load_dwordx4 v24, s[16:19], s6 offen offset:0 lds
buffer_load_dwordx4 v25, s[16:19], s6 offen offset:1056 lds
buffer_load_dwordx4 v26, s[16:19], s6 offen offset:2112 lds
s_waitcnt vmcnt(16)
s_barrier
s_add_u32 m0, s61, 59392
s_xor_b32 s6, s82, 131328
buffer_load_dwordx4 v27, s[16:19], s6 offen offset:3168 lds
buffer_load_dwordx4 v24, s[16:19], s6 offen offset:0 lds
buffer_load_dwordx4 v25, s[16:19], s6 offen offset:1056 lds
buffer_load_dwordx4 v26, s[16:19], s6 offen offset:2112 lds
s_waitcnt vmcnt(16)
s_barrier
s_add_u32 m0, s61, 76800
s_xor_b32 s6, s81, 262144
buffer_load_dwordx4 v23, s[12:15], s6 offen offset:3168 lds
buffer_load_dwordx4 v20, s[12:15], s6 offen offset:0 lds
buffer_load_dwordx4 v21, s[12:15], s6 offen offset:1056 lds
buffer_load_dwordx4 v22, s[12:15], s6 offen offset:2112 lds
s_waitcnt vmcnt(16)
s_barrier
s_add_u32 m0, s61, 111616
s_xor_b32 s6, s81, 262144
buffer_load_dwordx4 v35, s[12:15], s6 offen offset:3168 lds
buffer_load_dwordx4 v32, s[12:15], s6 offen offset:0 lds
buffer_load_dwordx4 v33, s[12:15], s6 offen offset:1056 lds
buffer_load_dwordx4 v34, s[12:15], s6 offen offset:2112 lds
s_waitcnt vmcnt(16)
s_barrier
s_add_u32 m0, s61, 129024
s_xor_b32 s6, s82, 163840
buffer_load_dwordx4 v27, s[16:19], s6 offen offset:3168 lds
buffer_load_dwordx4 v24, s[16:19], s6 offen offset:0 lds
buffer_load_dwordx4 v25, s[16:19], s6 offen offset:1056 lds
buffer_load_dwordx4 v26, s[16:19], s6 offen offset:2112 lds
s_waitcnt vmcnt(16)
s_barrier
s_add_u32 m0, s61, 7168
s_xor_b32 s6, s82, 164096
buffer_load_dwordx4 v27, s[16:19], s6 offen offset:3168 lds
buffer_load_dwordx4 v24, s[16:19], s6 offen offset:0 lds
buffer_load_dwordx4 v25, s[16:19], s6 offen offset:1056 lds
buffer_load_dwordx4 v26, s[16:19], s6 offen offset:2112 lds
s_waitcnt vmcnt(16)
s_barrier
s_add_u32 m0, s61, 41984
s_xor_b32 s6, s81, 229376
buffer_load_dwordx4 v23, s[12:15], s6 offen offset:3168 lds
buffer_load_dwordx4 v20, s[12:15], s6 offen offset:0 lds
buffer_load_dwordx4 v21, s[12:15], s6 offen offset:1056 lds
buffer_load_dwordx4 v22, s[12:15], s6 offen offset:2112 lds
s_barrier
s_add_u32 m0, s61, 24576
s_xor_b32 s6, s81, 229376
buffer_load_dwordx4 v35, s[12:15], s6 offen offset:3168 lds
buffer_load_dwordx4 v32, s[12:15], s6 offen offset:0 lds
buffer_load_dwordx4 v33, s[12:15], s6 offen offset:1056 lds
buffer_load_dwordx4 v34, s[12:15], s6 offen offset:2112 lds
s_barrier
s_add_u32 m0, s61, 59392
s_xor_b32 s6, s82, 196608
buffer_load_dwordx4 v27, s[16:19], s6 offen offset:3168 lds
buffer_load_dwordx4 v24, s[16:19], s6 offen offset:0 lds
buffer_load_dwordx4 v25, s[16:19], s6 offen offset:1056 lds
buffer_load_dwordx4 v26, s[16:19], s6 offen offset:2112 lds
s_waitcnt vmcnt(16)
s_barrier
s_add_u32 m0, s61, 146432
s_xor_b32 s6, s82, 196864
buffer_load_dwordx4 v27, s[16:19], s6 offen offset:3168 lds
buffer_load_dwordx4 v24, s[16:19], s6 offen offset:0 lds
buffer_load_dwordx4 v25, s[16:19], s6 offen offset:1056 lds
buffer_load_dwordx4 v26, s[16:19], s6 offen offset:2112 lds
s_waitcnt vmcnt(16)
s_barrier
s_add_u32 m0, s61, 94208
s_xor_b32 s6, s81, 327680
buffer_load_dwordx4 v23, s[12:15], s6 offen offset:3168 lds
buffer_load_dwordx4 v20, s[12:15], s6 offen offset:0 lds
buffer_load_dwordx4 v21, s[12:15], s6 offen offset:1056 lds
buffer_load_dwordx4 v22, s[12:15], s6 offen offset:2112 lds
s_waitcnt vmcnt(16)
s_barrier
s_add_u32 m0, s61, 129024
s_xor_b32 s6, s81, 327680
buffer_load_dwordx4 v35, s[12:15], s6 offen offset:3168 lds
buffer_load_dwordx4 v32, s[12:15], s6 offen offset:0 lds
buffer_load_dwordx4 v33, s[12:15], s6 offen offset:1056 lds
buffer_load_dwordx4 v34, s[12:15], s6 offen offset:2112 lds
s_waitcnt vmcnt(16)
s_barrier
s_add_u32 m0, s61, 7168
s_xor_b32 s6, s82, 229376
buffer_load_dwordx4 v27, s[16:19], s6 offen offset:3168 lds
buffer_load_dwordx4 v24, s[16:19], s6 offen offset:0 lds
buffer_load_dwordx4 v25, s[16:19], s6 offen offset:1056 lds
buffer_load_dwordx4 v26, s[16:19], s6 offen offset:2112 lds
s_waitcnt vmcnt(16)
s_barrier
s_add_u32 m0, s61, 41984
s_xor_b32 s6, s82, 229632
buffer_load_dwordx4 v27, s[16:19], s6 offen offset:3168 lds
buffer_load_dwordx4 v24, s[16:19], s6 offen offset:0 lds
buffer_load_dwordx4 v25, s[16:19], s6 offen offset:1056 lds
buffer_load_dwordx4 v26, s[16:19], s6 offen offset:2112 lds
s_waitcnt vmcnt(16)
s_barrier
s_add_u32 m0, s61, 24576
s_xor_b32 s6, s81, 294912
buffer_load_dwordx4 v23, s[12:15], s6 offen offset:3168 lds
buffer_load_dwordx4 v20, s[12:15], s6 offen offset:0 lds
buffer_load_dwordx4 v21, s[12:15], s6 offen offset:1056 lds
buffer_load_dwordx4 v22, s[12:15], s6 offen offset:2112 lds
s_barrier
s_add_u32 m0, s61, 59392
s_xor_b32 s6, s81, 294912
buffer_load_dwordx4 v35, s[12:15], s6 offen offset:3168 lds
buffer_load_dwordx4 v32, s[12:15], s6 offen offset:0 lds
buffer_load_dwordx4 v33, s[12:15], s6 offen offset:1056 lds
buffer_load_dwordx4 v34, s[12:15], s6 offen offset:2112 lds
s_barrier
s_add_u32 m0, s61, 146432
s_xor_b32 s6, s82, 262144
buffer_load_dwordx4 v27, s[16:19], s6 offen offset:3168 lds
buffer_load_dwordx4 v24, s[16:19], s6 offen offset:0 lds
buffer_load_dwordx4 v25, s[16:19], s6 offen offset:1056 lds
buffer_load_dwordx4 v26, s[16:19], s6 offen offset:2112 lds
s_waitcnt vmcnt(16)
s_barrier
s_add_u32 m0, s61, 76800
s_xor_b32 s6, s82, 262400
buffer_load_dwordx4 v27, s[16:19], s6 offen offset:3168 lds
buffer_load_dwordx4 v24, s[16:19], s6 offen offset:0 lds
buffer_load_dwordx4 v25, s[16:19], s6 offen offset:1056 lds
buffer_load_dwordx4 v26, s[16:19], s6 offen offset:2112 lds
s_waitcnt vmcnt(16)
s_barrier
s_add_u32 m0, s61, 111616
s_xor_b32 s6, s81, 393216
buffer_load_dwordx4 v23, s[12:15], s6 offen offset:3168 lds
buffer_load_dwordx4 v20, s[12:15], s6 offen offset:0 lds
buffer_load_dwordx4 v21, s[12:15], s6 offen offset:1056 lds
buffer_load_dwordx4 v22, s[12:15], s6 offen offset:2112 lds
s_waitcnt vmcnt(16)
s_barrier
s_add_u32 m0, s61, 7168
s_xor_b32 s6, s81, 393216
buffer_load_dwordx4 v35, s[12:15], s6 offen offset:3168 lds
buffer_load_dwordx4 v32, s[12:15], s6 offen offset:0 lds
buffer_load_dwordx4 v33, s[12:15], s6 offen offset:1056 lds
buffer_load_dwordx4 v34, s[12:15], s6 offen offset:2112 lds
s_waitcnt vmcnt(16)
s_barrier
s_add_u32 m0, s61, 41984
s_xor_b32 s6, s82, 294912
buffer_load_dwordx4 v27, s[16:19], s6 offen offset:3168 lds
buffer_load_dwordx4 v24, s[16:19], s6 offen offset:0 lds
buffer_load_dwordx4 v25, s[16:19], s6 offen offset:1056 lds
buffer_load_dwordx4 v26, s[16:19], s6 offen offset:2112 lds
s_waitcnt vmcnt(16)
s_barrier
s_add_u32 m0, s61, 24576
s_xor_b32 s6, s82, 295168
buffer_load_dwordx4 v27, s[16:19], s6 offen offset:3168 lds
buffer_load_dwordx4 v24, s[16:19], s6 offen offset:0 lds
buffer_load_dwordx4 v25, s[16:19], s6 offen offset:1056 lds
buffer_load_dwordx4 v26, s[16:19], s6 offen offset:2112 lds
s_waitcnt vmcnt(16)
s_barrier
s_add_u32 m0, s61, 59392
s_xor_b32 s6, s81, 360448
buffer_load_dwordx4 v23, s[12:15], s6 offen offset:3168 lds
buffer_load_dwordx4 v20, s[12:15], s6 offen offset:0 lds
buffer_load_dwordx4 v21, s[12:15], s6 offen offset:1056 lds
buffer_load_dwordx4 v22, s[12:15], s6 offen offset:2112 lds
s_barrier
s_add_u32 m0, s61, 146432
s_xor_b32 s6, s81, 360448
buffer_load_dwordx4 v35, s[12:15], s6 offen offset:3168 lds
buffer_load_dwordx4 v32, s[12:15], s6 offen offset:0 lds
buffer_load_dwordx4 v33, s[12:15], s6 offen offset:1056 lds
buffer_load_dwordx4 v34, s[12:15], s6 offen offset:2112 lds
s_barrier
s_add_u32 m0, s61, 76800
s_xor_b32 s6, s82, 327680
buffer_load_dwordx4 v27, s[16:19], s6 offen offset:3168 lds
buffer_load_dwordx4 v24, s[16:19], s6 offen offset:0 lds
buffer_load_dwordx4 v25, s[16:19], s6 offen offset:1056 lds
buffer_load_dwordx4 v26, s[16:19], s6 offen offset:2112 lds
s_waitcnt vmcnt(16)
s_barrier
s_add_u32 m0, s61, 94208
s_xor_b32 s6, s82, 327936
buffer_load_dwordx4 v27, s[16:19], s6 offen offset:3168 lds
buffer_load_dwordx4 v24, s[16:19], s6 offen offset:0 lds
buffer_load_dwordx4 v25, s[16:19], s6 offen offset:1056 lds
buffer_load_dwordx4 v26, s[16:19], s6 offen offset:2112 lds
s_waitcnt vmcnt(16)
s_barrier
buffer_load_dword v11, v10, s[24:27], s76 offen
v_mov_b32 v50, 0
global_load_dword v48, v50, s[0:1] sc1
global_load_dword v11, v45, s[72:73]
s_add_u32 m0, s61, 129024
s_xor_b32 s6, s81, 458752
buffer_load_dwordx4 v23, s[12:15], s6 offen offset:3168 lds
buffer_load_dwordx4 v20, s[12:15], s6 offen offset:0 lds
buffer_load_dwordx4 v21, s[12:15], s6 offen offset:1056 lds
buffer_load_dwordx4 v22, s[12:15], s6 offen offset:2112 lds
s_waitcnt vmcnt(19)
s_barrier
s_add_u32 m0, s61, 41984
s_xor_b32 s6, s81, 458752
buffer_load_dwordx4 v35, s[12:15], s6 offen offset:3168 lds
buffer_load_dwordx4 v32, s[12:15], s6 offen offset:0 lds
buffer_load_dwordx4 v33, s[12:15], s6 offen offset:1056 lds
buffer_load_dwordx4 v34, s[12:15], s6 offen offset:2112 lds
s_waitcnt vmcnt(19)
s_barrier
s_add_u32 m0, s61, 24576
s_xor_b32 s6, s82, 360448
buffer_load_dwordx4 v27, s[16:19], s6 offen offset:3168 lds
buffer_load_dwordx4 v24, s[16:19], s6 offen offset:0 lds
buffer_load_dwordx4 v25, s[16:19], s6 offen offset:1056 lds
buffer_load_dwordx4 v26, s[16:19], s6 offen offset:2112 lds
s_waitcnt vmcnt(19)
s_barrier
s_add_u32 m0, s61, 59392
s_xor_b32 s6, s82, 360704
buffer_load_dwordx4 v27, s[16:19], s6 offen offset:3168 lds
buffer_load_dwordx4 v24, s[16:19], s6 offen offset:0 lds
buffer_load_dwordx4 v25, s[16:19], s6 offen offset:1056 lds
buffer_load_dwordx4 v26, s[16:19], s6 offen offset:2112 lds
s_waitcnt vmcnt(19)
s_barrier
s_add_u32 m0, s61, 146432
s_xor_b32 s6, s81, 425984
buffer_load_dwordx4 v23, s[12:15], s6 offen offset:3168 lds
buffer_load_dwordx4 v20, s[12:15], s6 offen offset:0 lds
buffer_load_dwordx4 v21, s[12:15], s6 offen offset:1056 lds
buffer_load_dwordx4 v22, s[12:15], s6 offen offset:2112 lds
s_barrier
s_add_u32 m0, s61, 76800
s_xor_b32 s6, s81, 425984
buffer_load_dwordx4 v35, s[12:15], s6 offen offset:3168 lds
buffer_load_dwordx4 v32, s[12:15], s6 offen offset:0 lds
buffer_load_dwordx4 v33, s[12:15], s6 offen offset:1056 lds
buffer_load_dwordx4 v34, s[12:15], s6 offen offset:2112 lds
s_barrier
s_add_u32 m0, s61, 94208
s_xor_b32 s6, s82, 393216
buffer_load_dwordx4 v27, s[16:19], s6 offen offset:3168 lds
buffer_load_dwordx4 v24, s[16:19], s6 offen offset:0 lds
buffer_load_dwordx4 v25, s[16:19], s6 offen offset:1056 lds
buffer_load_dwordx4 v26, s[16:19], s6 offen offset:2112 lds
s_waitcnt vmcnt(16)
s_barrier
s_add_u32 m0, s61, 111616
s_xor_b32 s6, s82, 393472
buffer_load_dwordx4 v27, s[16:19], s6 offen offset:3168 lds
buffer_load_dwordx4 v24, s[16:19], s6 offen offset:0 lds
buffer_load_dwordx4 v25, s[16:19], s6 offen offset:1056 lds
buffer_load_dwordx4 v26, s[16:19], s6 offen offset:2112 lds
s_waitcnt vmcnt(16)
s_barrier
s_add_u32 m0, s61, 7168
s_xor_b32 s6, s82, 491520
buffer_load_dwordx4 v27, s[16:19], s6 offen offset:3168 lds
buffer_load_dwordx4 v24, s[16:19], s6 offen offset:0 lds
buffer_load_dwordx4 v25, s[16:19], s6 offen offset:1056 lds
buffer_load_dwordx4 v26, s[16:19], s6 offen offset:2112 lds
s_waitcnt vmcnt(16)
s_barrier
s_add_u32 m0, s61, 24576
s_xor_b32 s6, s82, 491776
buffer_load_dwordx4 v27, s[16:19], s6 offen offset:3168 lds
buffer_load_dwordx4 v24, s[16:19], s6 offen offset:0 lds
buffer_load_dwordx4 v25, s[16:19], s6 offen offset:1056 lds
buffer_load_dwordx4 v26, s[16:19], s6 offen offset:2112 lds
s_waitcnt vmcnt(16)
s_barrier
s_add_u32 m0, s61, 59392
s_xor_b32 s6, s82, 425984
buffer_load_dwordx4 v27, s[16:19], s6 offen offset:3168 lds
buffer_load_dwordx4 v24, s[16:19], s6 offen offset:0 lds
buffer_load_dwordx4 v25, s[16:19], s6 offen offset:1056 lds
buffer_load_dwordx4 v26, s[16:19], s6 offen offset:2112 lds
s_waitcnt vmcnt(16)
s_barrier
s_add_u32 m0, s61, 146432
s_xor_b32 s6, s82, 426240
buffer_load_dwordx4 v27, s[16:19], s6 offen offset:3168 lds
buffer_load_dwordx4 v24, s[16:19], s6 offen offset:0 lds
buffer_load_dwordx4 v25, s[16:19], s6 offen offset:1056 lds
buffer_load_dwordx4 v26, s[16:19], s6 offen offset:2112 lds
s_waitcnt vmcnt(16)
s_barrier
s_add_u32 m0, s61, 76800
s_xor_b32 s6, s81, 491520
buffer_load_dwordx4 v23, s[12:15], s6 offen offset:3168 lds
buffer_load_dwordx4 v20, s[12:15], s6 offen offset:0 lds
buffer_load_dwordx4 v21, s[12:15], s6 offen offset:1056 lds
buffer_load_dwordx4 v22, s[12:15], s6 offen offset:2112 lds
s_barrier
s_add_u32 m0, s61, 94208
s_xor_b32 s6, s81, 491520
buffer_load_dwordx4 v35, s[12:15], s6 offen offset:3168 lds
buffer_load_dwordx4 v32, s[12:15], s6 offen offset:0 lds
buffer_load_dwordx4 v33, s[12:15], s6 offen offset:1056 lds
buffer_load_dwordx4 v34, s[12:15], s6 offen offset:2112 lds
s_barrier
s_add_u32 m0, s61, 111616
s_xor_b32 s6, s82, 458752
buffer_load_dwordx4 v27, s[16:19], s6 offen offset:3168 lds
buffer_load_dwordx4 v24, s[16:19], s6 offen offset:0 lds
buffer_load_dwordx4 v25, s[16:19], s6 offen offset:1056 lds
buffer_load_dwordx4 v26, s[16:19], s6 offen offset:2112 lds
s_waitcnt vmcnt(16)
s_barrier
s_add_u32 m0, s61, 129024
s_xor_b32 s6, s82, 459008
buffer_load_dwordx4 v27, s[16:19], s6 offen offset:3168 lds
buffer_load_dwordx4 v24, s[16:19], s6 offen offset:0 lds
buffer_load_dwordx4 v25, s[16:19], s6 offen offset:1056 lds
buffer_load_dwordx4 v26, s[16:19], s6 offen offset:2112 lds
s_waitcnt vmcnt(16)
s_barrier
s_mov_b32 s84, s44
s_add_u32 s85, s84, 1
s_cmp_eq_u32 s85, 7
s_cselect_b32 s85, 0, s85
s_add_u32 s86, s85, 1
s_cmp_eq_u32 s86, 7
s_cselect_b32 s86, 0, s86
s_add_u32 s87, s86, 1
s_cmp_eq_u32 s87, 7
s_cselect_b32 s87, 0, s87
s_add_u32 s88, s87, 1
s_cmp_eq_u32 s88, 7
s_cselect_b32 s88, 0, s88
s_add_u32 s89, s88, 1
s_cmp_eq_u32 s89, 7
s_cselect_b32 s89, 0, s89
s_add_u32 s90, s89, 1
s_cmp_eq_u32 s90, 7
s_cselect_b32 s90, 0, s90
s_lshl_b32 s6, s84, 7
s_add_u32 m0, s61, 41984
s_add_u32 s6, s6, s60
buffer_load_dwordx4 v31, s[24:27], s6 offen offset:3168 lds
buffer_load_dwordx4 v28, s[24:27], s6 offen offset:0 lds
buffer_load_dwordx4 v29, s[24:27], s6 offen offset:1056 lds
buffer_load_dwordx4 v30, s[24:27], s6 offen offset:2112 lds
s_waitcnt vmcnt(16)
s_barrier
s_lshl_b32 s6, s84, 7
s_add_u32 m0, s61, 59392
s_add_u32 s6, s6, s60
s_add_u32 s6, s6, 114688
buffer_load_dwordx4 v31, s[24:27], s6 offen offset:3168 lds
buffer_load_dwordx4 v28, s[24:27], s6 offen offset:0 lds
buffer_load_dwordx4 v29, s[24:27], s6 offen offset:1056 lds
buffer_load_dwordx4 v30, s[24:27], s6 offen offset:2112 lds
s_waitcnt vmcnt(16)
s_barrier
s_lshl_b32 s6, s85, 7
s_add_u32 m0, s61, 146432
s_add_u32 s6, s6, s60
buffer_load_dwordx4 v31, s[24:27], s6 offen offset:3168 lds
buffer_load_dwordx4 v28, s[24:27], s6 offen offset:0 lds
buffer_load_dwordx4 v29, s[24:27], s6 offen offset:1056 lds
buffer_load_dwordx4 v30, s[24:27], s6 offen offset:2112 lds
s_waitcnt vmcnt(16)
s_barrier
s_lshl_b32 s6, s85, 7
s_add_u32 m0, s61, 76800
s_add_u32 s6, s6, s60
s_add_u32 s6, s6, 114688
buffer_load_dwordx4 v31, s[24:27], s6 offen offset:3168 lds
buffer_load_dwordx4 v28, s[24:27], s6 offen offset:0 lds
buffer_load_dwordx4 v29, s[24:27], s6 offen offset:1056 lds
buffer_load_dwordx4 v30, s[24:27], s6 offen offset:2112 lds
s_waitcnt vmcnt(16)
s_barrier
s_lshl_b32 s6, s86, 7
s_add_u32 m0, s61, 94208
s_add_u32 s6, s6, s60
buffer_load_dwordx4 v31, s[24:27], s6 offen offset:3168 lds
buffer_load_dwordx4 v28, s[24:27], s6 offen offset:0 lds
buffer_load_dwordx4 v29, s[24:27], s6 offen offset:1056 lds
buffer_load_dwordx4 v30, s[24:27], s6 offen offset:2112 lds
s_barrier
s_barrier
s_waitcnt vmcnt(12)
s_barrier
s_barrier
s_lshl_b32 s6, s86, 7
s_add_u32 m0, s61, 7168
s_add_u32 s6, s6, s60
s_add_u32 s6, s6, 114688
buffer_load_dwordx4 v31, s[24:27], s6 offen offset:3168 lds
buffer_load_dwordx4 v28, s[24:27], s6 offen offset:0 lds
buffer_load_dwordx4 v29, s[24:27], s6 offen offset:1056 lds
buffer_load_dwordx4 v30, s[24:27], s6 offen offset:2112 lds
s_waitcnt vmcnt(8)
s_barrier
s_lshl_b32 s6, s87, 7
s_add_u32 m0, s61, 24576
s_add_u32 s6, s6, s60
buffer_load_dwordx4 v31, s[24:27], s6 offen offset:3168 lds
buffer_load_dwordx4 v28, s[24:27], s6 offen offset:0 lds
buffer_load_dwordx4 v29, s[24:27], s6 offen offset:1056 lds
buffer_load_dwordx4 v30, s[24:27], s6 offen offset:2112 lds
s_barrier
s_lshl_b32 s6, s87, 7
s_add_u32 m0, s61, 111616
s_add_u32 s6, s6, s60
s_add_u32 s6, s6, 114688
buffer_load_dwordx4 v31, s[24:27], s6 offen offset:3168 lds
buffer_load_dwordx4 v28, s[24:27], s6 offen offset:0 lds
buffer_load_dwordx4 v29, s[24:27], s6 offen offset:1056 lds
buffer_load_dwordx4 v30, s[24:27], s6 offen offset:2112 lds
s_waitcnt vmcnt(8)
s_barrier
s_lshl_b32 s6, s88, 7
s_add_u32 m0, s61, 129024
s_add_u32 s6, s6, s60
buffer_load_dwordx4 v31, s[24:27], s6 offen offset:3168 lds
buffer_load_dwordx4 v28, s[24:27], s6 offen offset:0 lds
buffer_load_dwordx4 v29, s[24:27], s6 offen offset:1056 lds
buffer_load_dwordx4 v30, s[24:27], s6 offen offset:2112 lds
s_barrier
s_lshl_b32 s6, s88, 7
s_add_u32 m0, s61, 41984
s_add_u32 s6, s6, s60
s_add_u32 s6, s6, 114688
buffer_load_dwordx4 v31, s[24:27], s6 offen offset:3168 lds
buffer_load_dwordx4 v28, s[24:27], s6 offen offset:0 lds
buffer_load_dwordx4 v29, s[24:27], s6 offen offset:1056 lds
buffer_load_dwordx4 v30, s[24:27], s6 offen offset:2112 lds
s_waitcnt vmcnt(8)
s_barrier
s_lshl_b32 s6, s89, 7
s_add_u32 m0, s61, 59392
s_add_u32 s6, s6, s60
buffer_load_dwordx4 v31, s[24:27], s6 offen offset:3168 lds
buffer_load_dwordx4 v28, s[24:27], s6 offen offset:0 lds
buffer_load_dwordx4 v29, s[24:27], s6 offen offset:1056 lds
buffer_load_dwordx4 v30, s[24:27], s6 offen offset:2112 lds
s_barrier
s_lshl_b32 s6, s89, 7
s_add_u32 m0, s61, 76800
s_add_u32 s6, s6, s60
s_add_u32 s6, s6, 114688
buffer_load_dwordx4 v31, s[24:27], s6 offen offset:3168 lds
buffer_load_dwordx4 v28, s[24:27], s6 offen offset:0 lds
buffer_load_dwordx4 v29, s[24:27], s6 offen offset:1056 lds
buffer_load_dwordx4 v30, s[24:27], s6 offen offset:2112 lds
s_waitcnt vmcnt(8)
s_barrier
s_lshl_b32 s6, s90, 7
s_add_u32 m0, s61, 146432
s_add_u32 s6, s6, s60
buffer_load_dwordx4 v31, s[24:27], s6 offen offset:3168 lds
buffer_load_dwordx4 v28, s[24:27], s6 offen offset:0 lds
buffer_load_dwordx4 v29, s[24:27], s6 offen offset:1056 lds
buffer_load_dwordx4 v30, s[24:27], s6 offen offset:2112 lds
s_barrier
s_lshl_b32 s6, s90, 7
s_add_u32 m0, s61, 7168
s_add_u32 s6, s6, s60
s_add_u32 s6, s6, 114688
buffer_load_dwordx4 v31, s[24:27], s6 offen offset:3168 lds
buffer_load_dwordx4 v28, s[24:27], s6 offen offset:0 lds
buffer_load_dwordx4 v29, s[24:27], s6 offen offset:1056 lds
buffer_load_dwordx4 v30, s[24:27], s6 offen offset:2112 lds
s_waitcnt vmcnt(8)
s_barrier
s_barrier
s_waitcnt vmcnt(0)
s_barrier
s_barrier
s_mov_b32 s62, s45
s_branch L_reduce
.p2align 6
L_compute:
s_and_b32 s36, s3, 1
s_lshr_b32 s37, s3, 1
s_mov_b32 s38, 0x3db8aa3b
s_lshl_b32 s39, s44, 1
s_add_u32 s39, s39, s36
s_mul_i32 s39, s39, 28
s_lshl_b32 s6, s37, 1
s_add_u32 s39, s39, s6
s_lshl_b32 s39, s39, 4
s_add_u32 s39, s39, s33
s_lshl_b32 s39, s39, 10
v_and_b32 v3, 15, v2
v_lshrrev_b32 v4, 4, v2
v_bfe_u32 v5, v2, 2, 2
v_and_b32 v6, 3, v2
v_lshlrev_b32 v6, 3, v6
v_lshrrev_b32 v7, 2, v2
v_mul_u32_u24 v51, 1088, v7
s_lshl_b32 s6, s37, 8
v_lshl_add_u32 v51, v6, 1, v51
v_and_b32 v9, 1, v4
v_lshl_add_u32 v51, v9, 3, v51
v_add_u32 v51, s6, v51
v_and_b32 v7, 7, v7
v_mul_u32_u24 v61, 1056, v7
v_lshrrev_b32 v8, 5, v2
v_lshl_add_u32 v61, v8, 8, v61
s_mul_i32 s6, s37, 8448
v_add3_u32 v61, v61, v6, s6
v_mul_u32_u24 v60, 1056, v3
v_lshl_add_u32 v60, v4, 4, v60
s_lshl_b32 s6, s37, 9
v_add_u32 v60, s6, v60
v_lshrrev_b32 v9, 1, v3
v_mul_u32_u24 v52, 1056, v9
v_and_b32 v9, 1, v2
v_lshl_add_u32 v52, v9, 7, v52
v_lshl_add_u32 v52, v4, 4, v52
s_lshl_b32 s6, s36, 9
v_add_u32 v52, s6, v52
s_lshl_b32 s6, s37, 13
v_lshlrev_b32 v53, 4, v2
v_add_u32 v53, s6, v53
v_xor_b32 v54, 0x2000, v53
v_mov_b64 v[128:129], 0
v_mov_b64 v[130:131], 0
v_mov_b64 v[132:133], 0
v_mov_b64 v[134:135], 0
v_mov_b64 v[136:137], 0
v_mov_b64 v[138:139], 0
v_mov_b64 v[140:141], 0
v_mov_b64 v[142:143], 0
v_mov_b64 v[144:145], 0
v_mov_b64 v[146:147], 0
v_mov_b64 v[148:149], 0
v_mov_b64 v[150:151], 0
v_mov_b64 v[152:153], 0
v_mov_b64 v[154:155], 0
v_mov_b64 v[156:157], 0
v_mov_b64 v[158:159], 0
v_mov_b64 v[160:161], 0
v_mov_b64 v[162:163], 0
v_mov_b64 v[164:165], 0
v_mov_b64 v[166:167], 0
v_mov_b64 v[168:169], 0
v_mov_b64 v[170:171], 0
v_mov_b64 v[172:173], 0
v_mov_b64 v[174:175], 0
v_mov_b64 v[176:177], 0
v_mov_b64 v[178:179], 0
v_mov_b64 v[180:181], 0
v_mov_b64 v[182:183], 0
v_mov_b64 v[184:185], 0
v_mov_b64 v[186:187], 0
v_mov_b64 v[188:189], 0
v_mov_b64 v[190:191], 0
v_mov_b32 v63, 0
v_mov_b32 v56, s38
v_mov_b32 v57, s38
s_waitcnt lgkmcnt(0)
s_mov_b32 s0, s92
s_mov_b32 s1, s93
s_mov_b32 s28, s94
s_and_b32 s29, s95, 0xffff
s_mov_b32 s30, 0x10000000
s_mov_b32 s31, 0x20000
s_mov_b32 s96, s58
s_and_b32 s97, s59, 0xffff
s_mov_b32 s98, 0xe0000
s_mov_b32 s99, 0x20000
s_lshl_b32 s63, s44, 12
s_add_u32 s63, s63, 16777216
s_mov_b32 s41, 0x20000
s_sub_u32 s7, s44, 7
s_cmp_ge_u32 s44, 7
s_cselect_b32 s44, s7, s44
s_sub_u32 s7, s44, 7
s_cmp_ge_u32 s44, 7
s_cselect_b32 s44, s7, s44
s_add_u32 s6, s2, s3
s_cmp_lg_u32 s6, 0
s_cbranch_scc1 L_notag
s_memrealtime s[6:7]
s_waitcnt lgkmcnt(0)
s_or_b32 s6, s6, 1
v_mov_b32 v9, s6
global_store_dword v63, v9, s[0:1] sc1
L_notag:
s_mov_b32 s42, 0x41000000
s_barrier
ds_read_b32 v49, v63 offset:0
s_waitcnt lgkmcnt(0)
v_add_u32 v49, v49, v52
ds_read_b128 a[0:3], v49 offset:0
ds_read_b128 a[4:7], v49 offset:256
ds_read_b32 v58, v63 offset:4
s_waitcnt lgkmcnt(0)
v_add_u32 v62, v58, v51
ds_read_b64_tr_b16 v[32:33], v62 offset:0
ds_read_b64_tr_b16 v[34:35], v62 offset:512
ds_read_b64_tr_b16 v[36:37], v62 offset:8
ds_read_b64_tr_b16 v[38:39], v62 offset:520
ds_read_b64_tr_b16 v[40:41], v62 offset:64
ds_read_b64_tr_b16 v[42:43], v62 offset:576
ds_read_b64_tr_b16 v[44:45], v62 offset:72
ds_read_b64_tr_b16 v[46:47], v62 offset:584
ds_read_b128 a[8:11], v49 offset:64
ds_read_b128 a[12:15], v49 offset:320
ds_read_b128 a[16:19], v49 offset:8448
ds_read_b128 a[20:23], v49 offset:8704
ds_read_b128 a[24:27], v49 offset:8512
ds_read_b128 a[28:31], v49 offset:8768
s_waitcnt lgkmcnt(10)
v_mfma_f32_16x16x32_bf16 v[64:67], v[32:35], a[0:3], 0
ds_read_b32 v58, v63 offset:8
v_mfma_f32_16x16x32_bf16 v[72:75], v[32:35], a[4:7], 0
ds_read_b64_tr_b16 v[32:33], v62 offset:128
v_mfma_f32_16x16x32_bf16 v[68:71], v[36:39], a[0:3], 0
ds_read_b64_tr_b16 v[34:35], v62 offset:640
v_mfma_f32_16x16x32_bf16 v[76:79], v[36:39], a[4:7], 0
ds_read_b64_tr_b16 v[36:37], v62 offset:136
s_waitcnt lgkmcnt(10)
v_mfma_f32_16x16x32_bf16 v[80:83], v[40:43], a[0:3], 0
ds_read_b64_tr_b16 v[38:39], v62 offset:648
v_mfma_f32_16x16x32_bf16 v[88:91], v[40:43], a[4:7], 0
ds_read_b64_tr_b16 v[40:41], v62 offset:192
v_mfma_f32_16x16x32_bf16 v[84:87], v[44:47], a[0:3], 0
ds_read_b64_tr_b16 v[42:43], v62 offset:704
v_mfma_f32_16x16x32_bf16 v[92:95], v[44:47], a[4:7], 0
ds_read_b64_tr_b16 v[44:45], v62 offset:200
s_waitcnt lgkmcnt(3)
v_mfma_f32_16x16x32_bf16 v[96:99], v[32:35], a[0:3], 0
ds_read_b64_tr_b16 v[46:47], v62 offset:712
s_barrier
v_add_u32 v62, v58, v51
v_mfma_f32_16x16x32_bf16 v[104:107], v[32:35], a[4:7], 0
ds_read_b64_tr_b16 v[32:33], v62 offset:0
v_mfma_f32_16x16x32_bf16 v[100:103], v[36:39], a[0:3], 0
ds_read_b64_tr_b16 v[34:35], v62 offset:512
v_mfma_f32_16x16x32_bf16 v[108:111], v[36:39], a[4:7], 0
ds_read_b64_tr_b16 v[36:37], v62 offset:8
s_waitcnt lgkmcnt(3)
v_mfma_f32_16x16x32_bf16 v[112:115], v[40:43], a[0:3], 0
ds_read_b64_tr_b16 v[38:39], v62 offset:520
v_mfma_f32_16x16x32_bf16 v[120:123], v[40:43], a[4:7], 0
ds_read_b64_tr_b16 v[40:41], v62 offset:64
v_mfma_f32_16x16x32_bf16 v[116:119], v[44:47], a[0:3], 0
ds_read_b64_tr_b16 v[42:43], v62 offset:576
ds_read_b32 v58, v63 offset:12
v_mfma_f32_16x16x32_bf16 v[124:127], v[44:47], a[4:7], 0
ds_read_b64_tr_b16 v[44:45], v62 offset:72
s_waitcnt lgkmcnt(4)
v_mfma_f32_16x16x32_bf16 v[64:67], v[32:35], a[8:11], v[64:67]
ds_read_b64_tr_b16 v[46:47], v62 offset:584
v_mfma_f32_16x16x32_bf16 v[72:75], v[32:35], a[12:15], v[72:75]
ds_read_b64_tr_b16 v[32:33], v62 offset:128
v_mfma_f32_16x16x32_bf16 v[68:71], v[36:39], a[8:11], v[68:71]
ds_read_b64_tr_b16 v[34:35], v62 offset:640
v_mfma_f32_16x16x32_bf16 v[76:79], v[36:39], a[12:15], v[76:79]
ds_read_b64_tr_b16 v[36:37], v62 offset:136
s_waitcnt lgkmcnt(3)
v_mfma_f32_16x16x32_bf16 v[80:83], v[40:43], a[8:11], v[80:83]
ds_read_b64_tr_b16 v[38:39], v62 offset:648
v_mfma_f32_16x16x32_bf16 v[88:91], v[40:43], a[12:15], v[88:91]
ds_read_b64_tr_b16 v[40:41], v62 offset:192
v_mfma_f32_16x16x32_bf16 v[84:87], v[44:47], a[8:11], v[84:87]
ds_read_b64_tr_b16 v[42:43], v62 offset:704
v_mfma_f32_16x16x32_bf16 v[92:95], v[44:47], a[12:15], v[92:95]
ds_read_b64_tr_b16 v[44:45], v62 offset:200
s_waitcnt lgkmcnt(3)
v_mfma_f32_16x16x32_bf16 v[96:99], v[32:35], a[8:11], v[96:99]
ds_read_b64_tr_b16 v[46:47], v62 offset:712
s_barrier
v_add_u32 v62, v58, v51
v_mfma_f32_16x16x32_bf16 v[104:107], v[32:35], a[12:15], v[104:107]
ds_read_b64_tr_b16 v[32:33], v62 offset:0
v_mfma_f32_16x16x32_bf16 v[100:103], v[36:39], a[8:11], v[100:103]
ds_read_b64_tr_b16 v[34:35], v62 offset:512
v_mfma_f32_16x16x32_bf16 v[108:111], v[36:39], a[12:15], v[108:111]
ds_read_b64_tr_b16 v[36:37], v62 offset:8
s_waitcnt lgkmcnt(3)
v_mfma_f32_16x16x32_bf16 v[112:115], v[40:43], a[8:11], v[112:115]
ds_read_b64_tr_b16 v[38:39], v62 offset:520
v_mfma_f32_16x16x32_bf16 v[120:123], v[40:43], a[12:15], v[120:123]
ds_read_b64_tr_b16 v[40:41], v62 offset:64
v_mfma_f32_16x16x32_bf16 v[116:119], v[44:47], a[8:11], v[116:119]
ds_read_b64_tr_b16 v[42:43], v62 offset:576
ds_read_b32 v58, v63 offset:16
v_mfma_f32_16x16x32_bf16 v[124:127], v[44:47], a[12:15], v[124:127]
ds_read_b64_tr_b16 v[44:45], v62 offset:72
s_waitcnt lgkmcnt(4)
v_mfma_f32_16x16x32_bf16 v[64:67], v[32:35], a[16:19], v[64:67]
ds_read_b64_tr_b16 v[46:47], v62 offset:584
v_mfma_f32_16x16x32_bf16 v[72:75], v[32:35], a[20:23], v[72:75]
ds_read_b64_tr_b16 v[32:33], v62 offset:128
v_mfma_f32_16x16x32_bf16 v[68:71], v[36:39], a[16:19], v[68:71]
ds_read_b64_tr_b16 v[34:35], v62 offset:640
ds_read_b32 v49, v63 offset:20
v_mfma_f32_16x16x32_bf16 v[76:79], v[36:39], a[20:23], v[76:79]
ds_read_b64_tr_b16 v[36:37], v62 offset:136
s_waitcnt lgkmcnt(4)
v_mfma_f32_16x16x32_bf16 v[80:83], v[40:43], a[16:19], v[80:83]
ds_read_b64_tr_b16 v[38:39], v62 offset:648
v_mfma_f32_16x16x32_bf16 v[88:91], v[40:43], a[20:23], v[88:91]
ds_read_b64_tr_b16 v[40:41], v62 offset:192
v_mfma_f32_16x16x32_bf16 v[84:87], v[44:47], a[16:19], v[84:87]
ds_read_b64_tr_b16 v[42:43], v62 offset:704
v_mfma_f32_16x16x32_bf16 v[92:95], v[44:47], a[20:23], v[92:95]
ds_read_b64_tr_b16 v[44:45], v62 offset:200
s_waitcnt lgkmcnt(3)
v_mfma_f32_16x16x32_bf16 v[96:99], v[32:35], a[16:19], v[96:99]
ds_read_b64_tr_b16 v[46:47], v62 offset:712
s_barrier
v_add_u32 v62, v58, v51
v_add_u32 v49, v49, v52
v_mfma_f32_16x16x32_bf16 v[104:107], v[32:35], a[20:23], v[104:107]
ds_read_b64_tr_b16 v[32:33], v62 offset:0
ds_read_b128 a[32:35], v49 offset:0
ds_read_b128 a[36:39], v49 offset:256
v_mfma_f32_16x16x32_bf16 v[100:103], v[36:39], a[16:19], v[100:103]
ds_read_b64_tr_b16 v[34:35], v62 offset:512
ds_read_b128 a[40:43], v49 offset:64
ds_read_b128 a[44:47], v49 offset:320
v_mfma_f32_16x16x32_bf16 v[108:111], v[36:39], a[20:23], v[108:111]
ds_read_b64_tr_b16 v[36:37], v62 offset:8
s_waitcnt lgkmcnt(7)
v_mfma_f32_16x16x32_bf16 v[112:115], v[40:43], a[16:19], v[112:115]
ds_read_b64_tr_b16 v[38:39], v62 offset:520
ds_read_b128 a[48:51], v49 offset:8448
v_mfma_f32_16x16x32_bf16 v[120:123], v[40:43], a[20:23], v[120:123]
ds_read_b64_tr_b16 v[40:41], v62 offset:64
ds_read_b128 a[52:55], v49 offset:8704
v_mfma_f32_16x16x32_bf16 v[116:119], v[44:47], a[16:19], v[116:119]
ds_read_b64_tr_b16 v[42:43], v62 offset:576
ds_read_b32 v58, v63 offset:24
ds_read_b128 a[56:59], v49 offset:8512
v_mfma_f32_16x16x32_bf16 v[124:127], v[44:47], a[20:23], v[124:127]
ds_read_b64_tr_b16 v[44:45], v62 offset:72
s_waitcnt lgkmcnt(10)
ds_read_b128 a[60:63], v49 offset:8768
s_waitcnt lgkmcnt(8)
v_mfma_f32_16x16x32_bf16 v[64:67], v[32:35], a[24:27], v[64:67]
ds_read_b64_tr_b16 v[46:47], v62 offset:584
v_mfma_f32_16x16x32_bf16 v[72:75], v[32:35], a[28:31], v[72:75]
ds_read_b64_tr_b16 v[32:33], v62 offset:128
v_mfma_f32_16x16x32_bf16 v[68:71], v[36:39], a[24:27], v[68:71]
ds_read_b64_tr_b16 v[34:35], v62 offset:640
v_mfma_f32_16x16x32_bf16 v[76:79], v[36:39], a[28:31], v[76:79]
ds_read_b64_tr_b16 v[36:37], v62 offset:136
s_waitcnt lgkmcnt(3)
v_mfma_f32_16x16x32_bf16 v[80:83], v[40:43], a[24:27], v[80:83]
ds_read_b64_tr_b16 v[38:39], v62 offset:648
v_mfma_f32_16x16x32_bf16 v[88:91], v[40:43], a[28:31], v[88:91]
ds_read_b64_tr_b16 v[40:41], v62 offset:192
v_mfma_f32_16x16x32_bf16 v[84:87], v[44:47], a[24:27], v[84:87]
ds_read_b64_tr_b16 v[42:43], v62 offset:704
v_mfma_f32_16x16x32_bf16 v[92:95], v[44:47], a[28:31], v[92:95]
ds_read_b64_tr_b16 v[44:45], v62 offset:200
s_waitcnt lgkmcnt(3)
v_mfma_f32_16x16x32_bf16 v[96:99], v[32:35], a[24:27], v[96:99]
ds_read_b64_tr_b16 v[46:47], v62 offset:712
s_barrier
v_add_u32 v62, v58, v51
v_mfma_f32_16x16x32_bf16 v[104:107], v[32:35], a[28:31], v[104:107]
ds_read_b64_tr_b16 v[32:33], v62 offset:0
v_mfma_f32_16x16x32_bf16 v[100:103], v[36:39], a[24:27], v[100:103]
ds_read_b64_tr_b16 v[34:35], v62 offset:512
v_mfma_f32_16x16x32_bf16 v[108:111], v[36:39], a[28:31], v[108:111]
ds_read_b64_tr_b16 v[36:37], v62 offset:8
s_waitcnt lgkmcnt(3)
v_mfma_f32_16x16x32_bf16 v[112:115], v[40:43], a[24:27], v[112:115]
ds_read_b64_tr_b16 v[38:39], v62 offset:520
v_mfma_f32_16x16x32_bf16 v[120:123], v[40:43], a[28:31], v[120:123]
ds_read_b64_tr_b16 v[40:41], v62 offset:64
v_mfma_f32_16x16x32_bf16 v[116:119], v[44:47], a[24:27], v[116:119]
ds_read_b64_tr_b16 v[42:43], v62 offset:576
ds_read_b32 v58, v63 offset:28
v_mfma_f32_16x16x32_bf16 v[124:127], v[44:47], a[28:31], v[124:127]
ds_read_b64_tr_b16 v[44:45], v62 offset:72
s_waitcnt lgkmcnt(4)
v_mfma_f32_16x16x32_bf16 v[64:67], v[32:35], a[32:35], v[64:67]
ds_read_b64_tr_b16 v[46:47], v62 offset:584
v_mfma_f32_16x16x32_bf16 v[72:75], v[32:35], a[36:39], v[72:75]
ds_read_b64_tr_b16 v[32:33], v62 offset:128
v_mfma_f32_16x16x32_bf16 v[68:71], v[36:39], a[32:35], v[68:71]
ds_read_b64_tr_b16 v[34:35], v62 offset:640
v_mfma_f32_16x16x32_bf16 v[76:79], v[36:39], a[36:39], v[76:79]
ds_read_b64_tr_b16 v[36:37], v62 offset:136
s_waitcnt lgkmcnt(3)
v_mfma_f32_16x16x32_bf16 v[80:83], v[40:43], a[32:35], v[80:83]
ds_read_b64_tr_b16 v[38:39], v62 offset:648
v_mfma_f32_16x16x32_bf16 v[88:91], v[40:43], a[36:39], v[88:91]
ds_read_b64_tr_b16 v[40:41], v62 offset:192
v_mfma_f32_16x16x32_bf16 v[84:87], v[44:47], a[32:35], v[84:87]
ds_read_b64_tr_b16 v[42:43], v62 offset:704
v_mfma_f32_16x16x32_bf16 v[92:95], v[44:47], a[36:39], v[92:95]
ds_read_b64_tr_b16 v[44:45], v62 offset:200
s_waitcnt lgkmcnt(3)
v_mfma_f32_16x16x32_bf16 v[96:99], v[32:35], a[32:35], v[96:99]
ds_read_b64_tr_b16 v[46:47], v62 offset:712
s_barrier
v_add_u32 v62, v58, v51
v_mfma_f32_16x16x32_bf16 v[104:107], v[32:35], a[36:39], v[104:107]
ds_read_b64_tr_b16 v[32:33], v62 offset:0
v_mfma_f32_16x16x32_bf16 v[100:103], v[36:39], a[32:35], v[100:103]
ds_read_b64_tr_b16 v[34:35], v62 offset:512
v_mfma_f32_16x16x32_bf16 v[108:111], v[36:39], a[36:39], v[108:111]
ds_read_b64_tr_b16 v[36:37], v62 offset:8
s_waitcnt lgkmcnt(3)
v_mfma_f32_16x16x32_bf16 v[112:115], v[40:43], a[32:35], v[112:115]
ds_read_b64_tr_b16 v[38:39], v62 offset:520
v_mfma_f32_16x16x32_bf16 v[120:123], v[40:43], a[36:39], v[120:123]
ds_read_b64_tr_b16 v[40:41], v62 offset:64
v_mfma_f32_16x16x32_bf16 v[116:119], v[44:47], a[32:35], v[116:119]
ds_read_b64_tr_b16 v[42:43], v62 offset:576
ds_read_b32 v58, v63 offset:32
v_mfma_f32_16x16x32_bf16 v[124:127], v[44:47], a[36:39], v[124:127]
ds_read_b64_tr_b16 v[44:45], v62 offset:72
s_waitcnt lgkmcnt(4)
v_mfma_f32_16x16x32_bf16 v[64:67], v[32:35], a[40:43], v[64:67]
ds_read_b64_tr_b16 v[46:47], v62 offset:584
v_mfma_f32_16x16x32_bf16 v[72:75], v[32:35], a[44:47], v[72:75]
ds_read_b64_tr_b16 v[32:33], v62 offset:128
v_mfma_f32_16x16x32_bf16 v[68:71], v[36:39], a[40:43], v[68:71]
ds_read_b64_tr_b16 v[34:35], v62 offset:640
v_mfma_f32_16x16x32_bf16 v[76:79], v[36:39], a[44:47], v[76:79]
ds_read_b64_tr_b16 v[36:37], v62 offset:136
s_waitcnt lgkmcnt(3)
v_mfma_f32_16x16x32_bf16 v[80:83], v[40:43], a[40:43], v[80:83]
ds_read_b64_tr_b16 v[38:39], v62 offset:648
v_mfma_f32_16x16x32_bf16 v[88:91], v[40:43], a[44:47], v[88:91]
ds_read_b64_tr_b16 v[40:41], v62 offset:192
v_mfma_f32_16x16x32_bf16 v[84:87], v[44:47], a[40:43], v[84:87]
ds_read_b64_tr_b16 v[42:43], v62 offset:704
v_mfma_f32_16x16x32_bf16 v[92:95], v[44:47], a[44:47], v[92:95]
ds_read_b64_tr_b16 v[44:45], v62 offset:200
s_waitcnt lgkmcnt(3)
v_mfma_f32_16x16x32_bf16 v[96:99], v[32:35], a[40:43], v[96:99]
ds_read_b64_tr_b16 v[46:47], v62 offset:712
s_barrier
v_add_u32 v62, v58, v51
v_mfma_f32_16x16x32_bf16 v[104:107], v[32:35], a[44:47], v[104:107]
ds_read_b64_tr_b16 v[32:33], v62 offset:0
v_mfma_f32_16x16x32_bf16 v[100:103], v[36:39], a[40:43], v[100:103]
ds_read_b64_tr_b16 v[34:35], v62 offset:512
v_mfma_f32_16x16x32_bf16 v[108:111], v[36:39], a[44:47], v[108:111]
ds_read_b64_tr_b16 v[36:37], v62 offset:8
s_waitcnt lgkmcnt(3)
v_mfma_f32_16x16x32_bf16 v[112:115], v[40:43], a[40:43], v[112:115]
ds_read_b64_tr_b16 v[38:39], v62 offset:520
v_mfma_f32_16x16x32_bf16 v[120:123], v[40:43], a[44:47], v[120:123]
ds_read_b64_tr_b16 v[40:41], v62 offset:64
v_mfma_f32_16x16x32_bf16 v[116:119], v[44:47], a[40:43], v[116:119]
ds_read_b64_tr_b16 v[42:43], v62 offset:576
ds_read_b32 v58, v63 offset:36
v_mfma_f32_16x16x32_bf16 v[124:127], v[44:47], a[44:47], v[124:127]
ds_read_b64_tr_b16 v[44:45], v62 offset:72
s_waitcnt lgkmcnt(4)
v_mfma_f32_16x16x32_bf16 v[64:67], v[32:35], a[48:51], v[64:67]
ds_read_b64_tr_b16 v[46:47], v62 offset:584
v_mfma_f32_16x16x32_bf16 v[72:75], v[32:35], a[52:55], v[72:75]
ds_read_b64_tr_b16 v[32:33], v62 offset:128
v_mfma_f32_16x16x32_bf16 v[68:71], v[36:39], a[48:51], v[68:71]
ds_read_b64_tr_b16 v[34:35], v62 offset:640
ds_read_b32 v49, v63 offset:40
v_mfma_f32_16x16x32_bf16 v[76:79], v[36:39], a[52:55], v[76:79]
ds_read_b64_tr_b16 v[36:37], v62 offset:136
s_waitcnt lgkmcnt(4)
v_mfma_f32_16x16x32_bf16 v[80:83], v[40:43], a[48:51], v[80:83]
ds_read_b64_tr_b16 v[38:39], v62 offset:648
v_mfma_f32_16x16x32_bf16 v[88:91], v[40:43], a[52:55], v[88:91]
ds_read_b64_tr_b16 v[40:41], v62 offset:192
v_mfma_f32_16x16x32_bf16 v[84:87], v[44:47], a[48:51], v[84:87]
ds_read_b64_tr_b16 v[42:43], v62 offset:704
v_mfma_f32_16x16x32_bf16 v[92:95], v[44:47], a[52:55], v[92:95]
ds_read_b64_tr_b16 v[44:45], v62 offset:200
s_waitcnt lgkmcnt(3)
v_mfma_f32_16x16x32_bf16 v[96:99], v[32:35], a[48:51], v[96:99]
ds_read_b64_tr_b16 v[46:47], v62 offset:712
s_barrier
v_add_u32 v62, v58, v51
v_add_u32 v49, v49, v52
v_mfma_f32_16x16x32_bf16 v[104:107], v[32:35], a[52:55], v[104:107]
ds_read_b64_tr_b16 v[32:33], v62 offset:0
ds_read_b128 a[0:3], v49 offset:0
ds_read_b128 a[4:7], v49 offset:256
v_mfma_f32_16x16x32_bf16 v[100:103], v[36:39], a[48:51], v[100:103]
ds_read_b64_tr_b16 v[34:35], v62 offset:512
ds_read_b128 a[8:11], v49 offset:64
ds_read_b128 a[12:15], v49 offset:320
v_mfma_f32_16x16x32_bf16 v[108:111], v[36:39], a[52:55], v[108:111]
ds_read_b64_tr_b16 v[36:37], v62 offset:8
s_waitcnt lgkmcnt(7)
v_mfma_f32_16x16x32_bf16 v[112:115], v[40:43], a[48:51], v[112:115]
ds_read_b64_tr_b16 v[38:39], v62 offset:520
ds_read_b128 a[16:19], v49 offset:8448
v_mfma_f32_16x16x32_bf16 v[120:123], v[40:43], a[52:55], v[120:123]
ds_read_b64_tr_b16 v[40:41], v62 offset:64
ds_read_b128 a[20:23], v49 offset:8704
v_mfma_f32_16x16x32_bf16 v[116:119], v[44:47], a[48:51], v[116:119]
ds_read_b64_tr_b16 v[42:43], v62 offset:576
ds_read_b32 v58, v63 offset:44
ds_read_b128 a[24:27], v49 offset:8512
v_mfma_f32_16x16x32_bf16 v[124:127], v[44:47], a[52:55], v[124:127]
ds_read_b64_tr_b16 v[44:45], v62 offset:72
s_waitcnt lgkmcnt(10)
ds_read_b128 a[28:31], v49 offset:8768
s_waitcnt lgkmcnt(8)
v_mfma_f32_16x16x32_bf16 v[64:67], v[32:35], a[56:59], v[64:67]
ds_read_b64_tr_b16 v[46:47], v62 offset:584
v_mfma_f32_16x16x32_bf16 v[72:75], v[32:35], a[60:63], v[72:75]
ds_read_b64_tr_b16 v[32:33], v62 offset:128
v_mfma_f32_16x16x32_bf16 v[68:71], v[36:39], a[56:59], v[68:71]
ds_read_b64_tr_b16 v[34:35], v62 offset:640
v_mfma_f32_16x16x32_bf16 v[76:79], v[36:39], a[60:63], v[76:79]
ds_read_b64_tr_b16 v[36:37], v62 offset:136
s_waitcnt lgkmcnt(3)
v_mfma_f32_16x16x32_bf16 v[80:83], v[40:43], a[56:59], v[80:83]
ds_read_b64_tr_b16 v[38:39], v62 offset:648
v_mfma_f32_16x16x32_bf16 v[88:91], v[40:43], a[60:63], v[88:91]
ds_read_b64_tr_b16 v[40:41], v62 offset:192
v_mfma_f32_16x16x32_bf16 v[84:87], v[44:47], a[56:59], v[84:87]
ds_read_b64_tr_b16 v[42:43], v62 offset:704
v_mfma_f32_16x16x32_bf16 v[92:95], v[44:47], a[60:63], v[92:95]
ds_read_b64_tr_b16 v[44:45], v62 offset:200
s_waitcnt lgkmcnt(3)
v_mfma_f32_16x16x32_bf16 v[96:99], v[32:35], a[56:59], v[96:99]
ds_read_b64_tr_b16 v[46:47], v62 offset:712
s_barrier
v_add_u32 v62, v58, v51
v_mfma_f32_16x16x32_bf16 v[104:107], v[32:35], a[60:63], v[104:107]
ds_read_b64_tr_b16 v[32:33], v62 offset:0
v_mfma_f32_16x16x32_bf16 v[100:103], v[36:39], a[56:59], v[100:103]
ds_read_b64_tr_b16 v[34:35], v62 offset:512
v_mfma_f32_16x16x32_bf16 v[108:111], v[36:39], a[60:63], v[108:111]
ds_read_b64_tr_b16 v[36:37], v62 offset:8
s_waitcnt lgkmcnt(3)
v_mfma_f32_16x16x32_bf16 v[112:115], v[40:43], a[56:59], v[112:115]
ds_read_b64_tr_b16 v[38:39], v62 offset:520
v_mfma_f32_16x16x32_bf16 v[120:123], v[40:43], a[60:63], v[120:123]
ds_read_b64_tr_b16 v[40:41], v62 offset:64
v_mfma_f32_16x16x32_bf16 v[116:119], v[44:47], a[56:59], v[116:119]
ds_read_b64_tr_b16 v[42:43], v62 offset:576
ds_read_b32 v58, v63 offset:48
v_mfma_f32_16x16x32_bf16 v[124:127], v[44:47], a[60:63], v[124:127]
ds_read_b64_tr_b16 v[44:45], v62 offset:72
s_waitcnt lgkmcnt(4)
v_mfma_f32_16x16x32_bf16 v[64:67], v[32:35], a[0:3], v[64:67]
ds_read_b64_tr_b16 v[46:47], v62 offset:584
v_mfma_f32_16x16x32_bf16 v[72:75], v[32:35], a[4:7], v[72:75]
ds_read_b64_tr_b16 v[32:33], v62 offset:128
v_mfma_f32_16x16x32_bf16 v[68:71], v[36:39], a[0:3], v[68:71]
ds_read_b64_tr_b16 v[34:35], v62 offset:640
v_mfma_f32_16x16x32_bf16 v[76:79], v[36:39], a[4:7], v[76:79]
ds_read_b64_tr_b16 v[36:37], v62 offset:136
s_waitcnt lgkmcnt(3)
v_mfma_f32_16x16x32_bf16 v[80:83], v[40:43], a[0:3], v[80:83]
ds_read_b64_tr_b16 v[38:39], v62 offset:648
v_mfma_f32_16x16x32_bf16 v[88:91], v[40:43], a[4:7], v[88:91]
ds_read_b64_tr_b16 v[40:41], v62 offset:192
v_mfma_f32_16x16x32_bf16 v[84:87], v[44:47], a[0:3], v[84:87]
ds_read_b64_tr_b16 v[42:43], v62 offset:704
v_mfma_f32_16x16x32_bf16 v[92:95], v[44:47], a[4:7], v[92:95]
ds_read_b64_tr_b16 v[44:45], v62 offset:200
s_waitcnt lgkmcnt(3)
v_mfma_f32_16x16x32_bf16 v[96:99], v[32:35], a[0:3], v[96:99]
ds_read_b64_tr_b16 v[46:47], v62 offset:712
s_barrier
v_add_u32 v62, v58, v51
v_mfma_f32_16x16x32_bf16 v[104:107], v[32:35], a[4:7], v[104:107]
ds_read_b64_tr_b16 v[32:33], v62 offset:0
v_mfma_f32_16x16x32_bf16 v[100:103], v[36:39], a[0:3], v[100:103]
ds_read_b64_tr_b16 v[34:35], v62 offset:512
v_mfma_f32_16x16x32_bf16 v[108:111], v[36:39], a[4:7], v[108:111]
ds_read_b64_tr_b16 v[36:37], v62 offset:8
s_waitcnt lgkmcnt(3)
v_mfma_f32_16x16x32_bf16 v[112:115], v[40:43], a[0:3], v[112:115]
ds_read_b64_tr_b16 v[38:39], v62 offset:520
v_mfma_f32_16x16x32_bf16 v[120:123], v[40:43], a[4:7], v[120:123]
ds_read_b64_tr_b16 v[40:41], v62 offset:64
v_mfma_f32_16x16x32_bf16 v[116:119], v[44:47], a[0:3], v[116:119]
ds_read_b64_tr_b16 v[42:43], v62 offset:576
ds_read_b32 v58, v63 offset:52
v_mfma_f32_16x16x32_bf16 v[124:127], v[44:47], a[4:7], v[124:127]
ds_read_b64_tr_b16 v[44:45], v62 offset:72
s_waitcnt lgkmcnt(4)
v_mfma_f32_16x16x32_bf16 v[64:67], v[32:35], a[8:11], v[64:67]
ds_read_b64_tr_b16 v[46:47], v62 offset:584
v_mfma_f32_16x16x32_bf16 v[72:75], v[32:35], a[12:15], v[72:75]
ds_read_b64_tr_b16 v[32:33], v62 offset:128
v_mfma_f32_16x16x32_bf16 v[68:71], v[36:39], a[8:11], v[68:71]
ds_read_b64_tr_b16 v[34:35], v62 offset:640
v_mfma_f32_16x16x32_bf16 v[76:79], v[36:39], a[12:15], v[76:79]
ds_read_b64_tr_b16 v[36:37], v62 offset:136
s_waitcnt lgkmcnt(3)
v_mfma_f32_16x16x32_bf16 v[80:83], v[40:43], a[8:11], v[80:83]
ds_read_b64_tr_b16 v[38:39], v62 offset:648
v_mfma_f32_16x16x32_bf16 v[88:91], v[40:43], a[12:15], v[88:91]
ds_read_b64_tr_b16 v[40:41], v62 offset:192
v_mfma_f32_16x16x32_bf16 v[84:87], v[44:47], a[8:11], v[84:87]
ds_read_b64_tr_b16 v[42:43], v62 offset:704
v_mfma_f32_16x16x32_bf16 v[92:95], v[44:47], a[12:15], v[92:95]
ds_read_b64_tr_b16 v[44:45], v62 offset:200
s_waitcnt lgkmcnt(3)
v_mfma_f32_16x16x32_bf16 v[96:99], v[32:35], a[8:11], v[96:99]
ds_read_b64_tr_b16 v[46:47], v62 offset:712
s_barrier
v_add_u32 v62, v58, v51
v_mfma_f32_16x16x32_bf16 v[104:107], v[32:35], a[12:15], v[104:107]
ds_read_b64_tr_b16 v[32:33], v62 offset:0
v_mfma_f32_16x16x32_bf16 v[100:103], v[36:39], a[8:11], v[100:103]
ds_read_b64_tr_b16 v[34:35], v62 offset:512
v_mfma_f32_16x16x32_bf16 v[108:111], v[36:39], a[12:15], v[108:111]
ds_read_b64_tr_b16 v[36:37], v62 offset:8
s_waitcnt lgkmcnt(3)
v_mfma_f32_16x16x32_bf16 v[112:115], v[40:43], a[8:11], v[112:115]
ds_read_b64_tr_b16 v[38:39], v62 offset:520
v_mfma_f32_16x16x32_bf16 v[120:123], v[40:43], a[12:15], v[120:123]
ds_read_b64_tr_b16 v[40:41], v62 offset:64
v_mfma_f32_16x16x32_bf16 v[116:119], v[44:47], a[8:11], v[116:119]
ds_read_b64_tr_b16 v[42:43], v62 offset:576
ds_read_b32 v58, v63 offset:56
v_mfma_f32_16x16x32_bf16 v[124:127], v[44:47], a[12:15], v[124:127]
ds_read_b64_tr_b16 v[44:45], v62 offset:72
s_waitcnt lgkmcnt(4)
v_mfma_f32_16x16x32_bf16 v[64:67], v[32:35], a[16:19], v[64:67]
ds_read_b64_tr_b16 v[46:47], v62 offset:584
v_mfma_f32_16x16x32_bf16 v[72:75], v[32:35], a[20:23], v[72:75]
ds_read_b64_tr_b16 v[32:33], v62 offset:128
v_mfma_f32_16x16x32_bf16 v[68:71], v[36:39], a[16:19], v[68:71]
ds_read_b64_tr_b16 v[34:35], v62 offset:640
ds_read_b32 v49, v63 offset:60
v_mfma_f32_16x16x32_bf16 v[76:79], v[36:39], a[20:23], v[76:79]
ds_read_b64_tr_b16 v[36:37], v62 offset:136
s_waitcnt lgkmcnt(4)
v_mfma_f32_16x16x32_bf16 v[80:83], v[40:43], a[16:19], v[80:83]
ds_read_b64_tr_b16 v[38:39], v62 offset:648
v_mfma_f32_16x16x32_bf16 v[88:91], v[40:43], a[20:23], v[88:91]
ds_read_b64_tr_b16 v[40:41], v62 offset:192
v_mfma_f32_16x16x32_bf16 v[84:87], v[44:47], a[16:19], v[84:87]
ds_read_b64_tr_b16 v[42:43], v62 offset:704
v_mfma_f32_16x16x32_bf16 v[92:95], v[44:47], a[20:23], v[92:95]
ds_read_b64_tr_b16 v[44:45], v62 offset:200
s_waitcnt lgkmcnt(3)
v_mfma_f32_16x16x32_bf16 v[96:99], v[32:35], a[16:19], v[96:99]
ds_read_b64_tr_b16 v[46:47], v62 offset:712
s_barrier
v_add_u32 v62, v58, v51
v_add_u32 v49, v49, v52
v_mfma_f32_16x16x32_bf16 v[104:107], v[32:35], a[20:23], v[104:107]
ds_read_b64_tr_b16 v[32:33], v62 offset:0
ds_read_b128 a[32:35], v49 offset:0
ds_read_b128 a[36:39], v49 offset:256
v_mfma_f32_16x16x32_bf16 v[100:103], v[36:39], a[16:19], v[100:103]
ds_read_b64_tr_b16 v[34:35], v62 offset:512
ds_read_b128 a[40:43], v49 offset:64
ds_read_b128 a[44:47], v49 offset:320
v_mfma_f32_16x16x32_bf16 v[108:111], v[36:39], a[20:23], v[108:111]
ds_read_b64_tr_b16 v[36:37], v62 offset:8
s_waitcnt lgkmcnt(7)
v_mfma_f32_16x16x32_bf16 v[112:115], v[40:43], a[16:19], v[112:115]
ds_read_b64_tr_b16 v[38:39], v62 offset:520
v_mfma_f32_16x16x32_bf16 v[120:123], v[40:43], a[20:23], v[120:123]
ds_read_b64_tr_b16 v[40:41], v62 offset:64
v_mfma_f32_16x16x32_bf16 v[116:119], v[44:47], a[16:19], v[116:119]
ds_read_b64_tr_b16 v[42:43], v62 offset:576
ds_read_b32 v58, v63 offset:64
v_mfma_f32_16x16x32_bf16 v[124:127], v[44:47], a[20:23], v[124:127]
ds_read_b64_tr_b16 v[44:45], v62 offset:72
s_waitcnt lgkmcnt(4)
v_mfma_f32_16x16x32_bf16 v[64:67], v[32:35], a[24:27], v[64:67]
ds_read_b64_tr_b16 v[46:47], v62 offset:584
v_mfma_f32_16x16x32_bf16 v[72:75], v[32:35], a[28:31], v[72:75]
ds_read_b64_tr_b16 v[32:33], v62 offset:128
v_mfma_f32_16x16x32_bf16 v[68:71], v[36:39], a[24:27], v[68:71]
ds_read_b64_tr_b16 v[34:35], v62 offset:640
v_mfma_f32_16x16x32_bf16 v[76:79], v[36:39], a[28:31], v[76:79]
ds_read_b64_tr_b16 v[36:37], v62 offset:136
s_waitcnt lgkmcnt(3)
v_mfma_f32_16x16x32_bf16 v[80:83], v[40:43], a[24:27], v[80:83]
ds_read_b64_tr_b16 v[38:39], v62 offset:648
v_mfma_f32_16x16x32_bf16 v[88:91], v[40:43], a[28:31], v[88:91]
ds_read_b64_tr_b16 v[40:41], v62 offset:192
v_mfma_f32_16x16x32_bf16 v[84:87], v[44:47], a[24:27], v[84:87]
ds_read_b64_tr_b16 v[42:43], v62 offset:704
v_mfma_f32_16x16x32_bf16 v[92:95], v[44:47], a[28:31], v[92:95]
ds_read_b64_tr_b16 v[44:45], v62 offset:200
s_waitcnt lgkmcnt(3)
v_mfma_f32_16x16x32_bf16 v[96:99], v[32:35], a[24:27], v[96:99]
ds_read_b64_tr_b16 v[46:47], v62 offset:712
s_barrier
v_add_u32 v62, v58, v51
v_mfma_f32_16x16x32_bf16 v[104:107], v[32:35], a[28:31], v[104:107]
ds_read_b64_tr_b16 v[32:33], v62 offset:0
v_mfma_f32_16x16x32_bf16 v[100:103], v[36:39], a[24:27], v[100:103]
ds_read_b64_tr_b16 v[34:35], v62 offset:512
v_mfma_f32_16x16x32_bf16 v[108:111], v[36:39], a[28:31], v[108:111]
ds_read_b64_tr_b16 v[36:37], v62 offset:8
s_waitcnt lgkmcnt(3)
v_mfma_f32_16x16x32_bf16 v[112:115], v[40:43], a[24:27], v[112:115]
ds_read_b64_tr_b16 v[38:39], v62 offset:520
v_mfma_f32_16x16x32_bf16 v[120:123], v[40:43], a[28:31], v[120:123]
ds_read_b64_tr_b16 v[40:41], v62 offset:64
v_mfma_f32_16x16x32_bf16 v[116:119], v[44:47], a[24:27], v[116:119]
ds_read_b64_tr_b16 v[42:43], v62 offset:576
ds_read_b32 v58, v63 offset:68
v_mfma_f32_16x16x32_bf16 v[124:127], v[44:47], a[28:31], v[124:127]
ds_read_b64_tr_b16 v[44:45], v62 offset:72
s_waitcnt lgkmcnt(4)
v_mfma_f32_16x16x32_bf16 v[64:67], v[32:35], a[32:35], v[64:67]
ds_read_b64_tr_b16 v[46:47], v62 offset:584
v_mfma_f32_16x16x32_bf16 v[72:75], v[32:35], a[36:39], v[72:75]
ds_read_b64_tr_b16 v[32:33], v62 offset:128
v_mfma_f32_16x16x32_bf16 v[68:71], v[36:39], a[32:35], v[68:71]
ds_read_b64_tr_b16 v[34:35], v62 offset:640
v_mfma_f32_16x16x32_bf16 v[76:79], v[36:39], a[36:39], v[76:79]
ds_read_b64_tr_b16 v[36:37], v62 offset:136
s_waitcnt lgkmcnt(3)
v_mfma_f32_16x16x32_bf16 v[80:83], v[40:43], a[32:35], v[80:83]
ds_read_b64_tr_b16 v[38:39], v62 offset:648
v_mfma_f32_16x16x32_bf16 v[88:91], v[40:43], a[36:39], v[88:91]
ds_read_b64_tr_b16 v[40:41], v62 offset:192
v_mfma_f32_16x16x32_bf16 v[84:87], v[44:47], a[32:35], v[84:87]
ds_read_b64_tr_b16 v[42:43], v62 offset:704
v_mfma_f32_16x16x32_bf16 v[92:95], v[44:47], a[36:39], v[92:95]
ds_read_b64_tr_b16 v[44:45], v62 offset:200
s_waitcnt lgkmcnt(3)
v_mfma_f32_16x16x32_bf16 v[96:99], v[32:35], a[32:35], v[96:99]
ds_read_b64_tr_b16 v[46:47], v62 offset:712
s_barrier
v_add_u32 v62, v58, v51
v_mfma_f32_16x16x32_bf16 v[104:107], v[32:35], a[36:39], v[104:107]
ds_read_b64_tr_b16 v[32:33], v62 offset:0
v_mfma_f32_16x16x32_bf16 v[100:103], v[36:39], a[32:35], v[100:103]
ds_read_b64_tr_b16 v[34:35], v62 offset:512
v_mfma_f32_16x16x32_bf16 v[108:111], v[36:39], a[36:39], v[108:111]
ds_read_b64_tr_b16 v[36:37], v62 offset:8
s_waitcnt lgkmcnt(3)
v_mfma_f32_16x16x32_bf16 v[112:115], v[40:43], a[32:35], v[112:115]
ds_read_b64_tr_b16 v[38:39], v62 offset:520
v_mfma_f32_16x16x32_bf16 v[120:123], v[40:43], a[36:39], v[120:123]
ds_read_b64_tr_b16 v[40:41], v62 offset:64
v_mfma_f32_16x16x32_bf16 v[116:119], v[44:47], a[32:35], v[116:119]
ds_read_b64_tr_b16 v[42:43], v62 offset:576
ds_read_b64 v[58:59], v63 offset:80
v_mfma_f32_16x16x32_bf16 v[124:127], v[44:47], a[36:39], v[124:127]
ds_read_b64_tr_b16 v[44:45], v62 offset:72
s_waitcnt lgkmcnt(4)
v_mfma_f32_16x16x32_bf16 v[64:67], v[32:35], a[40:43], v[64:67]
ds_read_b64_tr_b16 v[46:47], v62 offset:584
v_mfma_f32_16x16x32_bf16 v[72:75], v[32:35], a[44:47], v[72:75]
ds_read_b64_tr_b16 v[32:33], v62 offset:128
v_mfma_f32_16x16x32_bf16 v[68:71], v[36:39], a[40:43], v[68:71]
ds_read_b64_tr_b16 v[34:35], v62 offset:640
v_mfma_f32_16x16x32_bf16 v[76:79], v[36:39], a[44:47], v[76:79]
ds_read_b64_tr_b16 v[36:37], v62 offset:136
s_waitcnt lgkmcnt(3)
v_mfma_f32_16x16x32_bf16 v[80:83], v[40:43], a[40:43], v[80:83]
ds_read_b64_tr_b16 v[38:39], v62 offset:648
v_mfma_f32_16x16x32_bf16 v[88:91], v[40:43], a[44:47], v[88:91]
ds_read_b64_tr_b16 v[40:41], v62 offset:192
v_mfma_f32_16x16x32_bf16 v[84:87], v[44:47], a[40:43], v[84:87]
ds_read_b64_tr_b16 v[42:43], v62 offset:704
s_lshl_b32 s6, s36, 2
v_mov_b32 v48, s6
v_mfma_f32_16x16x32_bf16 v[92:95], v[44:47], a[44:47], v[92:95]
ds_read_b64_tr_b16 v[44:45], v62 offset:200
s_waitcnt lgkmcnt(3)
v_mfma_f32_16x16x32_bf16 v[96:99], v[32:35], a[40:43], v[96:99]
ds_read_b64_tr_b16 v[46:47], v62 offset:712
s_barrier
v_add_u32 v62, v58, v60
v_mfma_f32_16x16x32_bf16 v[104:107], v[32:35], a[44:47], v[104:107]
ds_read_b128 v[32:35], v62 offset:0
ds_read_b32 v49, v48 offset:72
v_mfma_f32_16x16x32_bf16 v[100:103], v[36:39], a[40:43], v[100:103]
ds_read_b128 v[16:19], v62 offset:128
v_mfma_f32_16x16x32_bf16 v[108:111], v[36:39], a[44:47], v[108:111]
ds_read_b128 v[36:39], v62 offset:256
s_waitcnt lgkmcnt(4)
v_mfma_f32_16x16x32_bf16 v[112:115], v[40:43], a[40:43], v[112:115]
ds_read_b128 v[20:23], v62 offset:384
s_waitcnt lgkmcnt(3)
v_add_u32 v53, v49, v53
v_mfma_f32_16x16x32_bf16 v[120:123], v[40:43], a[44:47], v[120:123]
ds_read_b128 v[40:43], v62 offset:64
v_add_u32 v54, v49, v54
v_mfma_f32_16x16x32_bf16 v[116:119], v[44:47], a[40:43], v[116:119]
ds_read_b128 v[24:27], v62 offset:192
v_mfma_f32_16x16x32_bf16 v[124:127], v[44:47], a[44:47], v[124:127]
ds_read_b128 v[44:47], v62 offset:320
ds_read_b128 v[28:31], v62 offset:448
v_pk_mul_f32 v[64:65], v[64:65], v[56:57]
v_pk_mul_f32 v[66:67], v[66:67], v[56:57]
v_pk_mul_f32 v[68:69], v[68:69], v[56:57]
v_pk_mul_f32 v[70:71], v[70:71], v[56:57]
v_cvt_pk_bf16_f32 v64, v64, v65
v_cvt_pk_bf16_f32 v65, v66, v67
v_cvt_pk_bf16_f32 v66, v68, v69
v_cvt_pk_bf16_f32 v67, v70, v71
ds_write_b128 v53, v[64:67] offset:0
v_pk_mul_f32 v[72:73], v[72:73], v[56:57]
v_pk_mul_f32 v[74:75], v[74:75], v[56:57]
v_pk_mul_f32 v[76:77], v[76:77], v[56:57]
v_pk_mul_f32 v[78:79], v[78:79], v[56:57]
v_cvt_pk_bf16_f32 v68, v72, v73
v_cvt_pk_bf16_f32 v69, v74, v75
v_cvt_pk_bf16_f32 v70, v76, v77
v_cvt_pk_bf16_f32 v71, v78, v79
ds_write_b128 v53, v[68:71] offset:1024
v_pk_mul_f32 v[80:81], v[80:81], v[56:57]
v_pk_mul_f32 v[82:83], v[82:83], v[56:57]
v_pk_mul_f32 v[84:85], v[84:85], v[56:57]
v_pk_mul_f32 v[86:87], v[86:87], v[56:57]
v_cvt_pk_bf16_f32 v72, v80, v81
v_cvt_pk_bf16_f32 v73, v82, v83
v_cvt_pk_bf16_f32 v74, v84, v85
v_cvt_pk_bf16_f32 v75, v86, v87
ds_write_b128 v53, v[72:75] offset:2048
v_pk_mul_f32 v[88:89], v[88:89], v[56:57]
v_pk_mul_f32 v[90:91], v[90:91], v[56:57]
v_pk_mul_f32 v[92:93], v[92:93], v[56:57]
v_pk_mul_f32 v[94:95], v[94:95], v[56:57]
v_cvt_pk_bf16_f32 v76, v88, v89
v_cvt_pk_bf16_f32 v77, v90, v91
v_cvt_pk_bf16_f32 v78, v92, v93
v_cvt_pk_bf16_f32 v79, v94, v95
ds_write_b128 v53, v[76:79] offset:3072
v_pk_mul_f32 v[96:97], v[96:97], v[56:57]
v_pk_mul_f32 v[98:99], v[98:99], v[56:57]
v_pk_mul_f32 v[100:101], v[100:101], v[56:57]
v_pk_mul_f32 v[102:103], v[102:103], v[56:57]
v_cvt_pk_bf16_f32 v80, v96, v97
v_cvt_pk_bf16_f32 v81, v98, v99
v_cvt_pk_bf16_f32 v82, v100, v101
v_cvt_pk_bf16_f32 v83, v102, v103
ds_write_b128 v53, v[80:83] offset:4096
v_pk_mul_f32 v[104:105], v[104:105], v[56:57]
v_pk_mul_f32 v[106:107], v[106:107], v[56:57]
v_pk_mul_f32 v[108:109], v[108:109], v[56:57]
v_pk_mul_f32 v[110:111], v[110:111], v[56:57]
v_cvt_pk_bf16_f32 v84, v104, v105
v_cvt_pk_bf16_f32 v85, v106, v107
v_cvt_pk_bf16_f32 v86, v108, v109
v_cvt_pk_bf16_f32 v87, v110, v111
ds_write_b128 v53, v[84:87] offset:5120
v_pk_mul_f32 v[112:113], v[112:113], v[56:57]
v_pk_mul_f32 v[114:115], v[114:115], v[56:57]
v_pk_mul_f32 v[116:117], v[116:117], v[56:57]
v_pk_mul_f32 v[118:119], v[118:119], v[56:57]
v_cvt_pk_bf16_f32 v88, v112, v113
v_cvt_pk_bf16_f32 v89, v114, v115
v_cvt_pk_bf16_f32 v90, v116, v117
v_cvt_pk_bf16_f32 v91, v118, v119
ds_write_b128 v53, v[88:91] offset:6144
v_pk_mul_f32 v[120:121], v[120:121], v[56:57]
v_pk_mul_f32 v[122:123], v[122:123], v[56:57]
v_pk_mul_f32 v[124:125], v[124:125], v[56:57]
v_pk_mul_f32 v[126:127], v[126:127], v[56:57]
v_cvt_pk_bf16_f32 v92, v120, v121
v_cvt_pk_bf16_f32 v93, v122, v123
v_cvt_pk_bf16_f32 v94, v124, v125
v_cvt_pk_bf16_f32 v95, v126, v127
ds_write_b128 v53, v[92:95] offset:7168
s_nop 0
s_waitcnt lgkmcnt(13)
v_mfma_f32_16x16x32_bf16 v[0:3], v[32:35], v[64:67], 0
v_mov_b64 v[96:97], 0
v_mov_b64 v[98:99], 0
v_mfma_f32_16x16x32_bf16 v[8:11], v[32:35], v[68:71], 0
v_mov_b64 v[100:101], 0
v_mov_b64 v[102:103], 0
v_mfma_f32_16x16x32_bf16 v[4:7], v[36:39], v[64:67], 0
v_mov_b64 v[104:105], 0
v_mov_b64 v[106:107], 0
v_mov_b64 v[108:109], 0
v_mfma_f32_16x16x32_bf16 v[12:15], v[36:39], v[68:71], 0
v_mov_b64 v[110:111], 0
s_waitcnt lgkmcnt(9)
v_mfma_f32_16x16x32_bf16 v[0:3], v[40:43], v[72:75], v[0:3]
v_mov_b64 v[112:113], 0
v_mov_b64 v[114:115], 0
v_mfma_f32_16x16x32_bf16 v[8:11], v[40:43], v[76:79], v[8:11]
v_mov_b64 v[116:117], 0
v_mov_b64 v[118:119], 0
v_mfma_f32_16x16x32_bf16 v[4:7], v[44:47], v[72:75], v[4:7]
v_mov_b64 v[120:121], 0
v_mov_b64 v[122:123], 0
v_mov_b64 v[124:125], 0
v_mfma_f32_16x16x32_bf16 v[12:15], v[44:47], v[76:79], v[12:15]
v_mov_b64 v[126:127], 0
v_mfma_f32_16x16x32_bf16 v[0:3], v[16:19], v[80:83], v[0:3]
s_waitcnt lgkmcnt(0)
s_barrier
v_add_u32 v62, v59, v60
ds_read_b128 a[32:35], v54 offset:0
ds_read_b128 a[36:39], v54 offset:1024
v_mfma_f32_16x16x32_bf16 v[8:11], v[16:19], v[84:87], v[8:11]
ds_read_b128 v[32:35], v62 offset:0
v_mfma_f32_16x16x32_bf16 v[4:7], v[20:23], v[80:83], v[4:7]
ds_read_b128 a[40:43], v54 offset:2048
ds_read_b128 a[44:47], v54 offset:3072
v_mfma_f32_16x16x32_bf16 v[12:15], v[20:23], v[84:87], v[12:15]
ds_read_b128 v[36:39], v62 offset:256
v_mfma_f32_16x16x32_bf16 v[0:3], v[24:27], v[88:91], v[0:3]
ds_read_b128 a[48:51], v54 offset:4096
ds_read_b128 a[52:55], v54 offset:5120
v_mfma_f32_16x16x32_bf16 v[8:11], v[24:27], v[92:95], v[8:11]
ds_read_b128 v[40:43], v62 offset:64
v_mfma_f32_16x16x32_bf16 v[4:7], v[28:31], v[88:91], v[4:7]
ds_read_b64 v[58:59], v63 offset:88
ds_read_b128 a[56:59], v54 offset:6144
ds_read_b128 a[60:63], v54 offset:7168
v_mfma_f32_16x16x32_bf16 v[12:15], v[28:31], v[92:95], v[12:15]
ds_read_b128 v[44:47], v62 offset:320
s_waitcnt lgkmcnt(7)
v_mfma_f32_16x16x32_bf16 v[0:3], v[32:35], a[32:35], v[0:3]
ds_read_b128 a[0:3], v53 offset:0
ds_read_b128 a[4:7], v53 offset:1024
v_mov_b64 v[64:65], 0
v_mfma_f32_16x16x32_bf16 v[8:11], v[32:35], a[36:39], v[8:11]
ds_read_b128 v[32:35], v62 offset:128
v_mov_b64 v[66:67], 0
v_mfma_f32_16x16x32_bf16 v[4:7], v[36:39], a[32:35], v[4:7]
ds_read_b128 a[8:11], v53 offset:2048
ds_read_b128 a[12:15], v53 offset:3072
v_mov_b64 v[68:69], 0
v_mfma_f32_16x16x32_bf16 v[12:15], v[36:39], a[36:39], v[12:15]
ds_read_b128 v[36:39], v62 offset:384
v_mov_b64 v[70:71], 0
s_waitcnt lgkmcnt(6)
v_mfma_f32_16x16x32_bf16 v[0:3], v[40:43], a[40:43], v[0:3]
ds_read_b128 a[16:19], v53 offset:4096
ds_read_b128 a[20:23], v53 offset:5120
v_mov_b64 v[72:73], 0
v_mfma_f32_16x16x32_bf16 v[8:11], v[40:43], a[44:47], v[8:11]
ds_read_b128 v[40:43], v62 offset:192
v_mov_b64 v[74:75], 0
v_mfma_f32_16x16x32_bf16 v[4:7], v[44:47], a[40:43], v[4:7]
ds_read_b128 a[24:27], v53 offset:6144
ds_read_b128 a[28:31], v53 offset:7168
v_mov_b64 v[76:77], 0
v_mfma_f32_16x16x32_bf16 v[12:15], v[44:47], a[44:47], v[12:15]
ds_read_b128 v[44:47], v62 offset:448
v_mov_b64 v[78:79], 0
s_waitcnt lgkmcnt(6)
v_mfma_f32_16x16x32_bf16 v[0:3], v[32:35], a[48:51], v[0:3]
s_barrier
v_add_u32 v62, v58, v60
v_mov_b64 v[80:81], 0
v_mfma_f32_16x16x32_bf16 v[8:11], v[32:35], a[52:55], v[8:11]
ds_read_b128 v[32:35], v62 offset:0
v_mov_b64 v[82:83], 0
v_mfma_f32_16x16x32_bf16 v[4:7], v[36:39], a[48:51], v[4:7]
v_mov_b64 v[84:85], 0
v_mov_b64 v[86:87], 0
v_mfma_f32_16x16x32_bf16 v[12:15], v[36:39], a[52:55], v[12:15]
ds_read_b128 v[36:39], v62 offset:256
s_waitcnt lgkmcnt(2)
v_mfma_f32_16x16x32_bf16 v[0:3], v[40:43], a[56:59], v[0:3]
v_mov_b64 v[88:89], 0
v_mov_b64 v[90:91], 0
v_mfma_f32_16x16x32_bf16 v[8:11], v[40:43], a[60:63], v[8:11]
ds_read_b128 v[40:43], v62 offset:64
v_mfma_f32_16x16x32_bf16 v[4:7], v[44:47], a[56:59], v[4:7]
v_mov_b64 v[92:93], 0
v_mov_b64 v[94:95], 0
v_mfma_f32_16x16x32_bf16 v[12:15], v[44:47], a[60:63], v[12:15]
ds_read_b128 v[44:47], v62 offset:320
s_nop 7
v_max3_f32 v48, v0, v1, v2
v_max3_f32 v52, v8, v9, v10
v_max3_f32 v48, v48, v3, v4
v_max3_f32 v52, v52, v11, v12
v_max3_f32 v48, v48, v5, v6
v_max3_f32 v52, v52, v13, v14
v_max_f32 v48, v48, v7
v_max_f32 v52, v52, v15
v_mov_b32 v56, v48
v_mov_b32 v57, v52
s_nop 1
v_permlane16_swap_b32 v56, v48
v_permlane16_swap_b32 v57, v52
s_nop 1
v_max_f32 v48, v48, v56
v_max_f32 v52, v52, v57
v_mov_b32 v56, v48
v_mov_b32 v57, v52
s_nop 1
v_permlane32_swap_b32 v56, v48
v_permlane32_swap_b32 v57, v52
s_nop 1
v_max_f32 v48, v48, v56
v_max_f32 v52, v52, v57
v_sub_f32 v0, v0, v48
v_sub_f32 v1, v1, v48
v_sub_f32 v2, v2, v48
v_sub_f32 v3, v3, v48
v_sub_f32 v4, v4, v48
v_sub_f32 v5, v5, v48
v_sub_f32 v6, v6, v48
v_sub_f32 v7, v7, v48
v_sub_f32 v8, v8, v52
v_sub_f32 v9, v9, v52
v_sub_f32 v10, v10, v52
v_sub_f32 v11, v11, v52
v_sub_f32 v12, v12, v52
v_sub_f32 v13, v13, v52
v_sub_f32 v14, v14, v52
v_sub_f32 v15, v15, v52
v_sub_f32 v51, 0, v48
v_sub_f32 v50, 0, v48
v_sub_f32 v49, 0, v48
v_sub_f32 v48, 0, v48
v_sub_f32 v55, 0, v52
v_sub_f32 v54, 0, v52
v_sub_f32 v53, 0, v52
v_sub_f32 v52, 0, v52
v_mov_b32 v56, 0
v_mov_b32 v57, 0
v_exp_f32 v0, v0
v_exp_f32 v1, v1
v_exp_f32 v2, v2
v_exp_f32 v3, v3
v_exp_f32 v4, v4
v_exp_f32 v5, v5
s_nop 0
v_add_f32 v56, v56, v0
v_add_f32 v56, v56, v1
v_cvt_pk_bf16_f32 v0, v0, v1
v_add_f32 v56, v56, v2
s_nop 1
s_mov_b32 s40, 7
.p2align 6
L_attn:
s_waitcnt lgkmcnt(2)
v_mfma_f32_16x16x32_bf16 v[16:19], v[32:35], a[0:3], v[48:51]
v_exp_f32 v6, v6
v_mfma_f32_16x16x32_bf16 v[24:27], v[32:35], a[4:7], v[52:55]
ds_read_b128 v[32:35], v62 offset:128
v_add_f32 v56, v56, v3
v_mfma_f32_16x16x32_bf16 v[20:23], v[36:39], a[0:3], v[48:51]
v_exp_f32 v7, v7
v_mfma_f32_16x16x32_bf16 v[28:31], v[36:39], a[4:7], v[52:55]
ds_read_b128 v[36:39], v62 offset:384
s_waitcnt lgkmcnt(2)
v_mfma_f32_16x16x32_bf16 v[16:19], v[40:43], a[8:11], v[16:19]
v_exp_f32 v8, v8
v_mfma_f32_16x16x32_bf16 v[24:27], v[40:43], a[12:15], v[24:27]
ds_read_b128 v[40:43], v62 offset:192
v_cvt_pk_bf16_f32 v1, v2, v3
v_mfma_f32_16x16x32_bf16 v[20:23], v[44:47], a[8:11], v[20:23]
v_exp_f32 v9, v9
v_add_f32 v56, v56, v4
v_mfma_f32_16x16x32_bf16 v[28:31], v[44:47], a[12:15], v[28:31]
ds_read_b128 v[44:47], v62 offset:448
s_waitcnt lgkmcnt(2)
v_mfma_f32_16x16x32_bf16 v[16:19], v[32:35], a[16:19], v[16:19]
s_barrier
v_add_u32 v62, v59, v60
v_mfma_f32_16x16x32_bf16 v[24:27], v[32:35], a[20:23], v[24:27]
ds_read_b128 v[32:35], v62 offset:0
v_add_f32 v56, v56, v5
v_mfma_f32_16x16x32_bf16 v[20:23], v[36:39], a[16:19], v[20:23]
v_exp_f32 v10, v10
v_mfma_f32_16x16x32_bf16 v[28:31], v[36:39], a[20:23], v[28:31]
ds_read_b128 v[36:39], v62 offset:256
s_waitcnt lgkmcnt(2)
v_mfma_f32_16x16x32_bf16 v[16:19], v[40:43], a[24:27], v[16:19]
v_exp_f32 v11, v11
v_cvt_pk_bf16_f32 v2, v4, v5
v_mfma_f32_16x16x32_bf16 v[24:27], v[40:43], a[28:31], v[24:27]
ds_read_b128 v[40:43], v62 offset:64
v_add_f32 v56, v56, v6
v_mfma_f32_16x16x32_bf16 v[20:23], v[44:47], a[24:27], v[20:23]
ds_read_b64 v[58:59], v63 offset:96
v_add_f32 v56, v56, v7
v_mfma_f32_16x16x32_bf16 v[28:31], v[44:47], a[28:31], v[28:31]
ds_read_b128 v[44:47], v62 offset:320
s_waitcnt lgkmcnt(3)
v_mfma_f32_16x16x32_bf16 v[16:19], v[32:35], a[32:35], v[16:19]
v_exp_f32 v12, v12
v_mfma_f32_16x16x32_bf16 v[24:27], v[32:35], a[36:39], v[24:27]
ds_read_b128 v[32:35], v62 offset:128
v_cvt_pk_bf16_f32 v3, v6, v7
v_mfma_f32_16x16x32_bf16 v[20:23], v[36:39], a[32:35], v[20:23]
v_exp_f32 v13, v13
v_add_f32 v57, v57, v8
v_mfma_f32_16x16x32_bf16 v[28:31], v[36:39], a[36:39], v[28:31]
ds_read_b128 v[36:39], v62 offset:384
s_waitcnt lgkmcnt(2)
v_mfma_f32_16x16x32_bf16 v[16:19], v[40:43], a[40:43], v[16:19]
v_exp_f32 v14, v14
v_mfma_f32_16x16x32_bf16 v[24:27], v[40:43], a[44:47], v[24:27]
ds_read_b128 v[40:43], v62 offset:192
v_add_f32 v57, v57, v9
v_mfma_f32_16x16x32_bf16 v[20:23], v[44:47], a[40:43], v[20:23]
v_exp_f32 v15, v15
v_mfma_f32_16x16x32_bf16 v[28:31], v[44:47], a[44:47], v[28:31]
ds_read_b128 v[44:47], v62 offset:448
s_waitcnt lgkmcnt(2)
v_mfma_f32_16x16x32_bf16 v[16:19], v[32:35], a[48:51], v[16:19]
s_barrier
v_add_u32 v62, v58, v61
v_cvt_pk_bf16_f32 v4, v8, v9
v_mfma_f32_16x16x32_bf16 v[24:27], v[32:35], a[52:55], v[24:27]
ds_read_b64_tr_b16 v[32:33], v62 offset:0
v_add_f32 v57, v57, v10
v_mfma_f32_16x16x32_bf16 v[20:23], v[36:39], a[48:51], v[20:23]
ds_read_b64_tr_b16 v[34:35], v62 offset:512
v_add_f32 v57, v57, v11
v_mfma_f32_16x16x32_bf16 v[28:31], v[36:39], a[52:55], v[28:31]
ds_read_b64_tr_b16 v[36:37], v62 offset:32
s_waitcnt lgkmcnt(3)
v_mfma_f32_16x16x32_bf16 v[16:19], v[40:43], a[56:59], v[16:19]
ds_read_b64_tr_b16 v[38:39], v62 offset:544
v_cvt_pk_bf16_f32 v5, v10, v11
v_mfma_f32_16x16x32_bf16 v[24:27], v[40:43], a[60:63], v[24:27]
ds_read_b64_tr_b16 v[40:41], v62 offset:64
v_cvt_pk_bf16_f32 v6, v12, v13
v_cvt_pk_bf16_f32 v7, v14, v15
v_mfma_f32_16x16x32_bf16 v[20:23], v[44:47], a[56:59], v[20:23]
ds_read_b64_tr_b16 v[42:43], v62 offset:576
v_add_f32 v57, v57, v12
v_mfma_f32_16x16x32_bf16 v[28:31], v[44:47], a[60:63], v[28:31]
ds_read_b64_tr_b16 v[44:45], v62 offset:96
s_waitcnt lgkmcnt(3)
v_mfma_f32_16x16x32_bf16 v[64:67], v[32:35], v[0:3], v[64:67]
ds_read_b64_tr_b16 v[46:47], v62 offset:608
v_add_f32 v57, v57, v13
v_mfma_f32_16x16x32_bf16 v[72:75], v[32:35], v[4:7], v[72:75]
ds_read_b64_tr_b16 v[32:33], v62 offset:128
v_add_f32 v57, v57, v14
v_mfma_f32_16x16x32_bf16 v[68:71], v[36:39], v[0:3], v[68:71]
ds_read_b64_tr_b16 v[34:35], v62 offset:640
v_add_f32 v57, v57, v15
v_mfma_f32_16x16x32_bf16 v[76:79], v[36:39], v[4:7], v[76:79]
ds_read_b64_tr_b16 v[36:37], v62 offset:160
s_waitcnt lgkmcnt(3)
v_mfma_f32_16x16x32_bf16 v[80:83], v[40:43], v[0:3], v[80:83]
ds_read_b64_tr_b16 v[38:39], v62 offset:672
v_max3_f32 v8, v16, v17, v18
v_mfma_f32_16x16x32_bf16 v[88:91], v[40:43], v[4:7], v[88:91]
ds_read_b64_tr_b16 v[40:41], v62 offset:192
v_max3_f32 v9, v24, v25, v26
v_mfma_f32_16x16x32_bf16 v[84:87], v[44:47], v[0:3], v[84:87]
ds_read_b64_tr_b16 v[42:43], v62 offset:704
v_max3_f32 v8, v8, v19, v27
v_mfma_f32_16x16x32_bf16 v[92:95], v[44:47], v[4:7], v[92:95]
ds_read_b64_tr_b16 v[44:45], v62 offset:224
s_waitcnt lgkmcnt(3)
v_mfma_f32_16x16x32_bf16 v[96:99], v[32:35], v[0:3], v[96:99]
ds_read_b64_tr_b16 v[46:47], v62 offset:736
s_barrier
v_add_u32 v62, v59, v61
v_mfma_f32_16x16x32_bf16 v[104:107], v[32:35], v[4:7], v[104:107]
ds_read_b64_tr_b16 v[32:33], v62 offset:0
v_max3_f32 v9, v9, v20, v21
v_max3_f32 v8, v8, v22, v23
v_mfma_f32_16x16x32_bf16 v[100:103], v[36:39], v[0:3], v[100:103]
ds_read_b64_tr_b16 v[34:35], v62 offset:512
v_max3_f32 v9, v9, v28, v29
v_mfma_f32_16x16x32_bf16 v[108:111], v[36:39], v[4:7], v[108:111]
ds_read_b64_tr_b16 v[36:37], v62 offset:32
s_waitcnt lgkmcnt(3)
v_mfma_f32_16x16x32_bf16 v[112:115], v[40:43], v[0:3], v[112:115]
ds_read_b64_tr_b16 v[38:39], v62 offset:544
v_max3_f32 v8, v8, v30, v31
v_mfma_f32_16x16x32_bf16 v[120:123], v[40:43], v[4:7], v[120:123]
ds_read_b64_tr_b16 v[40:41], v62 offset:64
v_max_f32 v8, v8, v9
v_mfma_f32_16x16x32_bf16 v[116:119], v[44:47], v[0:3], v[116:119]
ds_read_b64_tr_b16 v[42:43], v62 offset:576
ds_read_b64 v[58:59], v63 offset:104
v_cmp_lt_f32 vcc, s42, v8
v_mfma_f32_16x16x32_bf16 v[124:127], v[44:47], v[4:7], v[124:127]
ds_read_b64_tr_b16 v[44:45], v62 offset:96
s_waitcnt lgkmcnt(4)
v_mfma_f32_16x16x32_bf16 v[128:131], v[32:35], v[0:3], v[128:131]
ds_read_b64_tr_b16 v[46:47], v62 offset:608
s_cbranch_vccnz L_ra_0
L_rab_0:
v_mfma_f32_16x16x32_bf16 v[136:139], v[32:35], v[4:7], v[136:139]
ds_read_b64_tr_b16 v[32:33], v62 offset:128
v_exp_f32 v16, v16
v_mfma_f32_16x16x32_bf16 v[132:135], v[36:39], v[0:3], v[132:135]
ds_read_b64_tr_b16 v[34:35], v62 offset:640
v_add_f32 v56, v56, v16
v_mfma_f32_16x16x32_bf16 v[140:143], v[36:39], v[4:7], v[140:143]
ds_read_b64_tr_b16 v[36:37], v62 offset:160
s_waitcnt lgkmcnt(3)
v_mfma_f32_16x16x32_bf16 v[144:147], v[40:43], v[0:3], v[144:147]
ds_read_b64_tr_b16 v[38:39], v62 offset:672
v_exp_f32 v17, v17
v_mfma_f32_16x16x32_bf16 v[152:155], v[40:43], v[4:7], v[152:155]
ds_read_b64_tr_b16 v[40:41], v62 offset:192
v_add_f32 v56, v56, v17
v_mfma_f32_16x16x32_bf16 v[148:151], v[44:47], v[0:3], v[148:151]
ds_read_b64_tr_b16 v[42:43], v62 offset:704
v_cvt_pk_bf16_f32 v16, v16, v17
v_mfma_f32_16x16x32_bf16 v[156:159], v[44:47], v[4:7], v[156:159]
ds_read_b64_tr_b16 v[44:45], v62 offset:224
s_waitcnt lgkmcnt(3)
v_mfma_f32_16x16x32_bf16 v[160:163], v[32:35], v[0:3], v[160:163]
ds_read_b64_tr_b16 v[46:47], v62 offset:736
s_barrier
v_add_u32 v62, v58, v60
v_mfma_f32_16x16x32_bf16 v[168:171], v[32:35], v[4:7], v[168:171]
ds_read_b128 v[32:35], v62 offset:0
v_exp_f32 v18, v18
v_mfma_f32_16x16x32_bf16 v[164:167], v[36:39], v[0:3], v[164:167]
v_exp_f32 v19, v19
v_mfma_f32_16x16x32_bf16 v[172:175], v[36:39], v[4:7], v[172:175]
ds_read_b128 v[36:39], v62 offset:256
s_waitcnt lgkmcnt(2)
v_mfma_f32_16x16x32_bf16 v[176:179], v[40:43], v[0:3], v[176:179]
v_exp_f32 v20, v20
v_mfma_f32_16x16x32_bf16 v[184:187], v[40:43], v[4:7], v[184:187]
ds_read_b128 v[40:43], v62 offset:64
v_add_f32 v56, v56, v18
v_mfma_f32_16x16x32_bf16 v[180:183], v[44:47], v[0:3], v[180:183]
v_exp_f32 v21, v21
v_mfma_f32_16x16x32_bf16 v[188:191], v[44:47], v[4:7], v[188:191]
ds_read_b128 v[44:47], v62 offset:320
s_cbranch_vccnz L_rb_0
L_rbb_0:
s_waitcnt lgkmcnt(2)
v_mfma_f32_16x16x32_bf16 v[0:3], v[32:35], a[0:3], v[48:51]
v_exp_f32 v22, v22
v_mfma_f32_16x16x32_bf16 v[8:11], v[32:35], a[4:7], v[52:55]
ds_read_b128 v[32:35], v62 offset:128
v_add_f32 v56, v56, v19
v_mfma_f32_16x16x32_bf16 v[4:7], v[36:39], a[0:3], v[48:51]
v_exp_f32 v23, v23
v_mfma_f32_16x16x32_bf16 v[12:15], v[36:39], a[4:7], v[52:55]
ds_read_b128 v[36:39], v62 offset:384
s_waitcnt lgkmcnt(2)
v_mfma_f32_16x16x32_bf16 v[0:3], v[40:43], a[8:11], v[0:3]
v_exp_f32 v24, v24
v_mfma_f32_16x16x32_bf16 v[8:11], v[40:43], a[12:15], v[8:11]
ds_read_b128 v[40:43], v62 offset:192
v_cvt_pk_bf16_f32 v17, v18, v19
v_mfma_f32_16x16x32_bf16 v[4:7], v[44:47], a[8:11], v[4:7]
v_exp_f32 v25, v25
v_add_f32 v56, v56, v20
v_mfma_f32_16x16x32_bf16 v[12:15], v[44:47], a[12:15], v[12:15]
ds_read_b128 v[44:47], v62 offset:448
s_waitcnt lgkmcnt(2)
v_mfma_f32_16x16x32_bf16 v[0:3], v[32:35], a[16:19], v[0:3]
s_barrier
v_add_u32 v62, v59, v60
v_mfma_f32_16x16x32_bf16 v[8:11], v[32:35], a[20:23], v[8:11]
ds_read_b128 v[32:35], v62 offset:0
v_add_f32 v56, v56, v21
v_mfma_f32_16x16x32_bf16 v[4:7], v[36:39], a[16:19], v[4:7]
v_exp_f32 v26, v26
v_mfma_f32_16x16x32_bf16 v[12:15], v[36:39], a[20:23], v[12:15]
ds_read_b128 v[36:39], v62 offset:256
s_waitcnt lgkmcnt(2)
v_mfma_f32_16x16x32_bf16 v[0:3], v[40:43], a[24:27], v[0:3]
v_exp_f32 v27, v27
v_cvt_pk_bf16_f32 v18, v20, v21
v_mfma_f32_16x16x32_bf16 v[8:11], v[40:43], a[28:31], v[8:11]
ds_read_b128 v[40:43], v62 offset:64
v_add_f32 v56, v56, v22
v_mfma_f32_16x16x32_bf16 v[4:7], v[44:47], a[24:27], v[4:7]
ds_read_b64 v[58:59], v63 offset:112
v_add_f32 v56, v56, v23
v_mfma_f32_16x16x32_bf16 v[12:15], v[44:47], a[28:31], v[12:15]
ds_read_b128 v[44:47], v62 offset:320
s_waitcnt lgkmcnt(3)
v_mfma_f32_16x16x32_bf16 v[0:3], v[32:35], a[32:35], v[0:3]
v_exp_f32 v28, v28
v_mfma_f32_16x16x32_bf16 v[8:11], v[32:35], a[36:39], v[8:11]
ds_read_b128 v[32:35], v62 offset:128
v_cvt_pk_bf16_f32 v19, v22, v23
v_mfma_f32_16x16x32_bf16 v[4:7], v[36:39], a[32:35], v[4:7]
v_exp_f32 v29, v29
v_add_f32 v57, v57, v24
v_mfma_f32_16x16x32_bf16 v[12:15], v[36:39], a[36:39], v[12:15]
ds_read_b128 v[36:39], v62 offset:384
s_waitcnt lgkmcnt(2)
v_mfma_f32_16x16x32_bf16 v[0:3], v[40:43], a[40:43], v[0:3]
v_exp_f32 v30, v30
v_mfma_f32_16x16x32_bf16 v[8:11], v[40:43], a[44:47], v[8:11]
ds_read_b128 v[40:43], v62 offset:192
v_add_f32 v57, v57, v25
v_mfma_f32_16x16x32_bf16 v[4:7], v[44:47], a[40:43], v[4:7]
v_exp_f32 v31, v31
v_mfma_f32_16x16x32_bf16 v[12:15], v[44:47], a[44:47], v[12:15]
ds_read_b128 v[44:47], v62 offset:448
s_waitcnt lgkmcnt(2)
v_mfma_f32_16x16x32_bf16 v[0:3], v[32:35], a[48:51], v[0:3]
s_barrier
v_add_u32 v62, v58, v61
v_cvt_pk_bf16_f32 v20, v24, v25
v_mfma_f32_16x16x32_bf16 v[8:11], v[32:35], a[52:55], v[8:11]
ds_read_b64_tr_b16 v[32:33], v62 offset:0
v_add_f32 v57, v57, v26
v_mfma_f32_16x16x32_bf16 v[4:7], v[36:39], a[48:51], v[4:7]
ds_read_b64_tr_b16 v[34:35], v62 offset:512
v_add_f32 v57, v57, v27
v_mfma_f32_16x16x32_bf16 v[12:15], v[36:39], a[52:55], v[12:15]
ds_read_b64_tr_b16 v[36:37], v62 offset:32
s_waitcnt lgkmcnt(3)
v_mfma_f32_16x16x32_bf16 v[0:3], v[40:43], a[56:59], v[0:3]
ds_read_b64_tr_b16 v[38:39], v62 offset:544
v_cvt_pk_bf16_f32 v21, v26, v27
v_mfma_f32_16x16x32_bf16 v[8:11], v[40:43], a[60:63], v[8:11]
ds_read_b64_tr_b16 v[40:41], v62 offset:64
v_cvt_pk_bf16_f32 v22, v28, v29
v_cvt_pk_bf16_f32 v23, v30, v31
v_mfma_f32_16x16x32_bf16 v[4:7], v[44:47], a[56:59], v[4:7]
ds_read_b64_tr_b16 v[42:43], v62 offset:576
v_add_f32 v57, v57, v28
v_mfma_f32_16x16x32_bf16 v[12:15], v[44:47], a[60:63], v[12:15]
ds_read_b64_tr_b16 v[44:45], v62 offset:96
s_waitcnt lgkmcnt(3)
v_mfma_f32_16x16x32_bf16 v[64:67], v[32:35], v[16:19], v[64:67]
ds_read_b64_tr_b16 v[46:47], v62 offset:608
v_add_f32 v57, v57, v29
v_mfma_f32_16x16x32_bf16 v[72:75], v[32:35], v[20:23], v[72:75]
ds_read_b64_tr_b16 v[32:33], v62 offset:128
v_add_f32 v57, v57, v30
v_mfma_f32_16x16x32_bf16 v[68:71], v[36:39], v[16:19], v[68:71]
ds_read_b64_tr_b16 v[34:35], v62 offset:640
v_add_f32 v57, v57, v31
v_mfma_f32_16x16x32_bf16 v[76:79], v[36:39], v[20:23], v[76:79]
ds_read_b64_tr_b16 v[36:37], v62 offset:160
s_waitcnt lgkmcnt(3)
v_mfma_f32_16x16x32_bf16 v[80:83], v[40:43], v[16:19], v[80:83]
ds_read_b64_tr_b16 v[38:39], v62 offset:672
v_max3_f32 v24, v0, v1, v2
v_mfma_f32_16x16x32_bf16 v[88:91], v[40:43], v[20:23], v[88:91]
ds_read_b64_tr_b16 v[40:41], v62 offset:192
v_max3_f32 v25, v8, v9, v10
v_mfma_f32_16x16x32_bf16 v[84:87], v[44:47], v[16:19], v[84:87]
ds_read_b64_tr_b16 v[42:43], v62 offset:704
v_max3_f32 v24, v24, v3, v11
v_mfma_f32_16x16x32_bf16 v[92:95], v[44:47], v[20:23], v[92:95]
ds_read_b64_tr_b16 v[44:45], v62 offset:224
s_waitcnt lgkmcnt(3)
v_mfma_f32_16x16x32_bf16 v[96:99], v[32:35], v[16:19], v[96:99]
ds_read_b64_tr_b16 v[46:47], v62 offset:736
s_barrier
v_add_u32 v62, v59, v61
v_mfma_f32_16x16x32_bf16 v[104:107], v[32:35], v[20:23], v[104:107]
ds_read_b64_tr_b16 v[32:33], v62 offset:0
v_max3_f32 v25, v25, v4, v5
v_max3_f32 v24, v24, v6, v7
v_mfma_f32_16x16x32_bf16 v[100:103], v[36:39], v[16:19], v[100:103]
ds_read_b64_tr_b16 v[34:35], v62 offset:512
v_max3_f32 v25, v25, v12, v13
v_mfma_f32_16x16x32_bf16 v[108:111], v[36:39], v[20:23], v[108:111]
ds_read_b64_tr_b16 v[36:37], v62 offset:32
s_waitcnt lgkmcnt(3)
v_mfma_f32_16x16x32_bf16 v[112:115], v[40:43], v[16:19], v[112:115]
ds_read_b64_tr_b16 v[38:39], v62 offset:544
v_max3_f32 v24, v24, v14, v15
v_mfma_f32_16x16x32_bf16 v[120:123], v[40:43], v[20:23], v[120:123]
ds_read_b64_tr_b16 v[40:41], v62 offset:64
v_max_f32 v24, v24, v25
v_mfma_f32_16x16x32_bf16 v[116:119], v[44:47], v[16:19], v[116:119]
ds_read_b64_tr_b16 v[42:43], v62 offset:576
ds_read_b64 v[58:59], v63 offset:120
v_add_u32 v63, 32, v63
v_cmp_lt_f32 vcc, s42, v24
v_mfma_f32_16x16x32_bf16 v[124:127], v[44:47], v[20:23], v[124:127]
ds_read_b64_tr_b16 v[44:45], v62 offset:96
s_waitcnt lgkmcnt(4)
v_mfma_f32_16x16x32_bf16 v[128:131], v[32:35], v[16:19], v[128:131]
ds_read_b64_tr_b16 v[46:47], v62 offset:608
s_cbranch_vccnz L_ra_1
L_rab_1:
v_mfma_f32_16x16x32_bf16 v[136:139], v[32:35], v[20:23], v[136:139]
ds_read_b64_tr_b16 v[32:33], v62 offset:128
v_exp_f32 v0, v0
v_mfma_f32_16x16x32_bf16 v[132:135], v[36:39], v[16:19], v[132:135]
ds_read_b64_tr_b16 v[34:35], v62 offset:640
v_add_f32 v56, v56, v0
v_mfma_f32_16x16x32_bf16 v[140:143], v[36:39], v[20:23], v[140:143]
ds_read_b64_tr_b16 v[36:37], v62 offset:160
s_waitcnt lgkmcnt(3)
v_mfma_f32_16x16x32_bf16 v[144:147], v[40:43], v[16:19], v[144:147]
ds_read_b64_tr_b16 v[38:39], v62 offset:672
v_exp_f32 v1, v1
v_mfma_f32_16x16x32_bf16 v[152:155], v[40:43], v[20:23], v[152:155]
ds_read_b64_tr_b16 v[40:41], v62 offset:192
v_add_f32 v56, v56, v1
v_mfma_f32_16x16x32_bf16 v[148:151], v[44:47], v[16:19], v[148:151]
ds_read_b64_tr_b16 v[42:43], v62 offset:704
v_cvt_pk_bf16_f32 v0, v0, v1
v_mfma_f32_16x16x32_bf16 v[156:159], v[44:47], v[20:23], v[156:159]
ds_read_b64_tr_b16 v[44:45], v62 offset:224
s_waitcnt lgkmcnt(3)
v_mfma_f32_16x16x32_bf16 v[160:163], v[32:35], v[16:19], v[160:163]
ds_read_b64_tr_b16 v[46:47], v62 offset:736
s_barrier
v_add_u32 v62, v58, v60
v_mfma_f32_16x16x32_bf16 v[168:171], v[32:35], v[20:23], v[168:171]
ds_read_b128 v[32:35], v62 offset:0
v_exp_f32 v2, v2
v_mfma_f32_16x16x32_bf16 v[164:167], v[36:39], v[16:19], v[164:167]
v_exp_f32 v3, v3
v_mfma_f32_16x16x32_bf16 v[172:175], v[36:39], v[20:23], v[172:175]
ds_read_b128 v[36:39], v62 offset:256
s_waitcnt lgkmcnt(2)
v_mfma_f32_16x16x32_bf16 v[176:179], v[40:43], v[16:19], v[176:179]
v_exp_f32 v4, v4
v_mfma_f32_16x16x32_bf16 v[184:187], v[40:43], v[20:23], v[184:187]
ds_read_b128 v[40:43], v62 offset:64
v_add_f32 v56, v56, v2
v_mfma_f32_16x16x32_bf16 v[180:183], v[44:47], v[16:19], v[180:183]
v_exp_f32 v5, v5
v_mfma_f32_16x16x32_bf16 v[188:191], v[44:47], v[20:23], v[188:191]
ds_read_b128 v[44:47], v62 offset:320
s_cbranch_vccnz L_rb_1
L_rbb_1:
s_sub_u32 s40, s40, 1
s_cmp_lg_u32 s40, 0
s_cbranch_scc1 L_attn
s_waitcnt lgkmcnt(2)
v_mfma_f32_16x16x32_bf16 v[16:19], v[32:35], a[0:3], v[48:51]
v_exp_f32 v6, v6
v_mfma_f32_16x16x32_bf16 v[24:27], v[32:35], a[4:7], v[52:55]
ds_read_b128 v[32:35], v62 offset:128
v_add_f32 v56, v56, v3
v_mfma_f32_16x16x32_bf16 v[20:23], v[36:39], a[0:3], v[48:51]
v_exp_f32 v7, v7
v_mfma_f32_16x16x32_bf16 v[28:31], v[36:39], a[4:7], v[52:55]
ds_read_b128 v[36:39], v62 offset:384
s_waitcnt lgkmcnt(2)
v_mfma_f32_16x16x32_bf16 v[16:19], v[40:43], a[8:11], v[16:19]
v_exp_f32 v8, v8
v_mfma_f32_16x16x32_bf16 v[24:27], v[40:43], a[12:15], v[24:27]
ds_read_b128 v[40:43], v62 offset:192
v_cvt_pk_bf16_f32 v1, v2, v3
v_mfma_f32_16x16x32_bf16 v[20:23], v[44:47], a[8:11], v[20:23]
v_exp_f32 v9, v9
v_add_f32 v56, v56, v4
v_mfma_f32_16x16x32_bf16 v[28:31], v[44:47], a[12:15], v[28:31]
ds_read_b128 v[44:47], v62 offset:448
s_waitcnt lgkmcnt(2)
v_mfma_f32_16x16x32_bf16 v[16:19], v[32:35], a[16:19], v[16:19]
s_barrier
v_add_u32 v62, v59, v60
v_mfma_f32_16x16x32_bf16 v[24:27], v[32:35], a[20:23], v[24:27]
ds_read_b128 v[32:35], v62 offset:0
v_add_f32 v56, v56, v5
v_mfma_f32_16x16x32_bf16 v[20:23], v[36:39], a[16:19], v[20:23]
v_exp_f32 v10, v10
v_mfma_f32_16x16x32_bf16 v[28:31], v[36:39], a[20:23], v[28:31]
ds_read_b128 v[36:39], v62 offset:256
s_waitcnt lgkmcnt(2)
v_mfma_f32_16x16x32_bf16 v[16:19], v[40:43], a[24:27], v[16:19]
v_exp_f32 v11, v11
v_cvt_pk_bf16_f32 v2, v4, v5
v_mfma_f32_16x16x32_bf16 v[24:27], v[40:43], a[28:31], v[24:27]
ds_read_b128 v[40:43], v62 offset:64
v_add_f32 v56, v56, v6
v_mfma_f32_16x16x32_bf16 v[20:23], v[44:47], a[24:27], v[20:23]
ds_read_b64 v[58:59], v63 offset:96
v_add_f32 v56, v56, v7
v_mfma_f32_16x16x32_bf16 v[28:31], v[44:47], a[28:31], v[28:31]
ds_read_b128 v[44:47], v62 offset:320
s_waitcnt lgkmcnt(3)
v_mfma_f32_16x16x32_bf16 v[16:19], v[32:35], a[32:35], v[16:19]
v_exp_f32 v12, v12
v_mfma_f32_16x16x32_bf16 v[24:27], v[32:35], a[36:39], v[24:27]
ds_read_b128 v[32:35], v62 offset:128
v_cvt_pk_bf16_f32 v3, v6, v7
v_mfma_f32_16x16x32_bf16 v[20:23], v[36:39], a[32:35], v[20:23]
v_exp_f32 v13, v13
v_add_f32 v57, v57, v8
v_mfma_f32_16x16x32_bf16 v[28:31], v[36:39], a[36:39], v[28:31]
ds_read_b128 v[36:39], v62 offset:384
s_waitcnt lgkmcnt(2)
v_mfma_f32_16x16x32_bf16 v[16:19], v[40:43], a[40:43], v[16:19]
v_exp_f32 v14, v14
v_mfma_f32_16x16x32_bf16 v[24:27], v[40:43], a[44:47], v[24:27]
ds_read_b128 v[40:43], v62 offset:192
v_add_f32 v57, v57, v9
v_mfma_f32_16x16x32_bf16 v[20:23], v[44:47], a[40:43], v[20:23]
v_exp_f32 v15, v15
v_mfma_f32_16x16x32_bf16 v[28:31], v[44:47], a[44:47], v[28:31]
ds_read_b128 v[44:47], v62 offset:448
s_waitcnt lgkmcnt(2)
v_mfma_f32_16x16x32_bf16 v[16:19], v[32:35], a[48:51], v[16:19]
s_barrier
v_add_u32 v62, v58, v61
v_cvt_pk_bf16_f32 v4, v8, v9
v_mfma_f32_16x16x32_bf16 v[24:27], v[32:35], a[52:55], v[24:27]
ds_read_b64_tr_b16 v[32:33], v62 offset:0
v_add_f32 v57, v57, v10
v_mfma_f32_16x16x32_bf16 v[20:23], v[36:39], a[48:51], v[20:23]
ds_read_b64_tr_b16 v[34:35], v62 offset:512
v_add_f32 v57, v57, v11
v_mfma_f32_16x16x32_bf16 v[28:31], v[36:39], a[52:55], v[28:31]
ds_read_b64_tr_b16 v[36:37], v62 offset:32
s_waitcnt lgkmcnt(3)
v_mfma_f32_16x16x32_bf16 v[16:19], v[40:43], a[56:59], v[16:19]
ds_read_b64_tr_b16 v[38:39], v62 offset:544
v_cvt_pk_bf16_f32 v5, v10, v11
v_mfma_f32_16x16x32_bf16 v[24:27], v[40:43], a[60:63], v[24:27]
ds_read_b64_tr_b16 v[40:41], v62 offset:64
v_cvt_pk_bf16_f32 v6, v12, v13
v_cvt_pk_bf16_f32 v7, v14, v15
v_mfma_f32_16x16x32_bf16 v[20:23], v[44:47], a[56:59], v[20:23]
ds_read_b64_tr_b16 v[42:43], v62 offset:576
v_add_f32 v57, v57, v12
v_mfma_f32_16x16x32_bf16 v[28:31], v[44:47], a[60:63], v[28:31]
ds_read_b64_tr_b16 v[44:45], v62 offset:96
s_waitcnt lgkmcnt(3)
v_mfma_f32_16x16x32_bf16 v[64:67], v[32:35], v[0:3], v[64:67]
ds_read_b64_tr_b16 v[46:47], v62 offset:608
v_add_f32 v57, v57, v13
v_mfma_f32_16x16x32_bf16 v[72:75], v[32:35], v[4:7], v[72:75]
ds_read_b64_tr_b16 v[32:33], v62 offset:128
v_add_f32 v57, v57, v14
v_mfma_f32_16x16x32_bf16 v[68:71], v[36:39], v[0:3], v[68:71]
ds_read_b64_tr_b16 v[34:35], v62 offset:640
v_add_f32 v57, v57, v15
v_mfma_f32_16x16x32_bf16 v[76:79], v[36:39], v[4:7], v[76:79]
ds_read_b64_tr_b16 v[36:37], v62 offset:160
s_waitcnt lgkmcnt(3)
v_mfma_f32_16x16x32_bf16 v[80:83], v[40:43], v[0:3], v[80:83]
ds_read_b64_tr_b16 v[38:39], v62 offset:672
v_max3_f32 v8, v16, v17, v18
v_mfma_f32_16x16x32_bf16 v[88:91], v[40:43], v[4:7], v[88:91]
ds_read_b64_tr_b16 v[40:41], v62 offset:192
v_max3_f32 v9, v24, v25, v26
v_mfma_f32_16x16x32_bf16 v[84:87], v[44:47], v[0:3], v[84:87]
ds_read_b64_tr_b16 v[42:43], v62 offset:704
v_max3_f32 v8, v8, v19, v27
v_mfma_f32_16x16x32_bf16 v[92:95], v[44:47], v[4:7], v[92:95]
ds_read_b64_tr_b16 v[44:45], v62 offset:224
s_waitcnt lgkmcnt(3)
v_mfma_f32_16x16x32_bf16 v[96:99], v[32:35], v[0:3], v[96:99]
ds_read_b64_tr_b16 v[46:47], v62 offset:736
s_barrier
v_add_u32 v62, v59, v61
v_mfma_f32_16x16x32_bf16 v[104:107], v[32:35], v[4:7], v[104:107]
ds_read_b64_tr_b16 v[32:33], v62 offset:0
v_max3_f32 v9, v9, v20, v21
v_max3_f32 v8, v8, v22, v23
v_mfma_f32_16x16x32_bf16 v[100:103], v[36:39], v[0:3], v[100:103]
ds_read_b64_tr_b16 v[34:35], v62 offset:512
v_max3_f32 v9, v9, v28, v29
v_mfma_f32_16x16x32_bf16 v[108:111], v[36:39], v[4:7], v[108:111]
ds_read_b64_tr_b16 v[36:37], v62 offset:32
s_waitcnt lgkmcnt(3)
v_mfma_f32_16x16x32_bf16 v[112:115], v[40:43], v[0:3], v[112:115]
ds_read_b64_tr_b16 v[38:39], v62 offset:544
v_max3_f32 v8, v8, v30, v31
v_mfma_f32_16x16x32_bf16 v[120:123], v[40:43], v[4:7], v[120:123]
ds_read_b64_tr_b16 v[40:41], v62 offset:64
v_max_f32 v8, v8, v9
v_mfma_f32_16x16x32_bf16 v[116:119], v[44:47], v[0:3], v[116:119]
ds_read_b64_tr_b16 v[42:43], v62 offset:576
ds_read_b64 v[58:59], v63 offset:104
v_cmp_lt_f32 vcc, s42, v8
v_mfma_f32_16x16x32_bf16 v[124:127], v[44:47], v[4:7], v[124:127]
ds_read_b64_tr_b16 v[44:45], v62 offset:96
s_waitcnt lgkmcnt(4)
v_mfma_f32_16x16x32_bf16 v[128:131], v[32:35], v[0:3], v[128:131]
ds_read_b64_tr_b16 v[46:47], v62 offset:608
s_cbranch_vccnz L_ra_14
L_rab_14:
v_mfma_f32_16x16x32_bf16 v[136:139], v[32:35], v[4:7], v[136:139]
ds_read_b64_tr_b16 v[32:33], v62 offset:128
v_exp_f32 v16, v16
v_mfma_f32_16x16x32_bf16 v[132:135], v[36:39], v[0:3], v[132:135]
ds_read_b64_tr_b16 v[34:35], v62 offset:640
v_add_f32 v56, v56, v16
v_mfma_f32_16x16x32_bf16 v[140:143], v[36:39], v[4:7], v[140:143]
ds_read_b64_tr_b16 v[36:37], v62 offset:160
s_waitcnt lgkmcnt(3)
v_mfma_f32_16x16x32_bf16 v[144:147], v[40:43], v[0:3], v[144:147]
ds_read_b64_tr_b16 v[38:39], v62 offset:672
v_exp_f32 v17, v17
v_mfma_f32_16x16x32_bf16 v[152:155], v[40:43], v[4:7], v[152:155]
ds_read_b64_tr_b16 v[40:41], v62 offset:192
v_add_f32 v56, v56, v17
v_mfma_f32_16x16x32_bf16 v[148:151], v[44:47], v[0:3], v[148:151]
ds_read_b64_tr_b16 v[42:43], v62 offset:704
v_cvt_pk_bf16_f32 v16, v16, v17
v_mfma_f32_16x16x32_bf16 v[156:159], v[44:47], v[4:7], v[156:159]
ds_read_b64_tr_b16 v[44:45], v62 offset:224
s_waitcnt lgkmcnt(3)
v_mfma_f32_16x16x32_bf16 v[160:163], v[32:35], v[0:3], v[160:163]
ds_read_b64_tr_b16 v[46:47], v62 offset:736
s_barrier
v_add_u32 v62, v58, v61
v_mfma_f32_16x16x32_bf16 v[168:171], v[32:35], v[4:7], v[168:171]
ds_read_b64_tr_b16 v[32:33], v62 offset:0
v_exp_f32 v18, v18
v_mfma_f32_16x16x32_bf16 v[164:167], v[36:39], v[0:3], v[164:167]
ds_read_b64_tr_b16 v[34:35], v62 offset:512
v_exp_f32 v19, v19
v_mfma_f32_16x16x32_bf16 v[172:175], v[36:39], v[4:7], v[172:175]
ds_read_b64_tr_b16 v[36:37], v62 offset:32
s_waitcnt lgkmcnt(3)
v_mfma_f32_16x16x32_bf16 v[176:179], v[40:43], v[0:3], v[176:179]
ds_read_b64_tr_b16 v[38:39], v62 offset:544
v_exp_f32 v20, v20
v_mfma_f32_16x16x32_bf16 v[184:187], v[40:43], v[4:7], v[184:187]
ds_read_b64_tr_b16 v[40:41], v62 offset:64
v_add_f32 v56, v56, v18
v_mfma_f32_16x16x32_bf16 v[180:183], v[44:47], v[0:3], v[180:183]
ds_read_b64_tr_b16 v[42:43], v62 offset:576
v_exp_f32 v21, v21
v_mfma_f32_16x16x32_bf16 v[188:191], v[44:47], v[4:7], v[188:191]
ds_read_b64_tr_b16 v[44:45], v62 offset:96
s_cbranch_vccnz L_rb_14
L_rbb_14:
v_exp_f32 v22, v22
v_exp_f32 v23, v23
v_exp_f32 v24, v24
v_exp_f32 v25, v25
v_exp_f32 v26, v26
v_exp_f32 v27, v27
v_exp_f32 v28, v28
v_exp_f32 v29, v29
v_exp_f32 v30, v30
v_exp_f32 v31, v31
s_nop 0
v_add_f32 v56, v56, v19
v_cvt_pk_bf16_f32 v17, v18, v19
v_add_f32 v56, v56, v20
v_add_f32 v56, v56, v21
v_cvt_pk_bf16_f32 v18, v20, v21
v_add_f32 v56, v56, v22
v_add_f32 v56, v56, v23
v_cvt_pk_bf16_f32 v19, v22, v23
v_add_f32 v57, v57, v24
v_add_f32 v57, v57, v25
v_cvt_pk_bf16_f32 v20, v24, v25
v_add_f32 v57, v57, v26
v_add_f32 v57, v57, v27
v_cvt_pk_bf16_f32 v21, v26, v27
v_cvt_pk_bf16_f32 v22, v28, v29
v_cvt_pk_bf16_f32 v23, v30, v31
v_add_f32 v57, v57, v28
v_add_f32 v57, v57, v29
v_add_f32 v57, v57, v30
v_add_f32 v57, v57, v31
s_nop 1
s_waitcnt lgkmcnt(3)
v_mfma_f32_16x16x32_bf16 v[64:67], v[32:35], v[16:19], v[64:67]
ds_read_b64_tr_b16 v[46:47], v62 offset:608
v_mov_b32 v24, v56
v_mov_b32 v25, v57
s_nop 1
v_permlane16_swap_b32 v24, v56
v_permlane16_swap_b32 v25, v57
s_nop 1
v_mfma_f32_16x16x32_bf16 v[72:75], v[32:35], v[20:23], v[72:75]
ds_read_b64_tr_b16 v[32:33], v62 offset:128
v_add_f32 v56, v56, v24
v_add_f32 v57, v57, v25
v_mov_b32 v24, v56
v_mov_b32 v25, v57
s_nop 1
v_mfma_f32_16x16x32_bf16 v[68:71], v[36:39], v[16:19], v[68:71]
ds_read_b64_tr_b16 v[34:35], v62 offset:640
v_permlane32_swap_b32 v24, v56
v_permlane32_swap_b32 v25, v57
s_nop 1
v_add_f32 v56, v56, v24
v_add_f32 v57, v57, v25
v_mbcnt_lo_u32_b32 v26, -1, 0
v_mfma_f32_16x16x32_bf16 v[76:79], v[36:39], v[20:23], v[76:79]
ds_read_b64_tr_b16 v[36:37], v62 offset:160
v_mbcnt_hi_u32_b32 v26, -1, v26
v_mov_b32 v54, v48
v_lshlrev_b32 v51, 4, v26
s_lshl_b32 s6, s3, 10
s_add_u32 s6, s6, 1024
s_waitcnt lgkmcnt(3)
v_mfma_f32_16x16x32_bf16 v[80:83], v[40:43], v[16:19], v[80:83]
ds_read_b64_tr_b16 v[38:39], v62 offset:672
v_add_u32 v27, s6, v51
ds_write_b128 v27, v[54:57]
s_xor_b32 s7, s3, 2
s_lshl_b32 s7, s7, 10
s_add_u32 s7, s7, 1024
v_mfma_f32_16x16x32_bf16 v[88:91], v[40:43], v[20:23], v[88:91]
ds_read_b64_tr_b16 v[40:41], v62 offset:192
v_add_u32 v27, s7, v51
s_lshl_b32 s6, s36, 2
v_mov_b32 v49, s6
ds_read_b32 v49, v49 offset:336
v_mfma_f32_16x16x32_bf16 v[84:87], v[44:47], v[16:19], v[84:87]
ds_read_b64_tr_b16 v[42:43], v62 offset:704
v_bfe_u32 v24, v26, 2, 3
v_mul_u32_u24 v60, 1056, v24
v_lshrrev_b32 v24, 5, v26
v_lshl_add_u32 v60, v24, 7, v60
v_and_b32 v24, 3, v26
v_mfma_f32_16x16x32_bf16 v[92:95], v[44:47], v[20:23], v[92:95]
ds_read_b64_tr_b16 v[44:45], v62 offset:224
v_lshl_add_u32 v60, v24, 3, v60
s_lshl_b32 s6, s37, 6
v_add_u32 v60, s6, v60
s_waitcnt lgkmcnt(5)
v_mfma_f32_16x16x32_bf16 v[96:99], v[32:35], v[16:19], v[96:99]
ds_read_b64_tr_b16 v[46:47], v62 offset:736
s_waitcnt lgkmcnt(5)
s_barrier
v_add_u32 v62, v59, v61
ds_read_b128 v[28:31], v27
v_mov_b32 v61, v51
v_mfma_f32_16x16x32_bf16 v[104:107], v[32:35], v[20:23], v[104:107]
ds_read_b64_tr_b16 v[32:33], v62 offset:0
ds_read_b64_tr_b16 v[34:35], v62 offset:512
v_mfma_f32_16x16x32_bf16 v[100:103], v[36:39], v[16:19], v[100:103]
ds_read_b64_tr_b16 v[0:1], v62 offset:128
ds_read_b64_tr_b16 v[2:3], v62 offset:640
v_mfma_f32_16x16x32_bf16 v[108:111], v[36:39], v[20:23], v[108:111]
ds_read_b64_tr_b16 v[36:37], v62 offset:32
ds_read_b64_tr_b16 v[38:39], v62 offset:544
s_waitcnt lgkmcnt(7)
v_mfma_f32_16x16x32_bf16 v[112:115], v[40:43], v[16:19], v[112:115]
ds_read_b64_tr_b16 v[4:5], v62 offset:160
ds_read_b64_tr_b16 v[6:7], v62 offset:672
s_lshl_b32 s6, s37, 13
s_xor_b32 s7, s6, 0x2000
v_add3_u32 v50, v49, v61, s7
v_add3_u32 v49, v49, v61, s6
s_waitcnt lgkmcnt(8)
v_min_f32 v26, v28, v54
v_sub_f32 v24, v26, v54
v_mfma_f32_16x16x32_bf16 v[120:123], v[40:43], v[20:23], v[120:123]
ds_read_b64_tr_b16 v[40:41], v62 offset:64
ds_read_b64_tr_b16 v[42:43], v62 offset:576
v_sub_f32 v28, v26, v28
v_exp_f32 v24, v24
v_exp_f32 v28, v28
v_mfma_f32_16x16x32_bf16 v[116:119], v[44:47], v[16:19], v[116:119]
ds_read_b64_tr_b16 v[8:9], v62 offset:192
ds_read_b64_tr_b16 v[10:11], v62 offset:704
s_nop 0
v_mul_f32 v26, v56, v24
v_fmac_f32 v26, v30, v28
v_rcp_f32 v26, v26
s_nop 0
v_mul_f32 v24, v24, v26
v_min_f32 v26, v29, v55
v_mfma_f32_16x16x32_bf16 v[124:127], v[44:47], v[20:23], v[124:127]
ds_read_b64_tr_b16 v[44:45], v62 offset:96
ds_read_b64_tr_b16 v[46:47], v62 offset:608
v_sub_f32 v25, v26, v55
v_sub_f32 v29, v26, v29
v_exp_f32 v25, v25
v_exp_f32 v29, v29
s_waitcnt lgkmcnt(8)
v_mfma_f32_16x16x32_bf16 v[128:131], v[32:35], v[16:19], v[128:131]
ds_read_b64_tr_b16 v[12:13], v62 offset:224
ds_read_b64_tr_b16 v[14:15], v62 offset:736
s_nop 0
v_mul_f32 v26, v57, v25
v_fmac_f32 v26, v31, v29
v_rcp_f32 v26, v26
s_nop 0
v_mfma_f32_16x16x32_bf16 v[136:139], v[32:35], v[20:23], v[136:139]
v_mul_f32 v25, v25, v26
v_mov_b32 v54, v24
v_mov_b32 v56, v25
s_lshl_b32 s6, s37, 2
v_mov_b32 v52, s6
v_xor_b32 v53, 4, v52
v_mfma_f32_16x16x32_bf16 v[132:135], v[36:39], v[16:19], v[132:135]
v_mul_f32 v64, v64, v54
v_mul_f32 v65, v65, v54
v_mul_f32 v66, v66, v54
v_mul_f32 v67, v67, v54
v_mul_f32 v68, v68, v54
v_mul_f32 v69, v69, v54
v_mul_f32 v70, v70, v54
v_mul_f32 v71, v71, v54
v_mfma_f32_16x16x32_bf16 v[140:143], v[36:39], v[20:23], v[140:143]
v_cvt_pk_bf16_f32 v64, v64, v65
v_cvt_pk_bf16_f32 v65, v66, v67
v_cvt_pk_bf16_f32 v66, v68, v69
v_cvt_pk_bf16_f32 v67, v70, v71
ds_write_b128 v49, v[64:67] offset:0
v_mul_f32 v72, v72, v56
s_waitcnt lgkmcnt(3)
v_mfma_f32_16x16x32_bf16 v[144:147], v[40:43], v[16:19], v[144:147]
v_mul_f32 v73, v73, v56
v_mul_f32 v74, v74, v56
v_mul_f32 v75, v75, v56
v_mul_f32 v76, v76, v56
v_mul_f32 v77, v77, v56
v_mul_f32 v78, v78, v56
v_mul_f32 v79, v79, v56
v_cvt_pk_bf16_f32 v68, v72, v73
v_mfma_f32_16x16x32_bf16 v[152:155], v[40:43], v[20:23], v[152:155]
v_cvt_pk_bf16_f32 v69, v74, v75
v_cvt_pk_bf16_f32 v70, v76, v77
v_cvt_pk_bf16_f32 v71, v78, v79
ds_write_b128 v49, v[68:71] offset:1024
v_mul_f32 v80, v80, v54
v_mul_f32 v81, v81, v54
v_mul_f32 v82, v82, v54
v_mfma_f32_16x16x32_bf16 v[148:151], v[44:47], v[16:19], v[148:151]
v_mul_f32 v83, v83, v54
v_mul_f32 v84, v84, v54
v_mul_f32 v85, v85, v54
v_mul_f32 v86, v86, v54
v_mul_f32 v87, v87, v54
v_cvt_pk_bf16_f32 v72, v80, v81
v_cvt_pk_bf16_f32 v73, v82, v83
v_cvt_pk_bf16_f32 v74, v84, v85
v_mfma_f32_16x16x32_bf16 v[156:159], v[44:47], v[20:23], v[156:159]
v_cvt_pk_bf16_f32 v75, v86, v87
ds_write_b128 v49, v[72:75] offset:2048
v_mul_f32 v88, v88, v56
v_mul_f32 v89, v89, v56
v_mul_f32 v90, v90, v56
v_mul_f32 v91, v91, v56
v_mul_f32 v92, v92, v56
v_mfma_f32_16x16x32_bf16 v[160:163], v[0:3], v[16:19], v[160:163]
v_mul_f32 v93, v93, v56
v_mul_f32 v94, v94, v56
v_mul_f32 v95, v95, v56
v_cvt_pk_bf16_f32 v76, v88, v89
v_cvt_pk_bf16_f32 v77, v90, v91
v_cvt_pk_bf16_f32 v78, v92, v93
v_cvt_pk_bf16_f32 v79, v94, v95
ds_write_b128 v49, v[76:79] offset:3072
v_mfma_f32_16x16x32_bf16 v[168:171], v[0:3], v[20:23], v[168:171]
v_mul_f32 v96, v96, v54
v_mul_f32 v97, v97, v54
v_mul_f32 v98, v98, v54
v_mul_f32 v99, v99, v54
v_mul_f32 v100, v100, v54
v_mul_f32 v101, v101, v54
v_mul_f32 v102, v102, v54
v_mfma_f32_16x16x32_bf16 v[164:167], v[4:7], v[16:19], v[164:167]
v_mul_f32 v103, v103, v54
v_cvt_pk_bf16_f32 v80, v96, v97
v_cvt_pk_bf16_f32 v81, v98, v99
v_cvt_pk_bf16_f32 v82, v100, v101
v_cvt_pk_bf16_f32 v83, v102, v103
ds_write_b128 v49, v[80:83] offset:4096
v_mul_f32 v104, v104, v56
v_mul_f32 v105, v105, v56
v_mfma_f32_16x16x32_bf16 v[172:175], v[4:7], v[20:23], v[172:175]
v_mul_f32 v106, v106, v56
v_mul_f32 v107, v107, v56
v_mul_f32 v108, v108, v56
v_mul_f32 v109, v109, v56
v_mul_f32 v110, v110, v56
v_mul_f32 v111, v111, v56
v_cvt_pk_bf16_f32 v84, v104, v105
s_waitcnt lgkmcnt(5)
v_mfma_f32_16x16x32_bf16 v[176:179], v[8:11], v[16:19], v[176:179]
v_cvt_pk_bf16_f32 v85, v106, v107
v_cvt_pk_bf16_f32 v86, v108, v109
v_cvt_pk_bf16_f32 v87, v110, v111
ds_write_b128 v49, v[84:87] offset:5120
v_mul_f32 v112, v112, v54
v_mul_f32 v113, v113, v54
v_mul_f32 v114, v114, v54
v_mul_f32 v115, v115, v54
v_mfma_f32_16x16x32_bf16 v[184:187], v[8:11], v[20:23], v[184:187]
v_mul_f32 v116, v116, v54
v_mul_f32 v117, v117, v54
v_mul_f32 v118, v118, v54
v_mul_f32 v119, v119, v54
v_cvt_pk_bf16_f32 v88, v112, v113
v_cvt_pk_bf16_f32 v89, v114, v115
v_cvt_pk_bf16_f32 v90, v116, v117
v_mfma_f32_16x16x32_bf16 v[180:183], v[12:15], v[16:19], v[180:183]
v_mfma_f32_16x16x32_bf16 v[188:191], v[12:15], v[20:23], v[188:191]
v_cvt_pk_bf16_f32 v91, v118, v119
ds_write_b128 v49, v[88:91] offset:6144
v_mul_f32 v120, v120, v56
v_mul_f32 v121, v121, v56
v_mul_f32 v122, v122, v56
v_mul_f32 v123, v123, v56
v_mul_f32 v124, v124, v56
v_mul_f32 v125, v125, v56
v_mul_f32 v126, v126, v56
v_mul_f32 v127, v127, v56
v_cvt_pk_bf16_f32 v92, v120, v121
v_cvt_pk_bf16_f32 v93, v122, v123
v_cvt_pk_bf16_f32 v94, v124, v125
v_cvt_pk_bf16_f32 v95, v126, v127
ds_write_b128 v49, v[92:95] offset:7168
v_mov_b32 v51, 0
global_load_dword v48, v51, s[0:1] sc1
s_mov_b32 s62, s44
s_waitcnt lgkmcnt(0)
s_barrier
ds_read_b128 v[96:99], v50 offset:0
ds_read_b128 v[100:103], v50 offset:1024
ds_read_b128 v[104:107], v50 offset:2048
ds_read_b128 v[108:111], v50 offset:3072
ds_read_b128 v[112:115], v50 offset:4096
ds_read_b128 v[116:119], v50 offset:5120
ds_read_b128 v[120:123], v50 offset:6144
ds_read_b128 v[124:127], v50 offset:7168
ds_read_b32 v58, v52 offset:344
s_waitcnt lgkmcnt(0)
v_add_u32 v62, v58, v60
ds_read_b64_tr_b16 v[32:33], v62 offset:0
ds_read_b64_tr_b16 v[34:35], v62 offset:256
ds_read_b64_tr_b16 v[36:37], v62 offset:32
ds_read_b64_tr_b16 v[38:39], v62 offset:288
ds_read_b64_tr_b16 v[40:41], v62 offset:512
ds_read_b64_tr_b16 v[42:43], v62 offset:768
ds_read_b64_tr_b16 v[44:45], v62 offset:544
ds_read_b64_tr_b16 v[46:47], v62 offset:800
v_lshlrev_b32 v0, 16, v96
v_and_b32 v1, 0xffff0000, v96
v_lshlrev_b32 v2, 16, v97
v_and_b32 v3, 0xffff0000, v97
v_lshlrev_b32 v4, 16, v98
v_and_b32 v5, 0xffff0000, v98
v_lshlrev_b32 v6, 16, v99
v_and_b32 v7, 0xffff0000, v99
v_pk_fma_f32 v[128:129], v[128:129], v[54:55], v[0:1] op_sel_hi:[1,0,1]
v_pk_fma_f32 v[130:131], v[130:131], v[54:55], v[2:3] op_sel_hi:[1,0,1]
v_pk_fma_f32 v[132:133], v[132:133], v[54:55], v[4:5] op_sel_hi:[1,0,1]
v_pk_fma_f32 v[134:135], v[134:135], v[54:55], v[6:7] op_sel_hi:[1,0,1]
v_cvt_pk_bf16_f32 v64, v128, v129
v_cvt_pk_bf16_f32 v65, v130, v131
v_cvt_pk_bf16_f32 v66, v132, v133
v_cvt_pk_bf16_f32 v67, v134, v135
ds_write_b128 v50, v[64:67] offset:0
v_lshlrev_b32 v8, 16, v100
v_and_b32 v9, 0xffff0000, v100
v_lshlrev_b32 v10, 16, v101
v_and_b32 v11, 0xffff0000, v101
v_lshlrev_b32 v12, 16, v102
v_and_b32 v13, 0xffff0000, v102
v_lshlrev_b32 v14, 16, v103
v_and_b32 v15, 0xffff0000, v103
v_pk_fma_f32 v[136:137], v[136:137], v[56:57], v[8:9] op_sel_hi:[1,0,1]
v_pk_fma_f32 v[138:139], v[138:139], v[56:57], v[10:11] op_sel_hi:[1,0,1]
v_pk_fma_f32 v[140:141], v[140:141], v[56:57], v[12:13] op_sel_hi:[1,0,1]
v_pk_fma_f32 v[142:143], v[142:143], v[56:57], v[14:15] op_sel_hi:[1,0,1]
v_cvt_pk_bf16_f32 v68, v136, v137
v_cvt_pk_bf16_f32 v69, v138, v139
v_cvt_pk_bf16_f32 v70, v140, v141
v_cvt_pk_bf16_f32 v71, v142, v143
ds_write_b128 v50, v[68:71] offset:1024
v_lshlrev_b32 v0, 16, v104
v_and_b32 v1, 0xffff0000, v104
v_lshlrev_b32 v2, 16, v105
v_and_b32 v3, 0xffff0000, v105
v_lshlrev_b32 v4, 16, v106
v_and_b32 v5, 0xffff0000, v106
v_lshlrev_b32 v6, 16, v107
v_and_b32 v7, 0xffff0000, v107
v_pk_fma_f32 v[144:145], v[144:145], v[54:55], v[0:1] op_sel_hi:[1,0,1]
v_pk_fma_f32 v[146:147], v[146:147], v[54:55], v[2:3] op_sel_hi:[1,0,1]
v_pk_fma_f32 v[148:149], v[148:149], v[54:55], v[4:5] op_sel_hi:[1,0,1]
v_pk_fma_f32 v[150:151], v[150:151], v[54:55], v[6:7] op_sel_hi:[1,0,1]
v_cvt_pk_bf16_f32 v72, v144, v145
v_cvt_pk_bf16_f32 v73, v146, v147
v_cvt_pk_bf16_f32 v74, v148, v149
v_cvt_pk_bf16_f32 v75, v150, v151
ds_write_b128 v50, v[72:75] offset:2048
v_lshlrev_b32 v8, 16, v108
v_and_b32 v9, 0xffff0000, v108
v_lshlrev_b32 v10, 16, v109
v_and_b32 v11, 0xffff0000, v109
v_lshlrev_b32 v12, 16, v110
v_and_b32 v13, 0xffff0000, v110
v_lshlrev_b32 v14, 16, v111
v_and_b32 v15, 0xffff0000, v111
v_pk_fma_f32 v[152:153], v[152:153], v[56:57], v[8:9] op_sel_hi:[1,0,1]
v_pk_fma_f32 v[154:155], v[154:155], v[56:57], v[10:11] op_sel_hi:[1,0,1]
v_pk_fma_f32 v[156:157], v[156:157], v[56:57], v[12:13] op_sel_hi:[1,0,1]
v_pk_fma_f32 v[158:159], v[158:159], v[56:57], v[14:15] op_sel_hi:[1,0,1]
v_cvt_pk_bf16_f32 v76, v152, v153
v_cvt_pk_bf16_f32 v77, v154, v155
v_cvt_pk_bf16_f32 v78, v156, v157
v_cvt_pk_bf16_f32 v79, v158, v159
ds_write_b128 v50, v[76:79] offset:3072
v_lshlrev_b32 v0, 16, v112
v_and_b32 v1, 0xffff0000, v112
v_lshlrev_b32 v2, 16, v113
v_and_b32 v3, 0xffff0000, v113
v_lshlrev_b32 v4, 16, v114
v_and_b32 v5, 0xffff0000, v114
v_lshlrev_b32 v6, 16, v115
v_and_b32 v7, 0xffff0000, v115
v_pk_fma_f32 v[160:161], v[160:161], v[54:55], v[0:1] op_sel_hi:[1,0,1]
v_pk_fma_f32 v[162:163], v[162:163], v[54:55], v[2:3] op_sel_hi:[1,0,1]
v_pk_fma_f32 v[164:165], v[164:165], v[54:55], v[4:5] op_sel_hi:[1,0,1]
v_pk_fma_f32 v[166:167], v[166:167], v[54:55], v[6:7] op_sel_hi:[1,0,1]
v_cvt_pk_bf16_f32 v80, v160, v161
v_cvt_pk_bf16_f32 v81, v162, v163
v_cvt_pk_bf16_f32 v82, v164, v165
v_cvt_pk_bf16_f32 v83, v166, v167
ds_write_b128 v50, v[80:83] offset:4096
v_lshlrev_b32 v8, 16, v116
v_and_b32 v9, 0xffff0000, v116
v_lshlrev_b32 v10, 16, v117
v_and_b32 v11, 0xffff0000, v117
v_lshlrev_b32 v12, 16, v118
v_and_b32 v13, 0xffff0000, v118
v_lshlrev_b32 v14, 16, v119
v_and_b32 v15, 0xffff0000, v119
v_pk_fma_f32 v[168:169], v[168:169], v[56:57], v[8:9] op_sel_hi:[1,0,1]
v_pk_fma_f32 v[170:171], v[170:171], v[56:57], v[10:11] op_sel_hi:[1,0,1]
v_pk_fma_f32 v[172:173], v[172:173], v[56:57], v[12:13] op_sel_hi:[1,0,1]
v_pk_fma_f32 v[174:175], v[174:175], v[56:57], v[14:15] op_sel_hi:[1,0,1]
v_cvt_pk_bf16_f32 v84, v168, v169
v_cvt_pk_bf16_f32 v85, v170, v171
v_cvt_pk_bf16_f32 v86, v172, v173
v_cvt_pk_bf16_f32 v87, v174, v175
ds_write_b128 v50, v[84:87] offset:5120
v_lshlrev_b32 v0, 16, v120
v_and_b32 v1, 0xffff0000, v120
v_lshlrev_b32 v2, 16, v121
v_and_b32 v3, 0xffff0000, v121
v_lshlrev_b32 v4, 16, v122
v_and_b32 v5, 0xffff0000, v122
v_lshlrev_b32 v6, 16, v123
v_and_b32 v7, 0xffff0000, v123
v_pk_fma_f32 v[176:177], v[176:177], v[54:55], v[0:1] op_sel_hi:[1,0,1]
v_pk_fma_f32 v[178:179], v[178:179], v[54:55], v[2:3] op_sel_hi:[1,0,1]
v_pk_fma_f32 v[180:181], v[180:181], v[54:55], v[4:5] op_sel_hi:[1,0,1]
v_pk_fma_f32 v[182:183], v[182:183], v[54:55], v[6:7] op_sel_hi:[1,0,1]
v_cvt_pk_bf16_f32 v88, v176, v177
v_cvt_pk_bf16_f32 v89, v178, v179
v_cvt_pk_bf16_f32 v90, v180, v181
v_cvt_pk_bf16_f32 v91, v182, v183
ds_write_b128 v50, v[88:91] offset:6144
v_lshlrev_b32 v8, 16, v124
v_and_b32 v9, 0xffff0000, v124
v_lshlrev_b32 v10, 16, v125
v_and_b32 v11, 0xffff0000, v125
v_lshlrev_b32 v12, 16, v126
v_and_b32 v13, 0xffff0000, v126
v_lshlrev_b32 v14, 16, v127
v_and_b32 v15, 0xffff0000, v127
v_pk_fma_f32 v[184:185], v[184:185], v[56:57], v[8:9] op_sel_hi:[1,0,1]
v_pk_fma_f32 v[186:187], v[186:187], v[56:57], v[10:11] op_sel_hi:[1,0,1]
v_pk_fma_f32 v[188:189], v[188:189], v[56:57], v[12:13] op_sel_hi:[1,0,1]
v_pk_fma_f32 v[190:191], v[190:191], v[56:57], v[14:15] op_sel_hi:[1,0,1]
v_cvt_pk_bf16_f32 v92, v184, v185
v_cvt_pk_bf16_f32 v93, v186, v187
v_cvt_pk_bf16_f32 v94, v188, v189
v_cvt_pk_bf16_f32 v95, v190, v191
s_waitcnt lgkmcnt(10)
ds_write_b128 v50, v[92:95] offset:7168
s_nop 1
v_mfma_f32_16x16x32_bf16 v[128:131], v[32:35], v[64:67], 0
ds_read_b32 v58, v53 offset:344
v_mfma_f32_16x16x32_bf16 v[136:139], v[32:35], v[68:71], 0
ds_read_b64_tr_b16 v[32:33], v62 offset:8448
v_mfma_f32_16x16x32_bf16 v[132:135], v[36:39], v[64:67], 0
ds_read_b64_tr_b16 v[34:35], v62 offset:8704
v_mfma_f32_16x16x32_bf16 v[140:143], v[36:39], v[68:71], 0
ds_read_b64_tr_b16 v[36:37], v62 offset:8480
s_waitcnt lgkmcnt(12)
v_mfma_f32_16x16x32_bf16 v[128:131], v[40:43], v[72:75], v[128:131]
ds_read_b64_tr_b16 v[38:39], v62 offset:8736
v_mfma_f32_16x16x32_bf16 v[136:139], v[40:43], v[76:79], v[136:139]
ds_read_b64_tr_b16 v[40:41], v62 offset:8960
v_mfma_f32_16x16x32_bf16 v[132:135], v[44:47], v[72:75], v[132:135]
ds_read_b64_tr_b16 v[42:43], v62 offset:9216
v_mfma_f32_16x16x32_bf16 v[140:143], v[44:47], v[76:79], v[140:143]
s_waitcnt lgkmcnt(10)
ds_read_b64_tr_b16 v[44:45], v62 offset:8992
s_waitcnt lgkmcnt(3)
v_mfma_f32_16x16x32_bf16 v[128:131], v[32:35], v[80:83], v[128:131]
ds_read_b64_tr_b16 v[46:47], v62 offset:9248
s_barrier
v_add_u32 v62, v58, v60
ds_read_b128 a[0:3], v49 offset:0
ds_read_b128 a[4:7], v49 offset:1024
ds_read_b128 a[8:11], v49 offset:2048
ds_read_b128 a[12:15], v49 offset:3072
ds_read_b128 a[16:19], v49 offset:4096
ds_read_b128 a[20:23], v49 offset:5120
ds_read_b128 a[24:27], v49 offset:6144
ds_read_b128 a[28:31], v49 offset:7168
v_mov_b32 v50, 0
v_mfma_f32_16x16x32_bf16 v[136:139], v[32:35], v[84:87], v[136:139]
ds_read_b64_tr_b16 v[32:33], v62 offset:0
v_mfma_f32_16x16x32_bf16 v[132:135], v[36:39], v[80:83], v[132:135]
ds_read_b64_tr_b16 v[34:35], v62 offset:256
v_mfma_f32_16x16x32_bf16 v[140:143], v[36:39], v[84:87], v[140:143]
ds_read_b64_tr_b16 v[36:37], v62 offset:32
s_waitcnt lgkmcnt(11)
v_mfma_f32_16x16x32_bf16 v[128:131], v[40:43], v[88:91], v[128:131]
ds_read_b64_tr_b16 v[38:39], v62 offset:288
v_mfma_f32_16x16x32_bf16 v[136:139], v[40:43], v[92:95], v[136:139]
ds_read_b64_tr_b16 v[40:41], v62 offset:512
v_mfma_f32_16x16x32_bf16 v[132:135], v[44:47], v[88:91], v[132:135]
ds_read_b64_tr_b16 v[42:43], v62 offset:768
ds_read_b32 v58, v52 offset:352
v_mfma_f32_16x16x32_bf16 v[140:143], v[44:47], v[92:95], v[140:143]
s_waitcnt lgkmcnt(10)
ds_read_b64_tr_b16 v[44:45], v62 offset:544
s_waitcnt lgkmcnt(4)
v_mfma_f32_16x16x32_bf16 v[128:131], v[32:35], a[0:3], v[128:131]
ds_read_b64_tr_b16 v[46:47], v62 offset:800
v_mfma_f32_16x16x32_bf16 v[136:139], v[32:35], a[4:7], v[136:139]
ds_read_b64_tr_b16 v[32:33], v62 offset:8448
v_mfma_f32_16x16x32_bf16 v[132:135], v[36:39], a[0:3], v[132:135]
ds_read_b64_tr_b16 v[34:35], v62 offset:8704
v_mfma_f32_16x16x32_bf16 v[140:143], v[36:39], a[4:7], v[140:143]
ds_read_b64_tr_b16 v[36:37], v62 offset:8480
s_waitcnt lgkmcnt(3)
v_mfma_f32_16x16x32_bf16 v[128:131], v[40:43], a[8:11], v[128:131]
ds_read_b64_tr_b16 v[38:39], v62 offset:8736
v_mfma_f32_16x16x32_bf16 v[136:139], v[40:43], a[12:15], v[136:139]
ds_read_b64_tr_b16 v[40:41], v62 offset:8960
v_mfma_f32_16x16x32_bf16 v[132:135], v[44:47], a[8:11], v[132:135]
ds_read_b64_tr_b16 v[42:43], v62 offset:9216
v_mfma_f32_16x16x32_bf16 v[140:143], v[44:47], a[12:15], v[140:143]
ds_read_b64_tr_b16 v[44:45], v62 offset:8992
s_waitcnt lgkmcnt(3)
v_mfma_f32_16x16x32_bf16 v[128:131], v[32:35], a[16:19], v[128:131]
ds_read_b64_tr_b16 v[46:47], v62 offset:9248
s_barrier
v_add_u32 v62, v58, v60
v_mfma_f32_16x16x32_bf16 v[136:139], v[32:35], a[20:23], v[136:139]
ds_read_b64_tr_b16 v[32:33], v62 offset:0
v_mfma_f32_16x16x32_bf16 v[132:135], v[36:39], a[16:19], v[132:135]
ds_read_b64_tr_b16 v[34:35], v62 offset:256
v_mfma_f32_16x16x32_bf16 v[140:143], v[36:39], a[20:23], v[140:143]
ds_read_b64_tr_b16 v[36:37], v62 offset:32
s_waitcnt lgkmcnt(3)
v_mfma_f32_16x16x32_bf16 v[128:131], v[40:43], a[24:27], v[128:131]
ds_read_b64_tr_b16 v[38:39], v62 offset:288
v_mfma_f32_16x16x32_bf16 v[136:139], v[40:43], a[28:31], v[136:139]
ds_read_b64_tr_b16 v[40:41], v62 offset:512
s_lshl_b32 s40, s3, 7
s_lshl_b32 s7, s33, 2
s_add_u32 s40, s40, s7
s_add_u32 s40, s40, s63
s_waitcnt vmcnt(0)
L_tag_c:
v_cmp_ne_u32 vcc, 0, v48
s_sub_u32 s41, s41, 1
s_cbranch_scc1 L_tagok_c
s_nop 2
s_cbranch_vccnz L_tagok_c
v_mov_b32 v50, 0
global_load_dword v48, v50, s[0:1] sc1
s_waitcnt vmcnt(0)
s_branch L_tag_c
L_tagok_c:
v_mfma_f32_16x16x32_bf16 v[132:135], v[44:47], a[24:27], v[132:135]
ds_read_b64_tr_b16 v[42:43], v62 offset:768
ds_read_b32 v58, v53 offset:352
v_mfma_f32_16x16x32_bf16 v[140:143], v[44:47], a[28:31], v[140:143]
ds_read_b64_tr_b16 v[44:45], v62 offset:544
s_waitcnt lgkmcnt(4)
v_mfma_f32_16x16x32_bf16 v[144:147], v[32:35], v[64:67], 0
ds_read_b64_tr_b16 v[46:47], v62 offset:800
v_mfma_f32_16x16x32_bf16 v[152:155], v[32:35], v[68:71], 0
ds_read_b64_tr_b16 v[32:33], v62 offset:8448
v_mfma_f32_16x16x32_bf16 v[148:151], v[36:39], v[64:67], 0
ds_read_b64_tr_b16 v[34:35], v62 offset:8704
v_mfma_f32_16x16x32_bf16 v[156:159], v[36:39], v[68:71], 0
ds_read_b64_tr_b16 v[36:37], v62 offset:8480
s_waitcnt lgkmcnt(3)
v_mfma_f32_16x16x32_bf16 v[144:147], v[40:43], v[72:75], v[144:147]
ds_read_b64_tr_b16 v[38:39], v62 offset:8736
s_lshl_b32 s43, s62, 16
s_add_u32 s43, s43, s39
v_mfma_f32_16x16x32_bf16 v[152:155], v[40:43], v[76:79], v[152:155]
ds_read_b64_tr_b16 v[40:41], v62 offset:8960
v_cvt_pk_bf16_f32 v16, v128, v129
v_mfma_f32_16x16x32_bf16 v[148:151], v[44:47], v[72:75], v[148:151]
ds_read_b64_tr_b16 v[42:43], v62 offset:9216
v_cvt_pk_bf16_f32 v17, v130, v131
v_cvt_pk_bf16_f32 v18, v132, v133
v_cvt_pk_bf16_f32 v19, v134, v135
v_mfma_f32_16x16x32_bf16 v[156:159], v[44:47], v[76:79], v[156:159]
ds_read_b64_tr_b16 v[44:45], v62 offset:8992
buffer_store_dwordx4 v[16:19], v61, s[28:31], s43 offen sc1
s_waitcnt lgkmcnt(3)
v_mfma_f32_16x16x32_bf16 v[144:147], v[32:35], v[80:83], v[144:147]
ds_read_b64_tr_b16 v[46:47], v62 offset:9248
s_barrier
v_add_u32 v62, v58, v60
v_mfma_f32_16x16x32_bf16 v[152:155], v[32:35], v[84:87], v[152:155]
ds_read_b64_tr_b16 v[32:33], v62 offset:0
v_mfma_f32_16x16x32_bf16 v[148:151], v[36:39], v[80:83], v[148:151]
ds_read_b64_tr_b16 v[34:35], v62 offset:256
v_mov_b32 v99, v48
v_mov_b32 v103, v48
v_mov_b32 v107, v48
v_mfma_f32_16x16x32_bf16 v[156:159], v[36:39], v[84:87], v[156:159]
ds_read_b64_tr_b16 v[36:37], v62 offset:32
s_add_u32 s43, s43, 16384
s_waitcnt lgkmcnt(3)
v_mfma_f32_16x16x32_bf16 v[144:147], v[40:43], v[88:91], v[144:147]
ds_read_b64_tr_b16 v[38:39], v62 offset:288
v_mov_b32 v111, v48
v_mov_b32 v115, v48
v_mfma_f32_16x16x32_bf16 v[152:155], v[40:43], v[92:95], v[152:155]
ds_read_b64_tr_b16 v[40:41], v62 offset:512
v_cvt_pk_bf16_f32 v20, v136, v137
v_mfma_f32_16x16x32_bf16 v[148:151], v[44:47], v[88:91], v[148:151]
ds_read_b64_tr_b16 v[42:43], v62 offset:768
ds_read_b32 v58, v52 offset:360
v_mov_b32 v119, v48
s_sub_u32 s45, s63, 16777216
v_mfma_f32_16x16x32_bf16 v[156:159], v[44:47], v[92:95], v[156:159]
ds_read_b64_tr_b16 v[44:45], v62 offset:544
v_cvt_pk_bf16_f32 v21, v138, v139
s_waitcnt lgkmcnt(4)
v_mfma_f32_16x16x32_bf16 v[144:147], v[32:35], a[0:3], v[144:147]
ds_read_b64_tr_b16 v[46:47], v62 offset:800
s_lshl_b32 s45, s45, 8
s_lshl_b32 s7, s3, 16
v_mfma_f32_16x16x32_bf16 v[152:155], v[32:35], a[4:7], v[152:155]
ds_read_b64_tr_b16 v[32:33], v62 offset:8448
v_cvt_pk_bf16_f32 v22, v140, v141
v_mfma_f32_16x16x32_bf16 v[148:151], v[36:39], a[0:3], v[148:151]
ds_read_b64_tr_b16 v[34:35], v62 offset:8704
s_add_u32 s45, s45, s7
s_lshl_b32 s7, s33, 12
v_mfma_f32_16x16x32_bf16 v[156:159], v[36:39], a[4:7], v[156:159]
ds_read_b64_tr_b16 v[36:37], v62 offset:8480
v_cvt_pk_bf16_f32 v23, v142, v143
s_waitcnt lgkmcnt(3)
v_mfma_f32_16x16x32_bf16 v[144:147], v[40:43], a[8:11], v[144:147]
ds_read_b64_tr_b16 v[38:39], v62 offset:8736
s_add_u32 s45, s45, s7
v_mfma_f32_16x16x32_bf16 v[152:155], v[40:43], a[12:15], v[152:155]
ds_read_b64_tr_b16 v[40:41], v62 offset:8960
s_add_u32 s45, s45, 33554432
v_mfma_f32_16x16x32_bf16 v[148:151], v[44:47], a[8:11], v[148:151]
ds_read_b64_tr_b16 v[42:43], v62 offset:9216
v_mfma_f32_16x16x32_bf16 v[156:159], v[44:47], a[12:15], v[156:159]
ds_read_b64_tr_b16 v[44:45], v62 offset:8992
buffer_store_dwordx4 v[20:23], v61, s[28:31], s43 offen sc1
s_waitcnt lgkmcnt(3)
v_mfma_f32_16x16x32_bf16 v[144:147], v[32:35], a[16:19], v[144:147]
ds_read_b64_tr_b16 v[46:47], v62 offset:9248
s_barrier
v_add_u32 v62, v58, v60
v_mfma_f32_16x16x32_bf16 v[152:155], v[32:35], a[20:23], v[152:155]
ds_read_b64_tr_b16 v[32:33], v62 offset:0
v_mfma_f32_16x16x32_bf16 v[148:151], v[36:39], a[16:19], v[148:151]
ds_read_b64_tr_b16 v[34:35], v62 offset:256
s_add_u32 s62, s62, 1
s_cmp_eq_u32 s62, 7
v_mfma_f32_16x16x32_bf16 v[156:159], v[36:39], a[20:23], v[156:159]
ds_read_b64_tr_b16 v[36:37], v62 offset:32
s_cselect_b32 s62, 0, s62
s_waitcnt lgkmcnt(3)
v_mfma_f32_16x16x32_bf16 v[144:147], v[40:43], a[24:27], v[144:147]
ds_read_b64_tr_b16 v[38:39], v62 offset:288
v_mfma_f32_16x16x32_bf16 v[152:155], v[40:43], a[28:31], v[152:155]
ds_read_b64_tr_b16 v[40:41], v62 offset:512
v_mfma_f32_16x16x32_bf16 v[148:151], v[44:47], a[24:27], v[148:151]
ds_read_b64_tr_b16 v[42:43], v62 offset:768
ds_read_b32 v58, v53 offset:360
v_mfma_f32_16x16x32_bf16 v[156:159], v[44:47], a[28:31], v[156:159]
ds_read_b64_tr_b16 v[44:45], v62 offset:544
s_waitcnt lgkmcnt(4)
v_mfma_f32_16x16x32_bf16 v[128:131], v[32:35], v[64:67], 0
ds_read_b64_tr_b16 v[46:47], v62 offset:800
v_mfma_f32_16x16x32_bf16 v[136:139], v[32:35], v[68:71], 0
ds_read_b64_tr_b16 v[32:33], v62 offset:8448
v_mfma_f32_16x16x32_bf16 v[132:135], v[36:39], v[64:67], 0
ds_read_b64_tr_b16 v[34:35], v62 offset:8704
v_mfma_f32_16x16x32_bf16 v[140:143], v[36:39], v[68:71], 0
ds_read_b64_tr_b16 v[36:37], v62 offset:8480
s_waitcnt lgkmcnt(3)
v_mfma_f32_16x16x32_bf16 v[128:131], v[40:43], v[72:75], v[128:131]
ds_read_b64_tr_b16 v[38:39], v62 offset:8736
s_lshl_b32 s43, s62, 16
s_add_u32 s43, s43, s39
v_mfma_f32_16x16x32_bf16 v[136:139], v[40:43], v[76:79], v[136:139]
ds_read_b64_tr_b16 v[40:41], v62 offset:8960
v_cvt_pk_bf16_f32 v24, v144, v145
v_mfma_f32_16x16x32_bf16 v[132:135], v[44:47], v[72:75], v[132:135]
ds_read_b64_tr_b16 v[42:43], v62 offset:9216
v_cvt_pk_bf16_f32 v25, v146, v147
v_cvt_pk_bf16_f32 v26, v148, v149
v_cvt_pk_bf16_f32 v27, v150, v151
v_mfma_f32_16x16x32_bf16 v[140:143], v[44:47], v[76:79], v[140:143]
ds_read_b64_tr_b16 v[44:45], v62 offset:8992
buffer_store_dwordx4 v[24:27], v61, s[28:31], s43 offen sc1
s_waitcnt lgkmcnt(3)
v_mfma_f32_16x16x32_bf16 v[128:131], v[32:35], v[80:83], v[128:131]
ds_read_b64_tr_b16 v[46:47], v62 offset:9248
s_barrier
v_add_u32 v62, v58, v60
v_mfma_f32_16x16x32_bf16 v[136:139], v[32:35], v[84:87], v[136:139]
ds_read_b64_tr_b16 v[32:33], v62 offset:0
v_mfma_f32_16x16x32_bf16 v[132:135], v[36:39], v[80:83], v[132:135]
ds_read_b64_tr_b16 v[34:35], v62 offset:256
s_add_u32 s43, s43, 16384
v_mfma_f32_16x16x32_bf16 v[140:143], v[36:39], v[84:87], v[140:143]
ds_read_b64_tr_b16 v[36:37], v62 offset:32
s_waitcnt lgkmcnt(3)
v_mfma_f32_16x16x32_bf16 v[128:131], v[40:43], v[88:91], v[128:131]
ds_read_b64_tr_b16 v[38:39], v62 offset:288
v_cvt_pk_bf16_f32 v28, v152, v153
v_mfma_f32_16x16x32_bf16 v[136:139], v[40:43], v[92:95], v[136:139]
ds_read_b64_tr_b16 v[40:41], v62 offset:512
v_mfma_f32_16x16x32_bf16 v[132:135], v[44:47], v[88:91], v[132:135]
ds_read_b64_tr_b16 v[42:43], v62 offset:768
ds_read_b32 v58, v52 offset:368
v_cvt_pk_bf16_f32 v29, v154, v155
v_mfma_f32_16x16x32_bf16 v[140:143], v[44:47], v[92:95], v[140:143]
ds_read_b64_tr_b16 v[44:45], v62 offset:544
s_waitcnt lgkmcnt(4)
v_mfma_f32_16x16x32_bf16 v[128:131], v[32:35], a[0:3], v[128:131]
ds_read_b64_tr_b16 v[46:47], v62 offset:800
v_cvt_pk_bf16_f32 v30, v156, v157
v_mfma_f32_16x16x32_bf16 v[136:139], v[32:35], a[4:7], v[136:139]
ds_read_b64_tr_b16 v[32:33], v62 offset:8448
v_mfma_f32_16x16x32_bf16 v[132:135], v[36:39], a[0:3], v[132:135]
ds_read_b64_tr_b16 v[34:35], v62 offset:8704
v_cvt_pk_bf16_f32 v31, v158, v159
v_mfma_f32_16x16x32_bf16 v[140:143], v[36:39], a[4:7], v[140:143]
ds_read_b64_tr_b16 v[36:37], v62 offset:8480
s_waitcnt lgkmcnt(3)
v_mfma_f32_16x16x32_bf16 v[128:131], v[40:43], a[8:11], v[128:131]
ds_read_b64_tr_b16 v[38:39], v62 offset:8736
v_mfma_f32_16x16x32_bf16 v[136:139], v[40:43], a[12:15], v[136:139]
ds_read_b64_tr_b16 v[40:41], v62 offset:8960
v_mfma_f32_16x16x32_bf16 v[132:135], v[44:47], a[8:11], v[132:135]
ds_read_b64_tr_b16 v[42:43], v62 offset:9216
v_mfma_f32_16x16x32_bf16 v[140:143], v[44:47], a[12:15], v[140:143]
ds_read_b64_tr_b16 v[44:45], v62 offset:8992
buffer_store_dwordx4 v[28:31], v61, s[28:31], s43 offen sc1
s_waitcnt lgkmcnt(3)
v_mfma_f32_16x16x32_bf16 v[128:131], v[32:35], a[16:19], v[128:131]
ds_read_b64_tr_b16 v[46:47], v62 offset:9248
s_barrier
v_add_u32 v62, v58, v60
v_mfma_f32_16x16x32_bf16 v[136:139], v[32:35], a[20:23], v[136:139]
ds_read_b64_tr_b16 v[32:33], v62 offset:0
v_mfma_f32_16x16x32_bf16 v[132:135], v[36:39], a[16:19], v[132:135]
ds_read_b64_tr_b16 v[34:35], v62 offset:256
s_add_u32 s62, s62, 1
s_cmp_eq_u32 s62, 7
v_mfma_f32_16x16x32_bf16 v[140:143], v[36:39], a[20:23], v[140:143]
ds_read_b64_tr_b16 v[36:37], v62 offset:32
s_cselect_b32 s62, 0, s62
s_waitcnt lgkmcnt(3)
v_mfma_f32_16x16x32_bf16 v[128:131], v[40:43], a[24:27], v[128:131]
ds_read_b64_tr_b16 v[38:39], v62 offset:288
v_mfma_f32_16x16x32_bf16 v[136:139], v[40:43], a[28:31], v[136:139]
ds_read_b64_tr_b16 v[40:41], v62 offset:512
v_mfma_f32_16x16x32_bf16 v[132:135], v[44:47], a[24:27], v[132:135]
ds_read_b64_tr_b16 v[42:43], v62 offset:768
ds_read_b32 v58, v53 offset:368
v_mfma_f32_16x16x32_bf16 v[140:143], v[44:47], a[28:31], v[140:143]
ds_read_b64_tr_b16 v[44:45], v62 offset:544
s_waitcnt lgkmcnt(4)
v_mfma_f32_16x16x32_bf16 v[144:147], v[32:35], v[64:67], 0
ds_read_b64_tr_b16 v[46:47], v62 offset:800
v_mfma_f32_16x16x32_bf16 v[152:155], v[32:35], v[68:71], 0
ds_read_b64_tr_b16 v[32:33], v62 offset:8448
v_mfma_f32_16x16x32_bf16 v[148:151], v[36:39], v[64:67], 0
ds_read_b64_tr_b16 v[34:35], v62 offset:8704
v_mfma_f32_16x16x32_bf16 v[156:159], v[36:39], v[68:71], 0
ds_read_b64_tr_b16 v[36:37], v62 offset:8480
s_waitcnt lgkmcnt(3)
v_mfma_f32_16x16x32_bf16 v[144:147], v[40:43], v[72:75], v[144:147]
ds_read_b64_tr_b16 v[38:39], v62 offset:8736
s_lshl_b32 s43, s62, 16
s_add_u32 s43, s43, s39
v_mfma_f32_16x16x32_bf16 v[152:155], v[40:43], v[76:79], v[152:155]
ds_read_b64_tr_b16 v[40:41], v62 offset:8960
v_cvt_pk_bf16_f32 v16, v128, v129
v_mfma_f32_16x16x32_bf16 v[148:151], v[44:47], v[72:75], v[148:151]
ds_read_b64_tr_b16 v[42:43], v62 offset:9216
v_cvt_pk_bf16_f32 v17, v130, v131
v_cvt_pk_bf16_f32 v18, v132, v133
v_cvt_pk_bf16_f32 v19, v134, v135
v_mfma_f32_16x16x32_bf16 v[156:159], v[44:47], v[76:79], v[156:159]
ds_read_b64_tr_b16 v[44:45], v62 offset:8992
buffer_store_dwordx4 v[16:19], v61, s[28:31], s43 offen sc1
s_waitcnt lgkmcnt(3)
v_mfma_f32_16x16x32_bf16 v[144:147], v[32:35], v[80:83], v[144:147]
ds_read_b64_tr_b16 v[46:47], v62 offset:9248
s_barrier
v_add_u32 v62, v58, v60
v_mfma_f32_16x16x32_bf16 v[152:155], v[32:35], v[84:87], v[152:155]
ds_read_b64_tr_b16 v[32:33], v62 offset:0
v_mfma_f32_16x16x32_bf16 v[148:151], v[36:39], v[80:83], v[148:151]
ds_read_b64_tr_b16 v[34:35], v62 offset:256
s_add_u32 s43, s43, 16384
v_mfma_f32_16x16x32_bf16 v[156:159], v[36:39], v[84:87], v[156:159]
ds_read_b64_tr_b16 v[36:37], v62 offset:32
s_waitcnt lgkmcnt(3)
v_mfma_f32_16x16x32_bf16 v[144:147], v[40:43], v[88:91], v[144:147]
ds_read_b64_tr_b16 v[38:39], v62 offset:288
v_cvt_pk_bf16_f32 v20, v136, v137
v_mfma_f32_16x16x32_bf16 v[152:155], v[40:43], v[92:95], v[152:155]
ds_read_b64_tr_b16 v[40:41], v62 offset:512
v_mfma_f32_16x16x32_bf16 v[148:151], v[44:47], v[88:91], v[148:151]
ds_read_b64_tr_b16 v[42:43], v62 offset:768
ds_read_b32 v58, v52 offset:376
v_cvt_pk_bf16_f32 v21, v138, v139
v_mfma_f32_16x16x32_bf16 v[156:159], v[44:47], v[92:95], v[156:159]
ds_read_b64_tr_b16 v[44:45], v62 offset:544
s_waitcnt lgkmcnt(4)
v_mfma_f32_16x16x32_bf16 v[144:147], v[32:35], a[0:3], v[144:147]
ds_read_b64_tr_b16 v[46:47], v62 offset:800
v_cvt_pk_bf16_f32 v22, v140, v141
v_mfma_f32_16x16x32_bf16 v[152:155], v[32:35], a[4:7], v[152:155]
ds_read_b64_tr_b16 v[32:33], v62 offset:8448
v_mfma_f32_16x16x32_bf16 v[148:151], v[36:39], a[0:3], v[148:151]
ds_read_b64_tr_b16 v[34:35], v62 offset:8704
v_cvt_pk_bf16_f32 v23, v142, v143
v_mfma_f32_16x16x32_bf16 v[156:159], v[36:39], a[4:7], v[156:159]
ds_read_b64_tr_b16 v[36:37], v62 offset:8480
s_waitcnt lgkmcnt(3)
v_mfma_f32_16x16x32_bf16 v[144:147], v[40:43], a[8:11], v[144:147]
ds_read_b64_tr_b16 v[38:39], v62 offset:8736
v_mfma_f32_16x16x32_bf16 v[152:155], v[40:43], a[12:15], v[152:155]
ds_read_b64_tr_b16 v[40:41], v62 offset:8960
v_mfma_f32_16x16x32_bf16 v[148:151], v[44:47], a[8:11], v[148:151]
ds_read_b64_tr_b16 v[42:43], v62 offset:9216
v_mfma_f32_16x16x32_bf16 v[156:159], v[44:47], a[12:15], v[156:159]
ds_read_b64_tr_b16 v[44:45], v62 offset:8992
buffer_store_dwordx4 v[20:23], v61, s[28:31], s43 offen sc1
s_waitcnt lgkmcnt(3)
v_mfma_f32_16x16x32_bf16 v[144:147], v[32:35], a[16:19], v[144:147]
ds_read_b64_tr_b16 v[46:47], v62 offset:9248
s_barrier
v_add_u32 v62, v58, v60
v_mfma_f32_16x16x32_bf16 v[152:155], v[32:35], a[20:23], v[152:155]
ds_read_b64_tr_b16 v[32:33], v62 offset:0
v_mfma_f32_16x16x32_bf16 v[148:151], v[36:39], a[16:19], v[148:151]
ds_read_b64_tr_b16 v[34:35], v62 offset:256
s_add_u32 s62, s62, 1
s_cmp_eq_u32 s62, 7
v_mfma_f32_16x16x32_bf16 v[156:159], v[36:39], a[20:23], v[156:159]
ds_read_b64_tr_b16 v[36:37], v62 offset:32
s_cselect_b32 s62, 0, s62
s_waitcnt lgkmcnt(3)
v_mfma_f32_16x16x32_bf16 v[144:147], v[40:43], a[24:27], v[144:147]
ds_read_b64_tr_b16 v[38:39], v62 offset:288
v_mfma_f32_16x16x32_bf16 v[152:155], v[40:43], a[28:31], v[152:155]
ds_read_b64_tr_b16 v[40:41], v62 offset:512
v_mfma_f32_16x16x32_bf16 v[148:151], v[44:47], a[24:27], v[148:151]
ds_read_b64_tr_b16 v[42:43], v62 offset:768
ds_read_b32 v58, v53 offset:376
v_mfma_f32_16x16x32_bf16 v[156:159], v[44:47], a[28:31], v[156:159]
ds_read_b64_tr_b16 v[44:45], v62 offset:544
s_waitcnt lgkmcnt(4)
v_mfma_f32_16x16x32_bf16 v[128:131], v[32:35], v[64:67], 0
ds_read_b64_tr_b16 v[46:47], v62 offset:800
v_mfma_f32_16x16x32_bf16 v[136:139], v[32:35], v[68:71], 0
ds_read_b64_tr_b16 v[32:33], v62 offset:8448
v_mfma_f32_16x16x32_bf16 v[132:135], v[36:39], v[64:67], 0
ds_read_b64_tr_b16 v[34:35], v62 offset:8704
v_mfma_f32_16x16x32_bf16 v[140:143], v[36:39], v[68:71], 0
ds_read_b64_tr_b16 v[36:37], v62 offset:8480
s_waitcnt lgkmcnt(3)
v_mfma_f32_16x16x32_bf16 v[128:131], v[40:43], v[72:75], v[128:131]
ds_read_b64_tr_b16 v[38:39], v62 offset:8736
s_lshl_b32 s43, s62, 16
s_add_u32 s43, s43, s39
v_mfma_f32_16x16x32_bf16 v[136:139], v[40:43], v[76:79], v[136:139]
ds_read_b64_tr_b16 v[40:41], v62 offset:8960
v_cvt_pk_bf16_f32 v24, v144, v145
v_mfma_f32_16x16x32_bf16 v[132:135], v[44:47], v[72:75], v[132:135]
ds_read_b64_tr_b16 v[42:43], v62 offset:9216
v_cvt_pk_bf16_f32 v25, v146, v147
v_cvt_pk_bf16_f32 v26, v148, v149
v_cvt_pk_bf16_f32 v27, v150, v151
v_mfma_f32_16x16x32_bf16 v[140:143], v[44:47], v[76:79], v[140:143]
ds_read_b64_tr_b16 v[44:45], v62 offset:8992
buffer_store_dwordx4 v[24:27], v61, s[28:31], s43 offen sc1
s_waitcnt lgkmcnt(3)
v_mfma_f32_16x16x32_bf16 v[128:131], v[32:35], v[80:83], v[128:131]
ds_read_b64_tr_b16 v[46:47], v62 offset:9248
s_barrier
v_add_u32 v62, v58, v60
v_mfma_f32_16x16x32_bf16 v[136:139], v[32:35], v[84:87], v[136:139]
ds_read_b64_tr_b16 v[32:33], v62 offset:0
v_mfma_f32_16x16x32_bf16 v[132:135], v[36:39], v[80:83], v[132:135]
ds_read_b64_tr_b16 v[34:35], v62 offset:256
s_add_u32 s43, s43, 16384
v_mfma_f32_16x16x32_bf16 v[140:143], v[36:39], v[84:87], v[140:143]
ds_read_b64_tr_b16 v[36:37], v62 offset:32
s_waitcnt lgkmcnt(3)
v_mfma_f32_16x16x32_bf16 v[128:131], v[40:43], v[88:91], v[128:131]
ds_read_b64_tr_b16 v[38:39], v62 offset:288
v_cvt_pk_bf16_f32 v28, v152, v153
v_mfma_f32_16x16x32_bf16 v[136:139], v[40:43], v[92:95], v[136:139]
ds_read_b64_tr_b16 v[40:41], v62 offset:512
v_mfma_f32_16x16x32_bf16 v[132:135], v[44:47], v[88:91], v[132:135]
ds_read_b64_tr_b16 v[42:43], v62 offset:768
ds_read_b32 v58, v52 offset:384
v_cvt_pk_bf16_f32 v29, v154, v155
v_mfma_f32_16x16x32_bf16 v[140:143], v[44:47], v[92:95], v[140:143]
ds_read_b64_tr_b16 v[44:45], v62 offset:544
s_waitcnt lgkmcnt(4)
v_mfma_f32_16x16x32_bf16 v[128:131], v[32:35], a[0:3], v[128:131]
ds_read_b64_tr_b16 v[46:47], v62 offset:800
v_cvt_pk_bf16_f32 v30, v156, v157
v_mfma_f32_16x16x32_bf16 v[136:139], v[32:35], a[4:7], v[136:139]
ds_read_b64_tr_b16 v[32:33], v62 offset:8448
v_mfma_f32_16x16x32_bf16 v[132:135], v[36:39], a[0:3], v[132:135]
ds_read_b64_tr_b16 v[34:35], v62 offset:8704
v_cvt_pk_bf16_f32 v31, v158, v159
v_mfma_f32_16x16x32_bf16 v[140:143], v[36:39], a[4:7], v[140:143]
ds_read_b64_tr_b16 v[36:37], v62 offset:8480
s_waitcnt lgkmcnt(3)
v_mfma_f32_16x16x32_bf16 v[128:131], v[40:43], a[8:11], v[128:131]
ds_read_b64_tr_b16 v[38:39], v62 offset:8736
v_mfma_f32_16x16x32_bf16 v[136:139], v[40:43], a[12:15], v[136:139]
ds_read_b64_tr_b16 v[40:41], v62 offset:8960
v_mfma_f32_16x16x32_bf16 v[132:135], v[44:47], a[8:11], v[132:135]
ds_read_b64_tr_b16 v[42:43], v62 offset:9216
v_mfma_f32_16x16x32_bf16 v[140:143], v[44:47], a[12:15], v[140:143]
ds_read_b64_tr_b16 v[44:45], v62 offset:8992
buffer_store_dwordx4 v[28:31], v61, s[28:31], s43 offen sc1
s_waitcnt lgkmcnt(3)
v_mfma_f32_16x16x32_bf16 v[128:131], v[32:35], a[16:19], v[128:131]
ds_read_b64_tr_b16 v[46:47], v62 offset:9248
s_barrier
v_add_u32 v62, v58, v60
v_mfma_f32_16x16x32_bf16 v[136:139], v[32:35], a[20:23], v[136:139]
ds_read_b64_tr_b16 v[32:33], v62 offset:0
v_mfma_f32_16x16x32_bf16 v[132:135], v[36:39], a[16:19], v[132:135]
ds_read_b64_tr_b16 v[34:35], v62 offset:256
s_add_u32 s62, s62, 1
s_cmp_eq_u32 s62, 7
v_mfma_f32_16x16x32_bf16 v[140:143], v[36:39], a[20:23], v[140:143]
ds_read_b64_tr_b16 v[36:37], v62 offset:32
s_cselect_b32 s62, 0, s62
s_waitcnt lgkmcnt(3)
v_mfma_f32_16x16x32_bf16 v[128:131], v[40:43], a[24:27], v[128:131]
ds_read_b64_tr_b16 v[38:39], v62 offset:288
v_mfma_f32_16x16x32_bf16 v[136:139], v[40:43], a[28:31], v[136:139]
ds_read_b64_tr_b16 v[40:41], v62 offset:512
v_mfma_f32_16x16x32_bf16 v[132:135], v[44:47], a[24:27], v[132:135]
ds_read_b64_tr_b16 v[42:43], v62 offset:768
ds_read_b32 v58, v53 offset:384
v_mfma_f32_16x16x32_bf16 v[140:143], v[44:47], a[28:31], v[140:143]
ds_read_b64_tr_b16 v[44:45], v62 offset:544
s_waitcnt lgkmcnt(4)
v_mfma_f32_16x16x32_bf16 v[144:147], v[32:35], v[64:67], 0
ds_read_b64_tr_b16 v[46:47], v62 offset:800
v_mfma_f32_16x16x32_bf16 v[152:155], v[32:35], v[68:71], 0
ds_read_b64_tr_b16 v[32:33], v62 offset:8448
v_mfma_f32_16x16x32_bf16 v[148:151], v[36:39], v[64:67], 0
ds_read_b64_tr_b16 v[34:35], v62 offset:8704
v_mfma_f32_16x16x32_bf16 v[156:159], v[36:39], v[68:71], 0
ds_read_b64_tr_b16 v[36:37], v62 offset:8480
s_waitcnt lgkmcnt(3)
v_mfma_f32_16x16x32_bf16 v[144:147], v[40:43], v[72:75], v[144:147]
ds_read_b64_tr_b16 v[38:39], v62 offset:8736
s_lshl_b32 s43, s62, 16
s_add_u32 s43, s43, s39
v_mfma_f32_16x16x32_bf16 v[152:155], v[40:43], v[76:79], v[152:155]
ds_read_b64_tr_b16 v[40:41], v62 offset:8960
v_cvt_pk_bf16_f32 v16, v128, v129
v_mfma_f32_16x16x32_bf16 v[148:151], v[44:47], v[72:75], v[148:151]
ds_read_b64_tr_b16 v[42:43], v62 offset:9216
v_cvt_pk_bf16_f32 v17, v130, v131
v_cvt_pk_bf16_f32 v18, v132, v133
v_cvt_pk_bf16_f32 v19, v134, v135
v_mfma_f32_16x16x32_bf16 v[156:159], v[44:47], v[76:79], v[156:159]
ds_read_b64_tr_b16 v[44:45], v62 offset:8992
buffer_store_dwordx4 v[16:19], v61, s[28:31], s43 offen sc1
s_waitcnt lgkmcnt(3)
v_mfma_f32_16x16x32_bf16 v[144:147], v[32:35], v[80:83], v[144:147]
ds_read_b64_tr_b16 v[46:47], v62 offset:9248
s_barrier
v_add_u32 v62, v58, v60
v_mfma_f32_16x16x32_bf16 v[152:155], v[32:35], v[84:87], v[152:155]
ds_read_b64_tr_b16 v[32:33], v62 offset:0
v_mfma_f32_16x16x32_bf16 v[148:151], v[36:39], v[80:83], v[148:151]
ds_read_b64_tr_b16 v[34:35], v62 offset:256
s_add_u32 s43, s43, 16384
v_mfma_f32_16x16x32_bf16 v[156:159], v[36:39], v[84:87], v[156:159]
ds_read_b64_tr_b16 v[36:37], v62 offset:32
s_waitcnt lgkmcnt(3)
v_mfma_f32_16x16x32_bf16 v[144:147], v[40:43], v[88:91], v[144:147]
ds_read_b64_tr_b16 v[38:39], v62 offset:288
v_cvt_pk_bf16_f32 v20, v136, v137
v_mfma_f32_16x16x32_bf16 v[152:155], v[40:43], v[92:95], v[152:155]
ds_read_b64_tr_b16 v[40:41], v62 offset:512
v_mfma_f32_16x16x32_bf16 v[148:151], v[44:47], v[88:91], v[148:151]
ds_read_b64_tr_b16 v[42:43], v62 offset:768
ds_read_b32 v58, v52 offset:392
v_cvt_pk_bf16_f32 v21, v138, v139
v_mfma_f32_16x16x32_bf16 v[156:159], v[44:47], v[92:95], v[156:159]
ds_read_b64_tr_b16 v[44:45], v62 offset:544
s_waitcnt lgkmcnt(4)
v_mfma_f32_16x16x32_bf16 v[144:147], v[32:35], a[0:3], v[144:147]
ds_read_b64_tr_b16 v[46:47], v62 offset:800
v_cvt_pk_bf16_f32 v22, v140, v141
v_mfma_f32_16x16x32_bf16 v[152:155], v[32:35], a[4:7], v[152:155]
ds_read_b64_tr_b16 v[32:33], v62 offset:8448
v_mfma_f32_16x16x32_bf16 v[148:151], v[36:39], a[0:3], v[148:151]
ds_read_b64_tr_b16 v[34:35], v62 offset:8704
v_cvt_pk_bf16_f32 v23, v142, v143
v_mfma_f32_16x16x32_bf16 v[156:159], v[36:39], a[4:7], v[156:159]
ds_read_b64_tr_b16 v[36:37], v62 offset:8480
s_waitcnt lgkmcnt(3)
v_mfma_f32_16x16x32_bf16 v[144:147], v[40:43], a[8:11], v[144:147]
ds_read_b64_tr_b16 v[38:39], v62 offset:8736
v_mfma_f32_16x16x32_bf16 v[152:155], v[40:43], a[12:15], v[152:155]
ds_read_b64_tr_b16 v[40:41], v62 offset:8960
v_mfma_f32_16x16x32_bf16 v[148:151], v[44:47], a[8:11], v[148:151]
ds_read_b64_tr_b16 v[42:43], v62 offset:9216
v_mfma_f32_16x16x32_bf16 v[156:159], v[44:47], a[12:15], v[156:159]
ds_read_b64_tr_b16 v[44:45], v62 offset:8992
buffer_store_dwordx4 v[20:23], v61, s[28:31], s43 offen sc1
s_waitcnt lgkmcnt(3)
v_mfma_f32_16x16x32_bf16 v[144:147], v[32:35], a[16:19], v[144:147]
ds_read_b64_tr_b16 v[46:47], v62 offset:9248
s_barrier
v_add_u32 v62, v58, v60
v_mfma_f32_16x16x32_bf16 v[152:155], v[32:35], a[20:23], v[152:155]
ds_read_b64_tr_b16 v[32:33], v62 offset:0
v_mfma_f32_16x16x32_bf16 v[148:151], v[36:39], a[16:19], v[148:151]
ds_read_b64_tr_b16 v[34:35], v62 offset:256
s_add_u32 s62, s62, 1
s_cmp_eq_u32 s62, 7
v_mfma_f32_16x16x32_bf16 v[156:159], v[36:39], a[20:23], v[156:159]
ds_read_b64_tr_b16 v[36:37], v62 offset:32
s_cselect_b32 s62, 0, s62
s_waitcnt lgkmcnt(3)
v_mfma_f32_16x16x32_bf16 v[144:147], v[40:43], a[24:27], v[144:147]
ds_read_b64_tr_b16 v[38:39], v62 offset:288
v_mfma_f32_16x16x32_bf16 v[152:155], v[40:43], a[28:31], v[152:155]
ds_read_b64_tr_b16 v[40:41], v62 offset:512
v_mfma_f32_16x16x32_bf16 v[148:151], v[44:47], a[24:27], v[148:151]
ds_read_b64_tr_b16 v[42:43], v62 offset:768
ds_read_b32 v58, v53 offset:392
v_mfma_f32_16x16x32_bf16 v[156:159], v[44:47], a[28:31], v[156:159]
ds_read_b64_tr_b16 v[44:45], v62 offset:544
s_waitcnt lgkmcnt(4)
v_mfma_f32_16x16x32_bf16 v[128:131], v[32:35], v[64:67], 0
ds_read_b64_tr_b16 v[46:47], v62 offset:800
v_mfma_f32_16x16x32_bf16 v[136:139], v[32:35], v[68:71], 0
ds_read_b64_tr_b16 v[32:33], v62 offset:8448
v_mfma_f32_16x16x32_bf16 v[132:135], v[36:39], v[64:67], 0
ds_read_b64_tr_b16 v[34:35], v62 offset:8704
v_mfma_f32_16x16x32_bf16 v[140:143], v[36:39], v[68:71], 0
ds_read_b64_tr_b16 v[36:37], v62 offset:8480
s_waitcnt lgkmcnt(3)
v_mfma_f32_16x16x32_bf16 v[128:131], v[40:43], v[72:75], v[128:131]
ds_read_b64_tr_b16 v[38:39], v62 offset:8736
s_lshl_b32 s43, s62, 16
s_add_u32 s43, s43, s39
v_mfma_f32_16x16x32_bf16 v[136:139], v[40:43], v[76:79], v[136:139]
ds_read_b64_tr_b16 v[40:41], v62 offset:8960
v_cvt_pk_bf16_f32 v24, v144, v145
v_mfma_f32_16x16x32_bf16 v[132:135], v[44:47], v[72:75], v[132:135]
ds_read_b64_tr_b16 v[42:43], v62 offset:9216
v_cvt_pk_bf16_f32 v25, v146, v147
v_cvt_pk_bf16_f32 v26, v148, v149
v_cvt_pk_bf16_f32 v27, v150, v151
v_mfma_f32_16x16x32_bf16 v[140:143], v[44:47], v[76:79], v[140:143]
ds_read_b64_tr_b16 v[44:45], v62 offset:8992
buffer_store_dwordx4 v[24:27], v61, s[28:31], s43 offen sc1
s_waitcnt lgkmcnt(3)
v_mfma_f32_16x16x32_bf16 v[128:131], v[32:35], v[80:83], v[128:131]
ds_read_b64_tr_b16 v[46:47], v62 offset:9248
s_barrier
v_add_u32 v62, v58, v60
v_mfma_f32_16x16x32_bf16 v[136:139], v[32:35], v[84:87], v[136:139]
ds_read_b64_tr_b16 v[32:33], v62 offset:0
v_mfma_f32_16x16x32_bf16 v[132:135], v[36:39], v[80:83], v[132:135]
ds_read_b64_tr_b16 v[34:35], v62 offset:256
s_add_u32 s43, s43, 16384
v_mfma_f32_16x16x32_bf16 v[140:143], v[36:39], v[84:87], v[140:143]
ds_read_b64_tr_b16 v[36:37], v62 offset:32
s_waitcnt lgkmcnt(3)
v_mfma_f32_16x16x32_bf16 v[128:131], v[40:43], v[88:91], v[128:131]
ds_read_b64_tr_b16 v[38:39], v62 offset:288
v_cvt_pk_bf16_f32 v28, v152, v153
v_mfma_f32_16x16x32_bf16 v[136:139], v[40:43], v[92:95], v[136:139]
ds_read_b64_tr_b16 v[40:41], v62 offset:512
v_mfma_f32_16x16x32_bf16 v[132:135], v[44:47], v[88:91], v[132:135]
ds_read_b64_tr_b16 v[42:43], v62 offset:768
v_cvt_pk_bf16_f32 v29, v154, v155
v_mfma_f32_16x16x32_bf16 v[140:143], v[44:47], v[92:95], v[140:143]
ds_read_b64_tr_b16 v[44:45], v62 offset:544
s_waitcnt lgkmcnt(3)
v_mfma_f32_16x16x32_bf16 v[128:131], v[32:35], a[0:3], v[128:131]
ds_read_b64_tr_b16 v[46:47], v62 offset:800
v_cvt_pk_bf16_f32 v30, v156, v157
v_mfma_f32_16x16x32_bf16 v[136:139], v[32:35], a[4:7], v[136:139]
ds_read_b64_tr_b16 v[32:33], v62 offset:8448
v_mfma_f32_16x16x32_bf16 v[132:135], v[36:39], a[0:3], v[132:135]
ds_read_b64_tr_b16 v[34:35], v62 offset:8704
v_cvt_pk_bf16_f32 v31, v158, v159
v_mfma_f32_16x16x32_bf16 v[140:143], v[36:39], a[4:7], v[140:143]
ds_read_b64_tr_b16 v[36:37], v62 offset:8480
s_waitcnt lgkmcnt(3)
v_mfma_f32_16x16x32_bf16 v[128:131], v[40:43], a[8:11], v[128:131]
ds_read_b64_tr_b16 v[38:39], v62 offset:8736
v_mfma_f32_16x16x32_bf16 v[136:139], v[40:43], a[12:15], v[136:139]
ds_read_b64_tr_b16 v[40:41], v62 offset:8960
v_mfma_f32_16x16x32_bf16 v[132:135], v[44:47], a[8:11], v[132:135]
ds_read_b64_tr_b16 v[42:43], v62 offset:9216
v_mfma_f32_16x16x32_bf16 v[140:143], v[44:47], a[12:15], v[140:143]
ds_read_b64_tr_b16 v[44:45], v62 offset:8992
buffer_store_dwordx4 v[28:31], v61, s[28:31], s43 offen sc1
s_add_u32 s46, s40, 1536
s_waitcnt vmcnt(4)
buffer_store_dword v48, v50, s[28:31], s46 offen sc1
s_waitcnt lgkmcnt(3)
v_mfma_f32_16x16x32_bf16 v[128:131], v[32:35], a[16:19], v[128:131]
ds_read_b64_tr_b16 v[46:47], v62 offset:9248
v_mfma_f32_16x16x32_bf16 v[136:139], v[32:35], a[20:23], v[136:139]
v_mfma_f32_16x16x32_bf16 v[132:135], v[36:39], a[16:19], v[132:135]
s_add_u32 s62, s62, 1
s_cmp_eq_u32 s62, 7
v_mfma_f32_16x16x32_bf16 v[140:143], v[36:39], a[20:23], v[140:143]
s_cselect_b32 s62, 0, s62
s_waitcnt lgkmcnt(0)
v_mfma_f32_16x16x32_bf16 v[128:131], v[40:43], a[24:27], v[128:131]
v_mfma_f32_16x16x32_bf16 v[136:139], v[40:43], a[28:31], v[136:139]
v_mfma_f32_16x16x32_bf16 v[132:135], v[44:47], a[24:27], v[132:135]
v_mfma_f32_16x16x32_bf16 v[140:143], v[44:47], a[28:31], v[140:143]
s_nop 7
s_lshl_b32 s43, s62, 16
s_add_u32 s43, s43, s39
v_cvt_pk_bf16_f32 v16, v128, v129
v_cvt_pk_bf16_f32 v17, v130, v131
v_cvt_pk_bf16_f32 v18, v132, v133
v_cvt_pk_bf16_f32 v19, v134, v135
buffer_store_dwordx4 v[16:19], v61, s[28:31], s43 offen sc1
s_add_u32 s43, s43, 16384
v_cvt_pk_bf16_f32 v20, v136, v137
v_cvt_pk_bf16_f32 v21, v138, v139
v_cvt_pk_bf16_f32 v22, v140, v141
v_cvt_pk_bf16_f32 v23, v142, v143
buffer_store_dwordx4 v[20:23], v61, s[28:31], s43 offen sc1
s_add_u32 s46, s40, 3072
s_waitcnt vmcnt(0)
buffer_store_dword v48, v50, s[28:31], s46 offen sc1
s_add_u32 s62, s3, 4
s_cmp_eq_u32 s3, 3
s_cbranch_scc1 L_fin
L_reduce:
v_mbcnt_lo_u32_b32 v2, -1, 0
v_mbcnt_hi_u32_b32 v2, -1, v2
s_lshr_b32 s4, s33, 3
s_bfe_u32 s5, s33, 0x10002
s_bfe_u32 s6, s33, 0x10001
s_and_b32 s52, s33, 1
s_lshl_b32 s45, s5, 1
s_add_u32 s45, s45, s4
s_lshl_b32 s46, s62, 2
s_cmp_lt_u32 s62, 4
s_cselect_b32 s46, 12, 24
s_add_u32 s45, s45, s46
s_lshl_b32 s45, s45, 7
s_add_u32 s45, s45, s63
s_add_u32 s46, s62, s44
s_sub_u32 s7, s46, 7
s_cmp_ge_u32 s46, 7
s_cselect_b32 s46, s7, s46
s_lshl_b32 s47, s32, 1
s_add_u32 s47, s47, s34
s_lshl_b32 s47, s47, 1
s_add_u32 s47, s47, s4
s_lshl_b32 s46, s46, 1
s_add_u32 s46, s46, s5
s_lshl_b32 s53, s46, 1
s_add_u32 s53, s53, s6
s_mul_i32 s48, s47, 28
s_add_u32 s48, s48, s53
s_lshl_b32 s48, s48, 14
s_lshl_b32 s49, s52, 9
s_add_u32 s48, s48, s49
s_lshl_b32 s50, s47, 1
s_add_u32 s50, s50, s6
s_mul_i32 s50, s50, 14336
s_lshl_b32 s46, s46, 6
s_add_u32 s50, s50, s46
s_lshl_b32 s49, s52, 4
s_add_u32 s50, s50, s49
v_and_b32 v3, 15, v2
v_lshlrev_b32 v5, 2, v3
v_and_b32 v6, 31, v2
v_lshrrev_b32 v7, 5, v2
v_lshlrev_b32 v8, 4, v6
v_lshl_add_u32 v8, v7, 13, v8
v_mul_u32_u24 v9, 896, v3
v_bfe_u32 v7, v2, 4, 1
v_lshl_add_u32 v9, v7, 3, v9
s_add_u32 s49, s48, 4096
L_tag_r:
v_cmp_ne_u32 vcc, 0, v48
s_sub_u32 s41, s41, 1
s_cbranch_scc1 L_tagok_r
s_nop 2
s_cbranch_vccnz L_tagok_r
v_mov_b32 v50, 0
global_load_dword v48, v50, s[0:1] sc1
s_waitcnt vmcnt(0)
s_branch L_tag_r
L_tagok_r:
v_mov_b32 v4, v48
L_rpoll:
buffer_load_dword v10, v5, s[28:31], s45 offen sc1
s_sub_u32 s41, s41, 1
s_waitcnt vmcnt(0)
v_cmp_ne_u32 vcc, v10, v4
s_cbranch_scc1 L_rgo
s_nop 2
s_cbranch_vccz L_rgo
s_sleep 8
s_branch L_rpoll
L_rgo:
buffer_load_dwordx4 v[16:19], v8, s[28:31], s48 offen offset:0 sc1
buffer_load_dwordx4 v[20:23], v8, s[28:31], s48 offen offset:1024 sc1
buffer_load_dwordx4 v[24:27], v8, s[28:31], s48 offen offset:2048 sc1
buffer_load_dwordx4 v[28:31], v8, s[28:31], s48 offen offset:3072 sc1
buffer_load_dwordx4 v[32:35], v8, s[28:31], s49 offen offset:0 sc1
buffer_load_dwordx4 v[36:39], v8, s[28:31], s49 offen offset:1024 sc1
buffer_load_dwordx4 v[40:43], v8, s[28:31], s49 offen offset:2048 sc1
buffer_load_dwordx4 v[44:47], v8, s[28:31], s49 offen offset:3072 sc1
s_waitcnt vmcnt(7)
v_lshlrev_b32 v48, 16, v16
v_and_b32 v49, 0xffff0000, v16
v_lshlrev_b32 v50, 16, v17
v_and_b32 v51, 0xffff0000, v17
v_lshlrev_b32 v52, 16, v18
v_and_b32 v53, 0xffff0000, v18
v_lshlrev_b32 v54, 16, v19
v_and_b32 v55, 0xffff0000, v19
s_waitcnt vmcnt(6)
v_lshlrev_b32 v10, 16, v20
v_and_b32 v11, 0xffff0000, v20
v_add_f32 v48, v48, v10
v_add_f32 v49, v49, v11
v_lshlrev_b32 v10, 16, v21
v_and_b32 v11, 0xffff0000, v21
v_add_f32 v50, v50, v10
v_add_f32 v51, v51, v11
v_lshlrev_b32 v10, 16, v22
v_and_b32 v11, 0xffff0000, v22
v_add_f32 v52, v52, v10
v_add_f32 v53, v53, v11
v_lshlrev_b32 v10, 16, v23
v_and_b32 v11, 0xffff0000, v23
v_add_f32 v54, v54, v10
v_add_f32 v55, v55, v11
s_waitcnt vmcnt(5)
v_lshlrev_b32 v10, 16, v24
v_and_b32 v11, 0xffff0000, v24
v_add_f32 v48, v48, v10
v_add_f32 v49, v49, v11
v_lshlrev_b32 v10, 16, v25
v_and_b32 v11, 0xffff0000, v25
v_add_f32 v50, v50, v10
v_add_f32 v51, v51, v11
v_lshlrev_b32 v10, 16, v26
v_and_b32 v11, 0xffff0000, v26
v_add_f32 v52, v52, v10
v_add_f32 v53, v53, v11
v_lshlrev_b32 v10, 16, v27
v_and_b32 v11, 0xffff0000, v27
v_add_f32 v54, v54, v10
v_add_f32 v55, v55, v11
s_waitcnt vmcnt(4)
v_lshlrev_b32 v10, 16, v28
v_and_b32 v11, 0xffff0000, v28
v_add_f32 v48, v48, v10
v_add_f32 v49, v49, v11
v_lshlrev_b32 v10, 16, v29
v_and_b32 v11, 0xffff0000, v29
v_add_f32 v50, v50, v10
v_add_f32 v51, v51, v11
v_lshlrev_b32 v10, 16, v30
v_and_b32 v11, 0xffff0000, v30
v_add_f32 v52, v52, v10
v_add_f32 v53, v53, v11
v_lshlrev_b32 v10, 16, v31
v_and_b32 v11, 0xffff0000, v31
v_add_f32 v54, v54, v10
v_add_f32 v55, v55, v11
s_waitcnt vmcnt(3)
v_lshlrev_b32 v10, 16, v32
v_and_b32 v11, 0xffff0000, v32
v_add_f32 v48, v48, v10
v_add_f32 v49, v49, v11
v_lshlrev_b32 v10, 16, v33
v_and_b32 v11, 0xffff0000, v33
v_add_f32 v50, v50, v10
v_add_f32 v51, v51, v11
v_lshlrev_b32 v10, 16, v34
v_and_b32 v11, 0xffff0000, v34
v_add_f32 v52, v52, v10
v_add_f32 v53, v53, v11
v_lshlrev_b32 v10, 16, v35
v_and_b32 v11, 0xffff0000, v35
v_add_f32 v54, v54, v10
v_add_f32 v55, v55, v11
s_waitcnt vmcnt(2)
v_lshlrev_b32 v10, 16, v36
v_and_b32 v11, 0xffff0000, v36
v_add_f32 v48, v48, v10
v_add_f32 v49, v49, v11
v_lshlrev_b32 v10, 16, v37
v_and_b32 v11, 0xffff0000, v37
v_add_f32 v50, v50, v10
v_add_f32 v51, v51, v11
v_lshlrev_b32 v10, 16, v38
v_and_b32 v11, 0xffff0000, v38
v_add_f32 v52, v52, v10
v_add_f32 v53, v53, v11
v_lshlrev_b32 v10, 16, v39
v_and_b32 v11, 0xffff0000, v39
v_add_f32 v54, v54, v10
v_add_f32 v55, v55, v11
s_waitcnt vmcnt(1)
v_lshlrev_b32 v10, 16, v40
v_and_b32 v11, 0xffff0000, v40
v_add_f32 v48, v48, v10
v_add_f32 v49, v49, v11
v_lshlrev_b32 v10, 16, v41
v_and_b32 v11, 0xffff0000, v41
v_add_f32 v50, v50, v10
v_add_f32 v51, v51, v11
v_lshlrev_b32 v10, 16, v42
v_and_b32 v11, 0xffff0000, v42
v_add_f32 v52, v52, v10
v_add_f32 v53, v53, v11
v_lshlrev_b32 v10, 16, v43
v_and_b32 v11, 0xffff0000, v43
v_add_f32 v54, v54, v10
v_add_f32 v55, v55, v11
s_waitcnt vmcnt(0)
v_lshlrev_b32 v10, 16, v44
v_and_b32 v11, 0xffff0000, v44
v_add_f32 v48, v48, v10
v_add_f32 v49, v49, v11
v_lshlrev_b32 v10, 16, v45
v_and_b32 v11, 0xffff0000, v45
v_add_f32 v50, v50, v10
v_add_f32 v51, v51, v11
v_lshlrev_b32 v10, 16, v46
v_and_b32 v11, 0xffff0000, v46
v_add_f32 v52, v52, v10
v_add_f32 v53, v53, v11
v_lshlrev_b32 v10, 16, v47
v_and_b32 v11, 0xffff0000, v47
v_add_f32 v54, v54, v10
v_add_f32 v55, v55, v11
v_mov_b32 v56, v48
v_mov_b32 v57, v49
v_mov_b32 v58, v50
v_mov_b32 v59, v51
v_mov_b32 v60, v52
v_mov_b32 v61, v53
v_mov_b32 v62, v54
v_mov_b32 v63, v55
s_nop 1
v_permlane32_swap_b32 v48, v56
v_permlane32_swap_b32 v49, v57
v_permlane32_swap_b32 v50, v58
v_permlane32_swap_b32 v51, v59
v_permlane32_swap_b32 v52, v60
v_permlane32_swap_b32 v53, v61
v_permlane32_swap_b32 v54, v62
v_permlane32_swap_b32 v55, v63
s_nop 1
v_add_f32 v48, v48, v56
v_add_f32 v49, v49, v57
v_add_f32 v50, v50, v58
v_add_f32 v51, v51, v59
v_add_f32 v52, v52, v60
v_add_f32 v53, v53, v61
v_add_f32 v54, v54, v62
v_add_f32 v55, v55, v63
v_cvt_pk_bf16_f32 v16, v48, v49
v_cvt_pk_bf16_f32 v17, v50, v51
v_cvt_pk_bf16_f32 v18, v52, v53
v_cvt_pk_bf16_f32 v19, v54, v55
s_mov_b32 exec_hi, 0
buffer_store_dwordx2 v[16:17], v9, s[96:99], s50 offen
buffer_store_dwordx2 v[18:19], v9, s[96:99], s50 offen offset:32
L_fin:
s_endpgm
L_ra_0:
s_call_b64 s[8:9], L_resa0
s_branch L_rab_0
L_rb_0:
s_call_b64 s[8:9], L_resb0
s_branch L_rbb_0
L_ra_1:
s_call_b64 s[8:9], L_resa1
s_branch L_rab_1
L_rb_1:
s_call_b64 s[8:9], L_resb1
s_branch L_rbb_1
L_ra_14:
s_call_b64 s[8:9], L_resa0
s_branch L_rab_14
L_rb_14:
s_call_b64 s[8:9], L_resb0
s_branch L_rbb_14
L_resa0:
v_max3_f32 v8, v16, v17, v18
v_max3_f32 v9, v24, v25, v26
v_max3_f32 v8, v8, v19, v20
v_max3_f32 v9, v9, v27, v28
v_max3_f32 v8, v8, v21, v22
v_max3_f32 v9, v9, v29, v30
v_max_f32 v8, v8, v23
v_max_f32 v9, v9, v31
v_mov_b32 v10, v8
v_mov_b32 v11, v9
s_nop 1
v_permlane16_swap_b32 v10, v8
v_permlane16_swap_b32 v11, v9
s_nop 1
v_max_f32 v8, v8, v10
v_max_f32 v9, v9, v11
v_mov_b32 v10, v8
v_mov_b32 v11, v9
s_nop 1
v_permlane32_swap_b32 v10, v8
v_permlane32_swap_b32 v11, v9
s_nop 1
v_max_f32 v8, v8, v10
v_max_f32 v9, v9, v11
v_max_f32 v8, 0, v8
v_sub_f32 v16, v16, v8
v_sub_f32 v17, v17, v8
v_sub_f32 v18, v18, v8
v_sub_f32 v19, v19, v8
v_sub_f32 v20, v20, v8
v_sub_f32 v21, v21, v8
v_sub_f32 v22, v22, v8
v_sub_f32 v23, v23, v8
v_sub_f32 v48, v48, v8
v_sub_f32 v49, v49, v8
v_sub_f32 v50, v50, v8
v_sub_f32 v51, v51, v8
v_exp_f32 v8, -v8
s_nop 0
v_mul_f32 v56, v56, v8
v_max_f32 v9, 0, v9
v_sub_f32 v24, v24, v9
v_sub_f32 v25, v25, v9
v_sub_f32 v26, v26, v9
v_sub_f32 v27, v27, v9
v_sub_f32 v28, v28, v9
v_sub_f32 v29, v29, v9
v_sub_f32 v30, v30, v9
v_sub_f32 v31, v31, v9
v_sub_f32 v52, v52, v9
v_sub_f32 v53, v53, v9
v_sub_f32 v54, v54, v9
v_sub_f32 v55, v55, v9
v_exp_f32 v9, -v9
s_nop 0
v_mul_f32 v57, v57, v9
s_setpc_b64 s[8:9]
L_resb0:
s_nop 7
v_mul_f32 v64, v64, v8
v_mul_f32 v65, v65, v8
v_mul_f32 v66, v66, v8
v_mul_f32 v67, v67, v8
v_mul_f32 v68, v68, v8
v_mul_f32 v69, v69, v8
v_mul_f32 v70, v70, v8
v_mul_f32 v71, v71, v8
v_mul_f32 v72, v72, v9
v_mul_f32 v73, v73, v9
v_mul_f32 v74, v74, v9
v_mul_f32 v75, v75, v9
v_mul_f32 v76, v76, v9
v_mul_f32 v77, v77, v9
v_mul_f32 v78, v78, v9
v_mul_f32 v79, v79, v9
v_mul_f32 v80, v80, v8
v_mul_f32 v81, v81, v8
v_mul_f32 v82, v82, v8
v_mul_f32 v83, v83, v8
v_mul_f32 v84, v84, v8
v_mul_f32 v85, v85, v8
v_mul_f32 v86, v86, v8
v_mul_f32 v87, v87, v8
v_mul_f32 v88, v88, v9
v_mul_f32 v89, v89, v9
v_mul_f32 v90, v90, v9
v_mul_f32 v91, v91, v9
v_mul_f32 v92, v92, v9
v_mul_f32 v93, v93, v9
v_mul_f32 v94, v94, v9
v_mul_f32 v95, v95, v9
v_mul_f32 v96, v96, v8
v_mul_f32 v97, v97, v8
v_mul_f32 v98, v98, v8
v_mul_f32 v99, v99, v8
v_mul_f32 v100, v100, v8
v_mul_f32 v101, v101, v8
v_mul_f32 v102, v102, v8
v_mul_f32 v103, v103, v8
v_mul_f32 v104, v104, v9
v_mul_f32 v105, v105, v9
v_mul_f32 v106, v106, v9
v_mul_f32 v107, v107, v9
v_mul_f32 v108, v108, v9
v_mul_f32 v109, v109, v9
v_mul_f32 v110, v110, v9
v_mul_f32 v111, v111, v9
v_mul_f32 v112, v112, v8
v_mul_f32 v113, v113, v8
v_mul_f32 v114, v114, v8
v_mul_f32 v115, v115, v8
v_mul_f32 v116, v116, v8
v_mul_f32 v117, v117, v8
v_mul_f32 v118, v118, v8
v_mul_f32 v119, v119, v8
v_mul_f32 v120, v120, v9
v_mul_f32 v121, v121, v9
v_mul_f32 v122, v122, v9
v_mul_f32 v123, v123, v9
v_mul_f32 v124, v124, v9
v_mul_f32 v125, v125, v9
v_mul_f32 v126, v126, v9
v_mul_f32 v127, v127, v9
v_mul_f32 v128, v128, v8
v_mul_f32 v129, v129, v8
v_mul_f32 v130, v130, v8
v_mul_f32 v131, v131, v8
v_mul_f32 v132, v132, v8
v_mul_f32 v133, v133, v8
v_mul_f32 v134, v134, v8
v_mul_f32 v135, v135, v8
v_mul_f32 v136, v136, v9
v_mul_f32 v137, v137, v9
v_mul_f32 v138, v138, v9
v_mul_f32 v139, v139, v9
v_mul_f32 v140, v140, v9
v_mul_f32 v141, v141, v9
v_mul_f32 v142, v142, v9
v_mul_f32 v143, v143, v9
v_mul_f32 v144, v144, v8
v_mul_f32 v145, v145, v8
v_mul_f32 v146, v146, v8
v_mul_f32 v147, v147, v8
v_mul_f32 v148, v148, v8
v_mul_f32 v149, v149, v8
v_mul_f32 v150, v150, v8
v_mul_f32 v151, v151, v8
v_mul_f32 v152, v152, v9
v_mul_f32 v153, v153, v9
v_mul_f32 v154, v154, v9
v_mul_f32 v155, v155, v9
v_mul_f32 v156, v156, v9
v_mul_f32 v157, v157, v9
v_mul_f32 v158, v158, v9
v_mul_f32 v159, v159, v9
v_mul_f32 v160, v160, v8
v_mul_f32 v161, v161, v8
v_mul_f32 v162, v162, v8
v_mul_f32 v163, v163, v8
v_mul_f32 v164, v164, v8
v_mul_f32 v165, v165, v8
v_mul_f32 v166, v166, v8
v_mul_f32 v167, v167, v8
v_mul_f32 v168, v168, v9
v_mul_f32 v169, v169, v9
v_mul_f32 v170, v170, v9
v_mul_f32 v171, v171, v9
v_mul_f32 v172, v172, v9
v_mul_f32 v173, v173, v9
v_mul_f32 v174, v174, v9
v_mul_f32 v175, v175, v9
v_mul_f32 v176, v176, v8
v_mul_f32 v177, v177, v8
v_mul_f32 v178, v178, v8
v_mul_f32 v179, v179, v8
v_mul_f32 v180, v180, v8
v_mul_f32 v181, v181, v8
v_mul_f32 v182, v182, v8
v_mul_f32 v183, v183, v8
v_mul_f32 v184, v184, v9
v_mul_f32 v185, v185, v9
v_mul_f32 v186, v186, v9
v_mul_f32 v187, v187, v9
v_mul_f32 v188, v188, v9
v_mul_f32 v189, v189, v9
v_mul_f32 v190, v190, v9
v_mul_f32 v191, v191, v9
s_nop 1
s_setpc_b64 s[8:9]
L_resa1:
v_max3_f32 v24, v0, v1, v2
v_max3_f32 v25, v8, v9, v10
v_max3_f32 v24, v24, v3, v4
v_max3_f32 v25, v25, v11, v12
v_max3_f32 v24, v24, v5, v6
v_max3_f32 v25, v25, v13, v14
v_max_f32 v24, v24, v7
v_max_f32 v25, v25, v15
v_mov_b32 v26, v24
v_mov_b32 v27, v25
s_nop 1
v_permlane16_swap_b32 v26, v24
v_permlane16_swap_b32 v27, v25
s_nop 1
v_max_f32 v24, v24, v26
v_max_f32 v25, v25, v27
v_mov_b32 v26, v24
v_mov_b32 v27, v25
s_nop 1
v_permlane32_swap_b32 v26, v24
v_permlane32_swap_b32 v27, v25
s_nop 1
v_max_f32 v24, v24, v26
v_max_f32 v25, v25, v27
v_max_f32 v24, 0, v24
v_sub_f32 v0, v0, v24
v_sub_f32 v1, v1, v24
v_sub_f32 v2, v2, v24
v_sub_f32 v3, v3, v24
v_sub_f32 v4, v4, v24
v_sub_f32 v5, v5, v24
v_sub_f32 v6, v6, v24
v_sub_f32 v7, v7, v24
v_sub_f32 v48, v48, v24
v_sub_f32 v49, v49, v24
v_sub_f32 v50, v50, v24
v_sub_f32 v51, v51, v24
v_exp_f32 v24, -v24
s_nop 0
v_mul_f32 v56, v56, v24
v_max_f32 v25, 0, v25
v_sub_f32 v8, v8, v25
v_sub_f32 v9, v9, v25
v_sub_f32 v10, v10, v25
v_sub_f32 v11, v11, v25
v_sub_f32 v12, v12, v25
v_sub_f32 v13, v13, v25
v_sub_f32 v14, v14, v25
v_sub_f32 v15, v15, v25
v_sub_f32 v52, v52, v25
v_sub_f32 v53, v53, v25
v_sub_f32 v54, v54, v25
v_sub_f32 v55, v55, v25
v_exp_f32 v25, -v25
s_nop 0
v_mul_f32 v57, v57, v25
s_setpc_b64 s[8:9]
L_resb1:
s_nop 7
v_mul_f32 v64, v64, v24
v_mul_f32 v65, v65, v24
v_mul_f32 v66, v66, v24
v_mul_f32 v67, v67, v24
v_mul_f32 v68, v68, v24
v_mul_f32 v69, v69, v24
v_mul_f32 v70, v70, v24
v_mul_f32 v71, v71, v24
v_mul_f32 v72, v72, v25
v_mul_f32 v73, v73, v25
v_mul_f32 v74, v74, v25
v_mul_f32 v75, v75, v25
v_mul_f32 v76, v76, v25
v_mul_f32 v77, v77, v25
v_mul_f32 v78, v78, v25
v_mul_f32 v79, v79, v25
v_mul_f32 v80, v80, v24
v_mul_f32 v81, v81, v24
v_mul_f32 v82, v82, v24
v_mul_f32 v83, v83, v24
v_mul_f32 v84, v84, v24
v_mul_f32 v85, v85, v24
v_mul_f32 v86, v86, v24
v_mul_f32 v87, v87, v24
v_mul_f32 v88, v88, v25
v_mul_f32 v89, v89, v25
v_mul_f32 v90, v90, v25
v_mul_f32 v91, v91, v25
v_mul_f32 v92, v92, v25
v_mul_f32 v93, v93, v25
v_mul_f32 v94, v94, v25
v_mul_f32 v95, v95, v25
v_mul_f32 v96, v96, v24
v_mul_f32 v97, v97, v24
v_mul_f32 v98, v98, v24
v_mul_f32 v99, v99, v24
v_mul_f32 v100, v100, v24
v_mul_f32 v101, v101, v24
v_mul_f32 v102, v102, v24
v_mul_f32 v103, v103, v24
v_mul_f32 v104, v104, v25
v_mul_f32 v105, v105, v25
v_mul_f32 v106, v106, v25
v_mul_f32 v107, v107, v25
v_mul_f32 v108, v108, v25
v_mul_f32 v109, v109, v25
v_mul_f32 v110, v110, v25
v_mul_f32 v111, v111, v25
v_mul_f32 v112, v112, v24
v_mul_f32 v113, v113, v24
v_mul_f32 v114, v114, v24
v_mul_f32 v115, v115, v24
v_mul_f32 v116, v116, v24
v_mul_f32 v117, v117, v24
v_mul_f32 v118, v118, v24
v_mul_f32 v119, v119, v24
v_mul_f32 v120, v120, v25
v_mul_f32 v121, v121, v25
v_mul_f32 v122, v122, v25
v_mul_f32 v123, v123, v25
v_mul_f32 v124, v124, v25
v_mul_f32 v125, v125, v25
v_mul_f32 v126, v126, v25
v_mul_f32 v127, v127, v25
v_mul_f32 v128, v128, v24
v_mul_f32 v129, v129, v24
v_mul_f32 v130, v130, v24
v_mul_f32 v131, v131, v24
v_mul_f32 v132, v132, v24
v_mul_f32 v133, v133, v24
v_mul_f32 v134, v134, v24
v_mul_f32 v135, v135, v24
v_mul_f32 v136, v136, v25
v_mul_f32 v137, v137, v25
v_mul_f32 v138, v138, v25
v_mul_f32 v139, v139, v25
v_mul_f32 v140, v140, v25
v_mul_f32 v141, v141, v25
v_mul_f32 v142, v142, v25
v_mul_f32 v143, v143, v25
v_mul_f32 v144, v144, v24
v_mul_f32 v145, v145, v24
v_mul_f32 v146, v146, v24
v_mul_f32 v147, v147, v24
v_mul_f32 v148, v148, v24
v_mul_f32 v149, v149, v24
v_mul_f32 v150, v150, v24
v_mul_f32 v151, v151, v24
v_mul_f32 v152, v152, v25
v_mul_f32 v153, v153, v25
v_mul_f32 v154, v154, v25
v_mul_f32 v155, v155, v25
v_mul_f32 v156, v156, v25
v_mul_f32 v157, v157, v25
v_mul_f32 v158, v158, v25
v_mul_f32 v159, v159, v25
v_mul_f32 v160, v160, v24
v_mul_f32 v161, v161, v24
v_mul_f32 v162, v162, v24
v_mul_f32 v163, v163, v24
v_mul_f32 v164, v164, v24
v_mul_f32 v165, v165, v24
v_mul_f32 v166, v166, v24
v_mul_f32 v167, v167, v24
v_mul_f32 v168, v168, v25
v_mul_f32 v169, v169, v25
v_mul_f32 v170, v170, v25
v_mul_f32 v171, v171, v25
v_mul_f32 v172, v172, v25
v_mul_f32 v173, v173, v25
v_mul_f32 v174, v174, v25
v_mul_f32 v175, v175, v25
v_mul_f32 v176, v176, v24
v_mul_f32 v177, v177, v24
v_mul_f32 v178, v178, v24
v_mul_f32 v179, v179, v24
v_mul_f32 v180, v180, v24
v_mul_f32 v181, v181, v24
v_mul_f32 v182, v182, v24
v_mul_f32 v183, v183, v24
v_mul_f32 v184, v184, v25
v_mul_f32 v185, v185, v25
v_mul_f32 v186, v186, v25
v_mul_f32 v187, v187, v25
v_mul_f32 v188, v188, v25
v_mul_f32 v189, v189, v25
v_mul_f32 v190, v190, v25
v_mul_f32 v191, v191, v25
s_nop 1
s_setpc_b64 s[8:9]
.p2align 8
.type L_table,@object
L_table:
.long 0x1c00, 0x6000, 0xa400, 0x12c00, 0x17000, 0xe800, 0x1b400, 0x1f800
.long 0x1c00, 0x6000, 0x23c00, 0xa400, 0x17000, 0x1f800, 0x1c00, 0x1b400
.long 0x6000, 0x23c00, 0x1f800, 0x1c00, 0x12c00, 0xe800, 0x1b400, 0x6000
.long 0x23c00, 0x12c00, 0x1c00, 0xe800, 0xa400, 0x17000, 0x6000, 0x23c00
.long 0x12c00, 0x1c00, 0xe800, 0xa400, 0x1f800, 0x1b400, 0x23c00, 0x12c00
.long 0x1c00, 0xe800, 0xa400, 0x1f800, 0x17000, 0x6000, 0x12c00, 0x1c00
.long 0xe800, 0xa400, 0x1f800, 0x17000, 0x1b400, 0x23c00, 0x1c00, 0xe800
.long 0xa400, 0x1f800, 0x17000, 0x1b400, 0x6000, 0x12c00, 0xe800, 0xa400
.long 0x1f800, 0x17000, 0x1b400, 0x6000, 0x23c00, 0x1c00, 0xa400, 0x1f800
.long 0x17000, 0x1b400, 0x6000, 0x23c00, 0x12c00, 0xe800, 0x1c00, 0xa400
.long 0x1f800, 0x17000, 0x1b400, 0x6000, 0x1f800, 0x17000, 0x23c00, 0x12c00
.long 0xe800, 0x1c00, 0xa400, 0x6000, 0x1b400, 0x17000, 0x1f800, 0x12c00
.long 0x23c00, 0x1c00, 0xe800, 0x6000, 0x0, 0x0, 0x0, 0x0
.long 0x0, 0x0, 0x0, 0x0, 0x0, 0x0, 0x0, 0x0
.long 0x0, 0x0, 0x0, 0x0, 0x0, 0x0, 0x0, 0x0
.long 0x0, 0x0, 0x0, 0x0, 0x0, 0x0, 0x0, 0x0
.long 0x1c00, 0x6000, 0xa400, 0x12c00, 0x17000, 0xe800, 0x1b400, 0x1f800
.long 0x1c00, 0x6000, 0x23c00, 0xa400, 0x12c00, 0x17000, 0x1c00, 0xe800
.long 0x6000, 0x23c00, 0x17000, 0x1c00, 0xa400, 0x12c00, 0x1b400, 0x1f800
.long 0x23c00, 0xa400, 0x1c00, 0x12c00, 0x17000, 0x1b400, 0xe800, 0x6000
.long 0xa400, 0x1c00, 0x12c00, 0x17000, 0x1b400, 0xe800, 0x1f800, 0x23c00
.long 0x1c00, 0x12c00, 0x17000, 0x1b400, 0xe800, 0x1f800, 0x6000, 0xa400
.long 0x12c00, 0x17000, 0x1b400, 0xe800, 0x1f800, 0x6000, 0x23c00, 0x1c00
.long 0x17000, 0x1b400, 0xe800, 0x1f800, 0x6000, 0x23c00, 0xa400, 0x12c00
.long 0x1b400, 0xe800, 0x1f800, 0x6000, 0x23c00, 0xa400, 0x1c00, 0x17000
.long 0xe800, 0x1f800, 0x6000, 0x23c00, 0xa400, 0x1c00, 0x12c00, 0x1b400
.long 0x17000, 0xe800, 0x1f800, 0x6000, 0x17000, 0xe800, 0x23c00, 0xa400
.long 0x1c00, 0x12c00, 0x1b400, 0x6000, 0x1f800, 0xe800, 0x17000, 0xa400
.long 0x23c00, 0x1c00, 0x12c00, 0x6000, 0x0, 0x0, 0x0, 0x0
.long 0x0, 0x0, 0x0, 0x0, 0x0, 0x0, 0x0, 0x0
.long 0x0, 0x0, 0x0, 0x0, 0x0, 0x0, 0x0, 0x0
.long 0x0, 0x0, 0x0, 0x0, 0x0, 0x0, 0x0, 0x0
.long 0x1c00, 0x6000, 0xa400, 0x12c00, 0x17000, 0xe800, 0x1b400, 0x1f800
.long 0x1c00, 0x6000, 0x23c00, 0xa400, 0x12c00, 0x17000, 0x1b400, 0xe800
.long 0x6000, 0x23c00, 0x17000, 0xe800, 0xa400, 0x12c00, 0x1b400, 0x6000
.long 0x1f800, 0x1c00, 0xe800, 0x12c00, 0x17000, 0x1b400, 0x6000, 0x1f800
.long 0x23c00, 0xa400, 0x12c00, 0x17000, 0x1b400, 0x6000, 0x1f800, 0x23c00
.long 0x1c00, 0xe800, 0x17000, 0x1b400, 0x6000, 0x1f800, 0x23c00, 0x1c00
.long 0xa400, 0x12c00, 0x1b400, 0x6000, 0x1f800, 0x23c00, 0x1c00, 0xa400
.long 0xe800, 0x17000, 0x6000, 0x1f800, 0x23c00, 0x1c00, 0xa400, 0xe800
.long 0x12c00, 0x1b400, 0x1f800, 0x23c00, 0x1c00, 0xa400, 0xe800, 0x12c00
.long 0x17000, 0x6000, 0x23c00, 0x1c00, 0xa400, 0xe800, 0x12c00, 0x17000
.long 0x1b400, 0x1f800, 0x6000, 0x23c00, 0x1b400, 0x1f800, 0x1c00, 0xa400
.long 0xe800, 0x12c00, 0x17000, 0x6000, 0x23c00, 0x1b400, 0x1f800, 0x1c00
.long 0xa400, 0xe800, 0x12c00, 0x6000, 0x0, 0x0, 0x0, 0x0
.long 0x0, 0x0, 0x0, 0x0, 0x0, 0x0, 0x0, 0x0
.long 0x0, 0x0, 0x0, 0x0, 0x0, 0x0, 0x0, 0x0
.long 0x0, 0x0, 0x0, 0x0, 0x0, 0x0, 0x0, 0x0
.long 0x1c00, 0x6000, 0xa400, 0x12c00, 0x17000, 0xe800, 0x1b400, 0x1f800
.long 0x1c00, 0x6000, 0x23c00, 0xa400, 0x12c00, 0x17000, 0x1b400, 0xe800
.long 0x1f800, 0x1c00, 0x17000, 0xe800, 0xa400, 0x12c00, 0x1b400, 0x1f800
.long 0x1c00, 0xa400, 0x6000, 0x23c00, 0x17000, 0x1b400, 0x1f800, 0x1c00
.long 0xa400, 0x6000, 0xe800, 0x12c00, 0x1b400, 0x1f800, 0x1c00, 0xa400
.long 0x6000, 0xe800, 0x23c00, 0x17000, 0x1f800, 0x1c00, 0xa400, 0x6000
.long 0xe800, 0x23c00, 0x12c00, 0x1b400, 0x1c00, 0xa400, 0x6000, 0xe800
.long 0x23c00, 0x12c00, 0x17000, 0x1f800, 0xa400, 0x6000, 0xe800, 0x23c00
.long 0x12c00, 0x17000, 0x1b400, 0x1c00, 0x6000, 0xe800, 0x23c00, 0x12c00
.long 0x17000, 0x1b400, 0x1f800, 0xa400, 0xe800, 0x23c00, 0x12c00, 0x17000
.long 0x1b400, 0x1f800, 0x1c00, 0x6000, 0x1b400, 0x1f800, 0xa400, 0xe800
.long 0x23c00, 0x12c00, 0x17000, 0x1c00, 0x6000, 0x1b400, 0x1f800, 0xa400
.long 0xe800, 0x12c00, 0x23c00, 0x1c00, 0x0, 0x0, 0x0, 0x0
.long 0x0, 0x0, 0x0, 0x0, 0x0, 0x0, 0x0, 0x0
.long 0x0, 0x0, 0x0, 0x0, 0x0, 0x0, 0x0, 0x0
.long 0x0, 0x0, 0x0, 0x0, 0x0, 0x0, 0x0, 0x0
.section .rodata,"a"
.p2align 6
.amdhsa_kernel standalone__gqa_block_cached__near_ridge_kernel
  .amdhsa_next_free_vgpr 256
  .amdhsa_next_free_sgpr 102
  .amdhsa_accum_offset 192
  .amdhsa_group_segment_fixed_size 0
  .amdhsa_kernarg_size 64
  .amdhsa_user_sgpr_count 2
  .amdhsa_user_sgpr_kernarg_segment_ptr 1
  .amdhsa_system_sgpr_workgroup_id_x 1
.end_amdhsa_kernel
```
